```python
import torch

def _softmax(x, axis=-1):
    return torch.softmax(x, dim=axis)

def _gelu(x):
    return torch.nn.functional.gelu(x, approximate='tanh')

def _silu(x):
    return torch.nn.functional.silu(x)

def _sigmoid(x):
    return torch.sigmoid(x)

def _layernorm(x, axis=-1, eps=1e-05):
    m = x.mean(dim=axis, keepdim=True)
    v = x.var(dim=axis, keepdim=True, unbiased=False)
    return (x - m) / torch.sqrt(v + eps)

def _scatter_add(tgt, idx, src, axis=0):
    return tgt.clone().index_add_(axis, idx, src)

def _segment_sum(src, seg, n):
    out = torch.zeros((n,) + src.shape[1:], dtype=src.dtype)
    return out.index_add_(0, seg, src)

def _pad(x, pw):
    flat = tuple((v for pair in reversed(pw) for v in pair))
    return torch.nn.functional.pad(x, flat)
kernel_name = 'adaLN_cond__ssm_conv_s4d__moe_arch_mod__prompt'

def setup_inputs():

    _w = lambda a: (lambda t: t.to(torch.bfloat16) if t.is_floating_point() else t)(torch.as_tensor(a))

    def _A_setup():
        Bsz, L, D, N = (1, 2048, 576, 128)
        return {'u': _w((lambda *s: torch.randn(*s, dtype=torch.bfloat16) * 0.1)(Bsz, L, D)), 'log_A_real': _w((lambda *s: torch.randn(*s, dtype=torch.bfloat16) * 3.2)(D, N) * 0.5), 'A_imag': _w((lambda *s: torch.randn(*s, dtype=torch.bfloat16) * 0.4)(D, N) * 3.14), 'C_real': _w((lambda *s: torch.randn(*s, dtype=torch.bfloat16) * 0.8)(D, N) / N ** 0.5), 'C_imag': _w((lambda *s: torch.randn(*s, dtype=torch.bfloat16) * 0.8)(D, N) / N ** 0.5), 'log_dt': _w((lambda *s: torch.randn(*s, dtype=torch.bfloat16) * 0.4)(D) * 0.5 - 4.0), 'D_skip': _w((lambda *s: torch.randn(*s, dtype=torch.bfloat16) * 0.4)(D))}
    _A_in = _A_setup()

    def _B_setup():
        B, S, D, F, C = (1, 2048, 576, 4608, 8)
        return {'x': _w((lambda *s: torch.randn(*s, dtype=torch.bfloat16) * 0.1)(B, S, D)), 'w_r': _w((lambda *s: torch.randn(*s, dtype=torch.bfloat16) * 0.4)(D)), 'w_gate': _w((lambda *s: torch.randn(*s, dtype=torch.bfloat16) * 0.4)(D, F)), 'w_up': _w((lambda *s: torch.randn(*s, dtype=torch.bfloat16) * 0.4)(D, F)), 'w_down': _w((lambda *s: torch.randn(*s, dtype=torch.bfloat16) * 0.4)(F, D))}
    _B_in = _B_setup()
    return {'A_u': _A_in['u'], 'A_log_A_real': _A_in['log_A_real'], 'A_A_imag': _A_in['A_imag'], 'A_C_real': _A_in['C_real'], 'A_C_imag': _A_in['C_imag'], 'A_log_dt': _A_in['log_dt'], 'A_D_skip': _A_in['D_skip'], 'B_x': _B_in['x'], 'B_w_r': _B_in['w_r'], 'B_w_gate': _B_in['w_gate'], 'B_w_up': _B_in['w_up'], 'B_w_down': _B_in['w_down'], 'c': _w((lambda *s: torch.randn(*s, dtype=torch.bfloat16) * 0.2)(1, 576) * 8.0), 'w_mod': _w((lambda *s: torch.randn(*s, dtype=torch.bfloat16) * 0.2)(576, 6 * 576) * 576 ** (-0.5) * 8.0)}

def reference(A_u, A_log_A_real, A_A_imag, A_C_real, A_C_imag, A_log_dt, A_D_skip, B_x, B_w_r, B_w_gate, B_w_up, B_w_down, c, w_mod):

    def _A_ref(u, log_A_real, A_imag, C_real, C_imag, log_dt, D_skip):
        L = u.shape[1]
        dt = torch.exp(log_dt)
        A = -torch.exp(log_A_real) + 1j * A_imag
        C = (C_real + 1j * C_imag) * dt[:, None]
        pos = (lambda x, dt: x.to(dt))(torch.arange(L), log_dt.dtype)
        P = torch.exp((A * dt[:, None])[:, :, None] * pos[None, None, :])
        K = 2.0 * torch.einsum('dn,dnl->dl', C, P).real
        L2 = 2 * L
        u_t = (lambda x, *d: x.permute(*d))(u, 0, 2, 1)
        Kf = (lambda x, *a, **k: torch.fft.rfft(x.float(), *a, **k))(K, L2)
        Uf = (lambda x, *a, **k: torch.fft.rfft(x.float(), *a, **k))(u_t, L2)
        y = (lambda x, *a, **k: torch.fft.irfft(x, *a, **k).to(torch.bfloat16))(Uf * Kf[None, :, :], L2)[:, :, :L]
        y = (lambda x, *d: x.permute(*d))(y, 0, 2, 1)
        return y + u * D_skip[None, None, :]

    def _B_ref(x, w_r, w_gate, w_up, w_down):
        B, S, D = x.shape
        C = 8
        r = x @ w_r
        idx = torch.argsort(-r, axis=-1)[:, :C]
        idx_e = (lambda x, n, axis: torch.repeat_interleave(x, n, dim=axis))(idx.reshape(B, C, 1), D, axis=2)
        x_sel = (lambda x, i, axis: torch.take_along_dim(x, i, dim=axis))(x, idx_e, axis=1)
        g = _silu(x_sel @ w_gate)
        u = x_sel @ w_up
        y = g * u @ w_down
        r_sel = _sigmoid((lambda x, i, axis: torch.take_along_dim(x, i, dim=axis))(r, idx, axis=1))
        y = y * r_sel.reshape(B, C, 1)
        b_off = (torch.arange(B) * S).reshape(B, 1)
        flat_idx = (idx + b_off).reshape(B * C)
        zero = (x * 0.0).reshape(B * S, D)
        upd = _scatter_add(zero, flat_idx, y.reshape(B * C, D), axis=0)
        return x + upd.reshape(B, S, D)
    x = A_u
    mod = (_silu(c) @ w_mod).reshape(c.shape[0], 6, 1, -1)
    sa, ca, ga, sb, cb, gb = (mod[:, 0].clone(), mod[:, 1].clone(), mod[:, 2].clone(), mod[:, 3].clone(), mod[:, 4].clone(), mod[:, 5].clone())
    h = _layernorm(x, axis=-1) * (1 + ca) + sa
    x = x + ga * _A_ref(h, A_log_A_real, A_A_imag, A_C_real, A_C_imag, A_log_dt, A_D_skip)
    h = _layernorm(x, axis=-1) * (1 + cb) + sb
    x = x + gb * _B_ref(h, B_w_r, B_w_gate, B_w_up, B_w_down)
    return x
```

```asm
; @launch kernel=ka_kernel grid=(256,1,1) block=(512,1,1) lds=160768
.amdgcn_target "amdgcn-amd-amdhsa--gfx950"
.text
.globl ka_kernel
.p2align 8
.type ka_kernel,@function
ka_kernel:
  s_cmp_ge_u32 s2, 256
  s_cbranch_scc1 M_END
  s_load_dwordx16 s[4:19], s[0:1], 0
  s_load_dwordx16 s[20:35], s[0:1], 64
  s_load_dwordx2 s[36:37], s[0:1], 128
  v_lshrrev_b32 v1, 6, v0
  v_and_b32 v2, 63, v0

  v_readfirstlane_b32 s3, v1
  s_cmp_lg_u32 s3, 3
  s_cbranch_scc1 M_NCP
  s_getpc_b64 s[74:75]
M_PC:
  s_sub_u32 s74, s74, M_PC - ka_kernel
  s_subb_u32 s75, s75, 0
  s_lshr_b32 s76, s2, 3
  s_mul_i32 s76, s76, 10
  v_min_u32 v25, 9, v2
  v_add_u32 v25, s76, v25
  v_lshlrev_b32 v25, 7, v25
  v_min_u32 v25, CODE_END - ka_kernel - 4, v25
  global_load_dword v250, v25, s[74:75]
M_NCP:

  s_lshl_b32 s40, s2, 3
  s_add_u32 s40, s40, s3
  s_mul_i32 s40, s40, 1152
  v_lshl_add_u32 v3, v2, 4, s40
  v_lshl_add_u32 v4, v2, 1, s40
  v_mov_b32 v20, 0
  v_mov_b32 v21, 0
  v_mov_b32 v22, 0
  v_mov_b32 v23, 0
  v_mov_b32 v248, 0
  v_mov_b32 v249, 1
  v_lshlrev_b32 v24, 4, v2
  s_cmp_eq_u32 s3, 0
  s_cbranch_scc0 M_Z1
  s_mov_b64 exec, 0x3fffffff
  ds_write_b128 v24, v[20:23] offset:55168
  ds_write_b128 v24, v[20:23] offset:59776
  ds_write_b128 v24, v[20:23] offset:64384
M_Z1:
  s_cmp_eq_u32 s3, 2
  s_cbranch_scc0 M_Z3
  ds_write_b128 v24, v[20:23] offset:512
M_Z3:
  s_cmp_eq_u32 s3, 3
  s_cbranch_scc0 M_Z0
  s_mov_b64 exec, 0xfffff
  ds_write_b128 v24, v[20:23] offset:192
M_Z0:
  s_mov_b64 exec, -1
  s_lshr_b32 s41, s3, 1
  s_lshl_b32 s42, s2, 1
  s_add_u32 s42, s42, s41
  s_lshr_b32 s45, s2, 2
  s_add_u32 s45, s45, 512
  s_cmp_eq_u32 s41, 2
  s_cselect_b32 s42, s45, s42
  s_and_b32 s43, s3, 1
  s_mul_i32 s44, s2, 2428
  s_lshr_b32 s44, s44, 16
  s_mul_i32 s40, s44, 27
  s_sub_u32 s49, s2, s40
  v_lshrrev_b32 v25, 2, v2
  s_lshl_b32 s40, s44, 6
  v_add_u32 v25, s40, v25
  v_mul_u32_u24 v25, 6912, v25
  v_and_b32 v26, 3, v2
  v_lshl_add_u32 v25, v26, 4, v25
  v_add_u32 v39, s40, v2
  s_lshl_b32 s40, s49, 7
  s_lshl_b32 s50, s43, 6
  s_add_u32 s40, s40, s50
  v_add_u32 v216, s40, v25
  v_lshlrev_b32 v39, 1, v39
  s_lshl_b32 s40, s42, 8
  v_lshl_add_u32 v5, v2, 2, s40
  s_lshl_b32 s40, s42, 1
  v_mov_b32 v6, s40
  s_waitcnt lgkmcnt(0)
  global_load_dwordx4 v[10:13], v3, s[4:5] nt
  global_load_ushort v14, v4, s[4:5] offset:1024 nt
  s_mov_b32 s50, 110592
  v_add_u32 v217, s50, v216
  v_add_u32 v218, s50, v217
  v_add_u32 v219, s50, v218
  v_mov_b32 v7, 13631488
  v_lshrrev_b32 v246, 5, v2
  v_lshlrev_b32 v246, 15, v246
  v_and_b32 v247, 31, v2
  v_lshl_add_u32 v246, v247, 7, v246
  s_and_b32 s50, s2, 7
  s_lshl_b32 s50, s50, 12
  s_add_u32 s50, s50, 13172736
  v_add_u32 v246, s50, v246
  s_cmp_ge_u32 s3, 6
  s_cbranch_scc1 M_T0MOD
  s_barrier
  global_load_ushort v44, v6, s[14:15]
  global_load_dword v40, v5, s[6:7]
  global_load_dword v41, v5, s[8:9]
  global_load_dword v42, v5, s[10:11]
  global_load_dword v43, v5, s[12:13]
  s_mov_b32 s62, 5

  s_branch M_T0J
M_T0MOD:
  s_setprio 2
  s_barrier
  global_load_dword v247, v246, s[36:37] sc1
  global_load_dword v47, v7, s[36:37]
  s_mov_b32 s62, 2
  s_cmp_ge_u32 s2, 243
  s_cbranch_scc1 M_T0J
  global_load_ushort v44, v39, s[28:29]

  global_load_dwordx4 v[48:51], v216, s[30:31] nt
  global_load_dwordx4 v[52:55], v217, s[30:31] nt
  global_load_dwordx4 v[56:59], v218, s[30:31] nt
  global_load_dwordx4 v[60:63], v219, s[30:31] nt
  s_mov_b32 s62, 7
M_T0J:

  s_lshl_b32 s40, s3, 2
  s_lshr_b32 s63, 0xc8000040, s40
  s_and_b32 s63, s63, 15
  s_lshl_b32 s50, s63, 10
  s_lshl_b32 s51, s2, 14
  s_add_u32 s50, s50, s51
  s_add_u32 s50, s50, 1048576
  v_lshl_add_u32 v252, v2, 4, s50
  v_lshrrev_b32 v21, 4, v2
  s_lshl_b32 s50, s2, 1
  v_add_u32 v20, s50, v21
  v_mov_b32 v22, s45
  v_cmp_gt_u32 vcc, 2, v21
  v_and_b32 v23, 15, v2
  v_min_u32 v23, 8, v23
  v_cndmask_b32 v20, v22, v20, vcc
  v_lshlrev_b32 v23, 9, v23
  v_lshlrev_b32 v243, 1, v20
  v_lshrrev_b32 v22, 6, v20
  v_mul_u32_u24 v22, 4608, v22
  v_and_b32 v20, 63, v20
  v_lshl_add_u32 v20, v20, 3, v22
  v_add_u32 v20, v20, v23
  v_add_u32 v240, 524288, v20
  v_add_u32 v241, 565760, v20
  v_add_u32 v242, 607232, v20
  v_and_b32 v20, 15, v2
  v_and_b32 v22, 3, v20
  v_mul_u32_u24 v22, 4160, v22
  v_lshrrev_b32 v23, 2, v20
  v_lshlrev_b32 v23, 3, v23
  v_lshl_add_u32 v23, v21, 4, v23
  v_sub_u32 v22, v22, v23
  v_add_u32 v22, 86088, v22
  v_lshlrev_b32 v23, 5, v20
  v_lshlrev_b32 v24, 4, v21
  v_sub_u32 v24, v23, v24
  v_add_u32 v24, 55216, v24
  v_lshl_add_u32 v3, v21, 3, v23
  v_add_u32 v3, 55648, v3
  s_lshr_b32 s40, 0x01021100, s40
  s_and_b32 s40, s40, 15
  s_mul_i32 s50, s40, 16640
  s_cmp_eq_u32 s40, 2
  s_cselect_b32 s50, 4294919808, s50
  v_add_u32 v4, s50, v22
  v_add_u32 v5, 16640, v22
  s_mul_i32 s50, s40, 4608
  v_add_u32 v6, s50, v24
  v_add_u32 v7, 4608, v24
  s_mul_i32 s50, s40, 18432
  s_add_u32 s50, s50, 1536
  v_lshl_add_u32 v8, v2, 4, s50
  v_lshlrev_b32 v9, 4, v2
  v_add_u32 v9, 19968, v9
  s_lshl_b32 s40, s40, 2
  v_mov_b32 v1, s40

  s_mul_i32 s50, s3, 4352
  s_add_u32 s51, s50, 21120
  s_add_u32 s50, s50, 1536
  s_cmp_ge_u32 s3, 4
  s_cselect_b32 s50, s51, s50
  s_mov_b32 m0, s50
  v_mul_u32_u24 v210, 272, v20
  v_lshl_add_u32 v210, v21, 4, v210
  v_add_u32 v210, s50, v210
  s_mul_i32 s61, s3, 2816
  s_add_u32 s61, s61, 69120
  v_lshrrev_b32 v22, 1, v21
  v_lshlrev_b32 v211, 9, v22
  v_and_b32 v23, 1, v21
  v_lshl_add_u32 v211, v23, 4, v211
  v_lshl_add_u32 v211, v20, 5, v211
  v_add_u32 v211, s61, v211
  v_sub_u32 v23, 4, v22
  v_lshlrev_b32 v23, v23, v20
  v_lshl_add_u32 v23, v21, 8, v23
  v_add_u32 v23, s61, v23
  v_add_u32 v212, 1024, v23
  v_mul_u32_u24 v22, 120, v22
  v_add3_u32 v215, v212, v22, 8
  v_lshlrev_b32 v213, 8, v21
  v_lshl_add_u32 v213, v20, 2, v213
  v_add_u32 v213, s61, v213
  s_mul_i32 s60, s41, 5632
  s_add_u32 s60, s60, 69120
  v_mov_b32 v205, s60
  v_add_u32 v206, -4, v205
  v_add_u32 v207, -8, v205
  v_sub_u32 v22, 63, v2
  s_lshl_b32 s51, s43, 8
  s_sub_u32 s51, s60, s51
  s_add_u32 s51, s51, 2304
  v_lshl_add_u32 v200, v22, 2, s51
  v_add_u32 v201, 4, v200
  s_add_u32 s51, s60, 1536
  v_lshl_add_u32 v202, v22, 3, s51
  v_add_u32 v203, 4, v202
  v_add_u32 v204, 8, v202
  v_lshlrev_b32 v23, 5, v22
  v_lshlrev_b32 v22, 4, v22
  v_add_u32 v22, 512, v22
  v_min_u32 v22, v22, v23
  v_add_u32 v22, s60, v22
  s_cmp_eq_u32 s43, 0
  s_cselect_b64 vcc, -1, 0
  s_mul_i32 s51, s41, 16640
  s_add_u32 s51, s51, 86016
  s_cmp_eq_u32 s41, 2
  s_cselect_b32 s51, 38528, s51
  v_cndmask_b32 v202, v202, v22, vcc
  v_lshrrev_b32 v22, 1, v2
  v_mul_u32_u24 v22, 4160, v22
  v_and_b32 v23, 1, v2
  v_lshl_add_u32 v22, v23, 4, v22
  v_add_u32 v214, s51, v22
  v_lshl_add_u32 v208, v2, 4, s51
  s_lshl_b32 s51, s41, 2
  v_mov_b32 v209, s51
  s_lshl_b32 s48, s43, 4
  s_sub_u32 s48, 16, s48
  s_mov_b32 s52, 0x3fb8aa3b
  s_mov_b32 s53, 0x32a57060
  s_mov_b32 s54, 0x3f317218
  s_mov_b32 s55, 0x3e22f983
  s_mov_b32 s56, 0x31dc9c88
  s_mov_b32 s58, 0x3fa00000

  s_lshr_b32 s40, s3, 1
  s_mul_i32 s40, s40, 2592
  s_mul_i32 s50, s43, 1280
  s_add_u32 s40, s40, s50
  s_add_u32 s40, s40, 27136
  v_lshl_add_u32 v220, v2, 4, s40
  s_lshl_b32 s40, s3, 1
  s_add_u32 s40, s40, 37504
  v_lshl_add_u32 v221, v2, 4, s40
  v_lshrrev_b32 v22, 2, v2
  s_and_b32 s40, s3, 3
  s_lshl_b32 s40, s40, 6
  v_add_u32 v22, s40, v22
  v_and_b32 v23, 3, v2
  v_mul_u32_u24 v222, 2592, v23
  v_lshl_add_u32 v222, v22, 2, v222
  v_add_u32 v222, 27136, v222
  v_lshrrev_b32 v223, 2, v22
  v_lshlrev_b32 v223, 4, v223
  v_lshl_add_u32 v223, v23, 2, v223
  v_add_u32 v223, 37504, v223
  v_lshlrev_b32 v22, 14, v22
  v_lshl_add_u32 v22, v23, 4, v22
  s_lshl_b32 s40, s2, 6
  s_add_u32 s40, s40, 1048576
  v_add_u32 v253, s40, v22
  s_mul_i32 s40, s49, 9
  s_add_u32 s40, s40, s44
  s_lshl_b32 s40, s40, 9
  s_lshl_b32 s50, s43, 8
  s_add_u32 s40, s40, s50
  s_add_u32 s40, s40, 524288
  v_and_b32 v34, 3, v2
  v_lshlrev_b32 v34, 6, v34
  v_lshrrev_b32 v35, 3, v2
  v_lshl_add_u32 v34, v35, 3, v34
  v_add_u32 v34, s40, v34
  v_add_u32 v35, 124416, v34
  v_mov_b32 v15, 0x3ae38e39
  v_mov_b32 v30, 0x3f803f80
  v_mov_b32 v32, 0x3f80
  v_mov_b32 v33, 0x3f800000
  s_cmp_eq_u32 s62, 7
  s_cbranch_scc1 M_W6
  s_cmp_eq_u32 s62, 5
  s_cbranch_scc1 M_W5
  s_waitcnt vmcnt(2)
M_W5:
  s_waitcnt vmcnt(5)
M_W6:
  s_waitcnt vmcnt(7)

  v_dot2_f32_bf16 v26, v10, v30, 0
  v_dot2_f32_bf16 v28, v10, v10, 0
  v_dot2_f32_bf16 v26, v11, v30, v26
  v_dot2_f32_bf16 v28, v11, v11, v28
  v_dot2_f32_bf16 v26, v12, v30, v26
  v_dot2_f32_bf16 v28, v12, v12, v28
  v_dot2_f32_bf16 v26, v13, v30, v26
  v_dot2_f32_bf16 v28, v13, v13, v28
  v_dot2_f32_bf16 v26, v14, v30, v26
  v_dot2_f32_bf16 v28, v14, v14, v28
  s_nop 1
  v_add_f32 v26, v26, v26 row_shr:1 row_mask:0xf bank_mask:0xf bound_ctrl:0
  v_add_f32 v28, v28, v28 row_shr:1 row_mask:0xf bank_mask:0xf bound_ctrl:0
  s_nop 0
  v_add_f32 v26, v26, v26 row_shr:2 row_mask:0xf bank_mask:0xf bound_ctrl:0
  v_add_f32 v28, v28, v28 row_shr:2 row_mask:0xf bank_mask:0xf bound_ctrl:0
  s_nop 0
  v_add_f32 v26, v26, v26 row_shr:4 row_mask:0xf bank_mask:0xf bound_ctrl:0
  v_add_f32 v28, v28, v28 row_shr:4 row_mask:0xf bank_mask:0xf bound_ctrl:0
  s_nop 0
  v_add_f32 v26, v26, v26 row_shr:8 row_mask:0xf bank_mask:0xf bound_ctrl:0
  v_add_f32 v28, v28, v28 row_shr:8 row_mask:0xf bank_mask:0xf bound_ctrl:0
  s_nop 0
  v_add_f32 v26, v26, v26 row_bcast:15 row_mask:0xa bank_mask:0xf
  v_add_f32 v28, v28, v28 row_bcast:15 row_mask:0xa bank_mask:0xf
  s_nop 0
  v_add_f32 v26, v26, v26 row_bcast:31 row_mask:0xc bank_mask:0xf
  v_add_f32 v28, v28, v28 row_bcast:31 row_mask:0xc bank_mask:0xf
  s_nop 0
  v_readlane_b32 s66, v26, 63
  v_readlane_b32 s67, v28, 63
  s_nop 0
  v_mul_f32 v26, s66, v15
  v_mul_f32 v27, s67, v15
  v_mul_f32 v28, v26, v26
  v_fma_f32 v27, -v26, v26, v27
  v_mul_f32 v29, 0x41800000, v27
  v_cmp_gt_f32 vcc, v28, v29
  s_cbranch_vccz M_FAST
  v_sub_f32 v29, 0, v26

  v_dot2_f32_bf16 v24, v14, v32, v29
  v_dot2_f32_bf16 v16, v10, v32, v29
  v_dot2_f32_bf16 v17, v10, v33, v29
  v_dot2_f32_bf16 v18, v11, v32, v29
  v_dot2_f32_bf16 v19, v11, v33, v29
  v_dot2_f32_bf16 v20, v12, v32, v29
  v_dot2_f32_bf16 v21, v12, v33, v29
  v_dot2_f32_bf16 v22, v13, v32, v29
  v_dot2_f32_bf16 v23, v13, v33, v29
  v_mul_f32 v28, v24, v24
  v_fmac_f32 v28, v16, v16
  v_fmac_f32 v28, v17, v17
  v_fmac_f32 v28, v18, v18
  v_fmac_f32 v28, v19, v19
  v_fmac_f32 v28, v20, v20
  v_fmac_f32 v28, v21, v21
  v_fmac_f32 v28, v22, v22
  v_fmac_f32 v28, v23, v23
  s_nop 1
  v_add_f32 v28, v28, v28 row_shr:1 row_mask:0xf bank_mask:0xf bound_ctrl:0
  s_nop 1
  v_add_f32 v28, v28, v28 row_shr:2 row_mask:0xf bank_mask:0xf bound_ctrl:0
  s_nop 1
  v_add_f32 v28, v28, v28 row_shr:4 row_mask:0xf bank_mask:0xf bound_ctrl:0
  s_nop 1
  v_add_f32 v28, v28, v28 row_shr:8 row_mask:0xf bank_mask:0xf bound_ctrl:0
  s_nop 1
  v_add_f32 v28, v28, v28 row_bcast:15 row_mask:0xa bank_mask:0xf
  s_nop 1
  v_add_f32 v28, v28, v28 row_bcast:31 row_mask:0xc bank_mask:0xf
  s_nop 1
  v_readlane_b32 s67, v28, 63
  s_nop 1
  v_mul_f32 v27, s67, v15
M_FAST:
  v_cvt_pk_bf16_f32 v27, -v26, v27
  v_lshlrev_b32 v26, 16, v27
  v_and_b32 v27, 0xffff0000, v27
  v_add_f32 v27, 0x3727c5ac, v27
  v_cvt_pk_bf16_f32 v27, v27, v27
  v_lshlrev_b32 v27, 16, v27
  v_sqrt_f32 v27, v27

  v_dot2_f32_bf16 v24, v14, v32, v26
  v_dot2_f32_bf16 v16, v10, v32, v26
  v_dot2_f32_bf16 v17, v10, v33, v26
  v_dot2_f32_bf16 v18, v11, v32, v26
  v_dot2_f32_bf16 v19, v11, v33, v26
  v_dot2_f32_bf16 v20, v12, v32, v26
  v_dot2_f32_bf16 v21, v12, v33, v26
  v_dot2_f32_bf16 v22, v13, v32, v26
  v_dot2_f32_bf16 v23, v13, v33, v26
  v_cvt_pk_bf16_f32 v27, v27, v27
  v_lshlrev_b32 v27, 16, v27
  v_rcp_f32 v27, v27

  v_cvt_pk_bf16_f32 v24, v24, v24
  v_lshlrev_b32 v24, 16, v24
  v_cvt_pk_bf16_f32 v17, v16, v17
  v_cvt_pk_bf16_f32 v19, v18, v19
  v_cvt_pk_bf16_f32 v21, v20, v21
  v_cvt_pk_bf16_f32 v23, v22, v23
  v_lshlrev_b32 v16, 16, v17
  v_and_b32 v17, 0xffff0000, v17
  v_lshlrev_b32 v18, 16, v19
  v_and_b32 v19, 0xffff0000, v19
  v_lshlrev_b32 v20, 16, v21
  v_and_b32 v21, 0xffff0000, v21
  v_lshlrev_b32 v22, 16, v23
  v_and_b32 v23, 0xffff0000, v23
  v_mul_f32 v24, v24, v27
  v_pk_mul_f32 v[16:17], v[16:17], v[26:27] op_sel:[0,1] op_sel_hi:[1,1]
  v_pk_mul_f32 v[18:19], v[18:19], v[26:27] op_sel:[0,1] op_sel_hi:[1,1]
  v_pk_mul_f32 v[20:21], v[20:21], v[26:27] op_sel:[0,1] op_sel_hi:[1,1]
  v_pk_mul_f32 v[22:23], v[22:23], v[26:27] op_sel:[0,1] op_sel_hi:[1,1]
  v_cvt_pk_bf16_f32 v26, v16, v17
  v_cvt_pk_bf16_f32 v27, v18, v19
  v_cvt_pk_bf16_f32 v28, v20, v21
  v_cvt_pk_bf16_f32 v29, v22, v23
  v_cvt_pk_bf16_f32 v30, v24, 0
  ds_write_b128 v220, v[26:29]
  ds_write_b16 v221, v30
  s_cmp_lt_u32 s3, 6
  s_cbranch_scc1 M_NTAG
  s_cmp_eq_u32 s62, 7
  s_cbranch_scc1 M_TG5
  s_waitcnt vmcnt(0)
M_TG5:
  s_waitcnt vmcnt(5)
  s_mov_b32 s40, 0x9E3779B1
  v_mul_lo_u32 v33, v47, s40
  v_add_u32 v33, 0x7F4A7C15, v33
  ds_write_b32 v248, v33 offset:196
M_NTAG:

  s_mov_b64 exec, 1
  ds_add_u32 v248, v249 offset:192
  s_mov_b64 exec, -1
  s_cmp_lt_u32 s3, 4
  s_cbranch_scc1 M_KG
  s_cmp_lt_u32 s3, 6
  s_cbranch_scc1 M_PACK
  s_cmp_ge_u32 s2, 243
  s_cbranch_scc1 M_PACK
  s_mov_b32 s40, 0xbfb8aa3b
  s_waitcnt vmcnt(4)
  v_lshlrev_b32 v44, 16, v44
  v_mul_f32 v45, s40, v44
  v_exp_f32 v45, v45
  v_lshrrev_b32 v46, 2, v2
  v_add_f32 v45, 1.0, v45
  v_rcp_f32 v45, v45
  v_lshlrev_b32 v46, 2, v46
  v_mul_f32 v44, v44, v45
  v_cvt_pk_bf16_f32 v44, v44, 0

  ds_bpermute_b32 v28, v46, v44 offset:0
  ds_bpermute_b32 v29, v46, v44 offset:64
  ds_bpermute_b32 v30, v46, v44 offset:128
  ds_bpermute_b32 v31, v46, v44 offset:192
  s_waitcnt lgkmcnt(0)

  v_lshlrev_b32 v24, 16, v28
  v_lshlrev_b32 v25, 16, v29
  v_lshlrev_b32 v26, 16, v30
  v_lshlrev_b32 v27, 16, v31
  v_mov_b32 v112, 0
  v_mov_b32 v113, 0
  v_mov_b32 v114, 0
  v_mov_b32 v115, 0
  v_mov_b32 v116, 0
  v_mov_b32 v117, 0
  v_mov_b32 v118, 0
  v_mov_b32 v119, 0
  s_waitcnt vmcnt(3)
  v_dot2c_f32_bf16 v112, v48, v28
  v_dot2c_f32_bf16 v113, v48, v24
  v_dot2c_f32_bf16 v114, v49, v28
  v_dot2c_f32_bf16 v115, v49, v24
  v_dot2c_f32_bf16 v116, v50, v28
  v_dot2c_f32_bf16 v117, v50, v24
  v_dot2c_f32_bf16 v118, v51, v28
  v_dot2c_f32_bf16 v119, v51, v24
  s_waitcnt vmcnt(2)
  v_dot2c_f32_bf16 v112, v52, v29
  v_dot2c_f32_bf16 v113, v52, v25
  v_dot2c_f32_bf16 v114, v53, v29
  v_dot2c_f32_bf16 v115, v53, v25
  v_dot2c_f32_bf16 v116, v54, v29
  v_dot2c_f32_bf16 v117, v54, v25
  v_dot2c_f32_bf16 v118, v55, v29
  v_dot2c_f32_bf16 v119, v55, v25
  s_waitcnt vmcnt(1)
  v_dot2c_f32_bf16 v112, v56, v30
  v_dot2c_f32_bf16 v113, v56, v26
  v_dot2c_f32_bf16 v114, v57, v30
  v_dot2c_f32_bf16 v115, v57, v26
  v_dot2c_f32_bf16 v116, v58, v30
  v_dot2c_f32_bf16 v117, v58, v26
  v_dot2c_f32_bf16 v118, v59, v30
  v_dot2c_f32_bf16 v119, v59, v26
  s_waitcnt vmcnt(0)
  v_dot2c_f32_bf16 v112, v60, v31
  v_dot2c_f32_bf16 v113, v60, v27
  v_dot2c_f32_bf16 v114, v61, v31
  v_dot2c_f32_bf16 v115, v61, v27
  v_dot2c_f32_bf16 v116, v62, v31
  v_dot2c_f32_bf16 v117, v62, v27
  v_dot2c_f32_bf16 v118, v63, v31
  v_dot2c_f32_bf16 v119, v63, v27
  s_nop 2
  v_permlane32_swap_b32 v112, v116
  v_permlane32_swap_b32 v113, v117
  v_permlane32_swap_b32 v114, v118
  v_permlane32_swap_b32 v115, v119
  v_add_f32 v112, v112, v116
  v_add_f32 v113, v113, v117
  v_add_f32 v114, v114, v118
  v_add_f32 v115, v115, v119
  s_nop 0
  v_permlane16_swap_b32 v112, v114
  v_permlane16_swap_b32 v113, v115
  v_add_f32 v112, v112, v114
  v_add_f32 v113, v113, v115
  s_nop 1
  v_add_f32 v32, v112, v112 row_ror:8 row_mask:0xf bank_mask:0x3
  v_add_f32 v32, v113, v113 row_ror:8 row_mask:0xf bank_mask:0xc
  s_nop 1
  v_add_f32 v32, v32, v32 row_shl:4 row_mask:0xf bank_mask:0x5
  s_mov_b32 exec_lo, 0x0f0f0f0f
  s_mov_b32 exec_hi, 0x0f0f0f0f
  global_store_dwordx2 v34, v[32:33], s[36:37] sc1
  s_mov_b64 exec, -1
M_PACK:
  v_add_u32 v21, 64, v222
  v_add_u32 v22, 128, v222
  v_add_u32 v23, 192, v222
  s_mov_b32 s41, 262144
M_SPL:
  ds_read_b64 v[96:97], v248 offset:192

  ds_read2st64_b32 v[80:81], v222 offset0:0 offset1:5
  ds_read_b32 v82, v223 offset:0
  ds_read2st64_b32 v[84:85], v21 offset0:0 offset1:5
  ds_read_b32 v86, v223 offset:64
  ds_read2st64_b32 v[88:89], v22 offset0:0 offset1:5
  ds_read_b32 v90, v223 offset:128
  ds_read2st64_b32 v[92:93], v23 offset0:0 offset1:5
  ds_read_b32 v94, v223 offset:192
  s_waitcnt lgkmcnt(8)
  v_readfirstlane_b32 s94, v96
  v_readfirstlane_b32 s38, v97
  s_cmp_ge_u32 s94, 8
  s_cbranch_scc0 M_SPL

  v_mov_b32 v83, v97
  s_waitcnt lgkmcnt(6)
  global_store_dwordx4 v253, v[80:83], s[36:37] sc1
  v_add_u32 v253, s41, v253
  v_mov_b32 v87, v97
  s_waitcnt lgkmcnt(4)
  global_store_dwordx4 v253, v[84:87], s[36:37] sc1
  v_add_u32 v253, s41, v253
  v_mov_b32 v91, v97
  s_waitcnt lgkmcnt(2)
  global_store_dwordx4 v253, v[88:91], s[36:37] sc1
  v_add_u32 v253, s41, v253
  v_mov_b32 v95, v97
  s_waitcnt lgkmcnt(0)
  global_store_dwordx4 v253, v[92:95], s[36:37] sc1
  s_setprio 0
  s_cmp_ge_u32 s3, 6
  s_cbranch_scc1 M_MOD
  s_waitcnt vmcnt(4)

  s_mov_b64 exec, 1
  ds_add_u32 v248, v249 offset:240
  s_mov_b64 exec, -1
  s_branch KG_W1
M_KG:
  s_waitcnt vmcnt(0)
KG_W1:
  v_lshlrev_b32 v44, 16, v44
  v_lshlrev_b32 v40, s48, v40
  v_lshlrev_b32 v41, s48, v41
  v_mul_f32 v45, s52, v44
  v_fma_f32 v46, v44, s52, -v45
  v_fma_f32 v46, v44, s53, v46
  v_exp_f32 v45, v45
  v_mul_f32 v46, s54, v46
  v_fma_f32 v45, v45, v46, v45
  v_cvt_pk_bf16_f32 v45, v45, v45
  v_lshlrev_b32 v44, 16, v45
  v_and_b32 v40, 0xffff0000, v40
  v_and_b32 v41, 0xffff0000, v41
  v_mul_f32 v45, s52, v40
  v_fma_f32 v46, v40, s52, -v45
  v_fma_f32 v46, v40, s53, v46
  v_exp_f32 v45, v45
  v_mul_f32 v46, s54, v46
  v_fma_f32 v45, v45, v46, v45
  v_cvt_pk_bf16_f32 v45, v45, v45
  v_lshlrev_b32 v40, 16, v45
  v_mul_f32 v40, v40, v44
  v_mul_f32 v45, v41, v44
  v_mul_f32 v40, s52, v40
  v_sub_f32 v40, 0, v40
  v_mul_f32 v41, s55, v45
  v_fma_f32 v47, v45, s55, -v41
  v_fma_f32 v47, v45, s56, v47
  v_and_b32 v48, 0x7fff7fff, v42
  v_and_b32 v46, 0x7fff7fff, v43
  v_pk_max_u16 v48, v48, v46
  v_lshlrev_b32 v46, 16, v48
  v_max_u32 v48, v48, v46

  v_mov_b32 v56, 0x3c00
  ds_write_addtid_b32 v56 offset:0
  v_mul_f32 v64, 0x41000000, v40
  v_mul_f32 v65, 0x41000000, v41
  v_exp_f32 v64, v64
  v_fract_f32 v65, v65
  v_fmamk_f32 v65, v47, 0x41000000, v65
  v_cos_f32 v62, v65
  v_sin_f32 v63, v65
  s_nop 0
  v_pk_mul_f32 v[62:63], v[62:63], v[64:65] op_sel_hi:[1,0]
  v_cvt_pk_f16_f32 v57, v62, v63
  v_pk_mul_f32 v[64:65], v[62:63], v[62:63] op_sel_hi:[1,0]
  v_pk_fma_f32 v[64:65], v[62:63], v[62:63], v[64:65] op_sel:[1,1,0] op_sel_hi:[0,1,1] neg_lo:[1,0,0]
  v_cvt_pk_f16_f32 v58, v64, v65
  v_max_u32 v48, v48, v48 row_shr:1 row_mask:0xf bank_mask:0xf bound_ctrl:0
  v_pk_mul_f32 v[66:67], v[62:63], v[64:65] op_sel_hi:[1,0]
  v_pk_fma_f32 v[66:67], v[62:63], v[64:65], v[66:67] op_sel:[1,1,0] op_sel_hi:[0,1,1] neg_lo:[1,0,0]
  v_cvt_pk_f16_f32 v59, v66, v67
  ds_write_addtid_b32 v57 offset:272
  ds_write_addtid_b32 v58 offset:544
  v_max_u32 v48, v48, v48 row_shr:2 row_mask:0xf bank_mask:0xf bound_ctrl:0
  v_pk_mul_f32 v[68:69], v[64:65], v[64:65] op_sel_hi:[1,0]
  v_pk_fma_f32 v[68:69], v[64:65], v[64:65], v[68:69] op_sel:[1,1,0] op_sel_hi:[0,1,1] neg_lo:[1,0,0]
  v_cvt_pk_f16_f32 v60, v68, v69
  v_max_u32 v48, v48, v48 row_shr:4 row_mask:0xf bank_mask:0xf bound_ctrl:0
  v_pk_mul_f32 v[70:71], v[68:69], v[62:63] op_sel_hi:[1,0]
  v_pk_fma_f32 v[70:71], v[68:69], v[62:63], v[70:71] op_sel:[1,1,0] op_sel_hi:[0,1,1] neg_lo:[1,0,0]
  v_cvt_pk_f16_f32 v61, v70, v71
  ds_write_addtid_b32 v59 offset:816
  ds_write_addtid_b32 v60 offset:1088
  v_max_u32 v48, v48, v48 row_shr:8 row_mask:0xf bank_mask:0xf bound_ctrl:0
  v_pk_mul_f32 v[72:73], v[68:69], v[64:65] op_sel_hi:[1,0]
  v_pk_fma_f32 v[72:73], v[68:69], v[64:65], v[72:73] op_sel:[1,1,0] op_sel_hi:[0,1,1] neg_lo:[1,0,0]
  v_cvt_pk_f16_f32 v56, v72, v73
  v_max_u32 v48, v48, v48 row_bcast:15 row_mask:0xa bank_mask:0xf
  v_pk_mul_f32 v[74:75], v[68:69], v[66:67] op_sel_hi:[1,0]
  v_pk_fma_f32 v[74:75], v[68:69], v[66:67], v[74:75] op_sel:[1,1,0] op_sel_hi:[0,1,1] neg_lo:[1,0,0]
  v_cvt_pk_f16_f32 v57, v74, v75
  ds_write_addtid_b32 v61 offset:1360
  ds_write_addtid_b32 v56 offset:1632
  v_max_u32 v48, v48, v48 row_bcast:31 row_mask:0xc bank_mask:0xf
  v_pk_mul_f32 v[76:77], v[68:69], v[68:69] op_sel_hi:[1,0]
  v_pk_fma_f32 v[76:77], v[68:69], v[68:69], v[76:77] op_sel:[1,1,0] op_sel_hi:[0,1,1] neg_lo:[1,0,0]
  v_cvt_pk_f16_f32 v58, v76, v77
  v_readlane_b32 s57, v48, 63
  v_pk_mul_f32 v[78:79], v[76:77], v[62:63] op_sel_hi:[1,0]
  v_pk_fma_f32 v[78:79], v[76:77], v[62:63], v[78:79] op_sel:[1,1,0] op_sel_hi:[0,1,1] neg_lo:[1,0,0]
  v_cvt_pk_f16_f32 v59, v78, v79
  ds_write_addtid_b32 v57 offset:1904
  ds_write_addtid_b32 v58 offset:2176
  v_pk_mul_f32 v[78:79], v[76:77], v[64:65] op_sel_hi:[1,0]
  v_pk_fma_f32 v[78:79], v[76:77], v[64:65], v[78:79] op_sel:[1,1,0] op_sel_hi:[0,1,1] neg_lo:[1,0,0]
  v_cvt_pk_f16_f32 v60, v78, v79
  v_pk_mul_f32 v[78:79], v[76:77], v[66:67] op_sel_hi:[1,0]
  v_pk_fma_f32 v[78:79], v[76:77], v[66:67], v[78:79] op_sel:[1,1,0] op_sel_hi:[0,1,1] neg_lo:[1,0,0]
  v_cvt_pk_f16_f32 v61, v78, v79
  ds_write_addtid_b32 v59 offset:2448
  ds_write_addtid_b32 v60 offset:2720
  v_pk_mul_f32 v[78:79], v[76:77], v[68:69] op_sel_hi:[1,0]
  v_pk_fma_f32 v[78:79], v[76:77], v[68:69], v[78:79] op_sel:[1,1,0] op_sel_hi:[0,1,1] neg_lo:[1,0,0]
  v_cvt_pk_f16_f32 v56, v78, v79
  v_pk_mul_f32 v[78:79], v[76:77], v[70:71] op_sel_hi:[1,0]
  v_pk_fma_f32 v[78:79], v[76:77], v[70:71], v[78:79] op_sel:[1,1,0] op_sel_hi:[0,1,1] neg_lo:[1,0,0]
  v_cvt_pk_f16_f32 v57, v78, v79
  ds_write_addtid_b32 v61 offset:2992
  ds_write_addtid_b32 v56 offset:3264
  v_pk_mul_f32 v[78:79], v[76:77], v[72:73] op_sel_hi:[1,0]
  v_pk_fma_f32 v[78:79], v[76:77], v[72:73], v[78:79] op_sel:[1,1,0] op_sel_hi:[0,1,1] neg_lo:[1,0,0]
  v_cvt_pk_f16_f32 v58, v78, v79
  v_pk_mul_f32 v[78:79], v[76:77], v[74:75] op_sel_hi:[1,0]
  v_pk_fma_f32 v[78:79], v[76:77], v[74:75], v[78:79] op_sel:[1,1,0] op_sel_hi:[0,1,1] neg_lo:[1,0,0]
  v_cvt_pk_f16_f32 v59, v78, v79
  ds_write_addtid_b32 v57 offset:3536
  ds_write_addtid_b32 v58 offset:3808
  ds_write_addtid_b32 v59 offset:4080
  ds_read_b128 v[64:67], v210 offset:0
  ds_read_b128 v[68:71], v210 offset:64
  ds_read_b128 v[72:75], v210 offset:128
  ds_read_b128 v[76:79], v210 offset:192
  v_mul_f32 v80, 1.0, v40
  v_mul_f32 v81, 1.0, v41
  v_exp_f32 v80, v80
  v_fract_f32 v81, v81
  v_fmamk_f32 v81, v47, 0x3f800000, v81
  v_cos_f32 v62, v81
  v_sin_f32 v63, v81
  s_nop 0
  v_pk_mul_f32 v[62:63], v[62:63], v[80:81] op_sel_hi:[1,0]
  s_and_b32 s57, s57, 0xffff0000
  v_frexp_exp_i32_f32 v48, s57
  v_lshlrev_b32 v42, s48, v42
  v_lshlrev_b32 v43, s48, v43
  v_sub_u32 v48, 6, v48
  v_and_b32 v42, 0xffff0000, v42
  v_and_b32 v43, 0xffff0000, v43
  v_ldexp_f32 v45, s58, v48
  v_mul_f32 v44, 0x3f4ccccd, v44
  v_mul_f32 v42, v42, v45
  v_mul_f32 v43, v43, v45
  v_sub_u32 v48, 1, v48
  v_ldexp_f32 v44, v44, v48

  ds_write_b32 v209, v44 offset:80
  v_pk_mul_f32 v[80:81], v[62:63], v[62:63] op_sel_hi:[1,0]
  v_pk_fma_f32 v[80:81], v[62:63], v[62:63], v[80:81] op_sel:[1,1,0] op_sel_hi:[0,1,1] neg_lo:[1,0,0]
  v_pk_mul_f32 v[82:83], v[80:81], v[80:81] op_sel_hi:[1,0]
  v_pk_fma_f32 v[82:83], v[80:81], v[80:81], v[82:83] op_sel:[1,1,0] op_sel_hi:[0,1,1] neg_lo:[1,0,0]
  v_mul_f32 v86, 0x43000000, v40
  v_mul_f32 v87, 0x43000000, v41
  v_exp_f32 v86, v86
  v_fract_f32 v87, v87
  v_fmamk_f32 v87, v47, 0x43000000, v87
  v_cos_f32 v84, v87
  v_sin_f32 v85, v87
  s_nop 0
  v_pk_mul_f32 v[84:85], v[84:85], v[86:87] op_sel_hi:[1,0]
  v_cvt_pk_f16_f32 v60, v42, -v43
  v_pk_mul_f32 v[86:87], v[42:43], v[62:63] op_sel_hi:[1,0]
  v_pk_fma_f32 v[86:87], v[42:43], v[62:63], v[86:87] op_sel:[1,1,0] op_sel_hi:[0,1,1] neg_lo:[1,0,0]
  v_cvt_pk_f16_f32 v61, v86, -v87
  v_pk_mul_f32 v[116:117], v[42:43], v[80:81] op_sel_hi:[1,0]
  v_pk_fma_f32 v[116:117], v[42:43], v[80:81], v[116:117] op_sel:[1,1,0] op_sel_hi:[0,1,1] neg_lo:[1,0,0]
  v_cvt_pk_f16_f32 v56, v116, -v117
  ds_write_addtid_b32 v60 offset:0
  ds_write_addtid_b32 v61 offset:272
  v_pk_mul_f32 v[118:119], v[86:87], v[80:81] op_sel_hi:[1,0]
  v_pk_fma_f32 v[118:119], v[86:87], v[80:81], v[118:119] op_sel:[1,1,0] op_sel_hi:[0,1,1] neg_lo:[1,0,0]
  v_cvt_pk_f16_f32 v57, v118, -v119
  v_pk_mul_f32 v[120:121], v[42:43], v[82:83] op_sel_hi:[1,0]
  v_pk_fma_f32 v[120:121], v[42:43], v[82:83], v[120:121] op_sel:[1,1,0] op_sel_hi:[0,1,1] neg_lo:[1,0,0]
  v_cvt_pk_f16_f32 v58, v120, -v121
  ds_write_addtid_b32 v56 offset:544
  ds_write_addtid_b32 v57 offset:816
  v_pk_mul_f32 v[122:123], v[86:87], v[82:83] op_sel_hi:[1,0]
  v_pk_fma_f32 v[122:123], v[86:87], v[82:83], v[122:123] op_sel:[1,1,0] op_sel_hi:[0,1,1] neg_lo:[1,0,0]
  v_cvt_pk_f16_f32 v59, v122, -v123
  v_pk_mul_f32 v[124:125], v[116:117], v[82:83] op_sel_hi:[1,0]
  v_pk_fma_f32 v[124:125], v[116:117], v[82:83], v[124:125] op_sel:[1,1,0] op_sel_hi:[0,1,1] neg_lo:[1,0,0]
  v_cvt_pk_f16_f32 v60, v124, -v125
  ds_write_addtid_b32 v58 offset:1088
  ds_write_addtid_b32 v59 offset:1360
  v_pk_mul_f32 v[126:127], v[118:119], v[82:83] op_sel_hi:[1,0]
  v_pk_fma_f32 v[126:127], v[118:119], v[82:83], v[126:127] op_sel:[1,1,0] op_sel_hi:[0,1,1] neg_lo:[1,0,0]
  v_cvt_pk_f16_f32 v61, v126, -v127
  v_pk_mul_f32 v[62:63], v[42:43], v[84:85] op_sel_hi:[1,0]
  v_pk_fma_f32 v[62:63], v[42:43], v[84:85], v[62:63] op_sel:[1,1,0] op_sel_hi:[0,1,1] neg_lo:[1,0,0]
  v_cvt_pk_f16_f32 v56, v62, -v63
  ds_write_addtid_b32 v60 offset:1632
  ds_write_addtid_b32 v61 offset:1904
  v_pk_mul_f32 v[80:81], v[86:87], v[84:85] op_sel_hi:[1,0]
  v_pk_fma_f32 v[80:81], v[86:87], v[84:85], v[80:81] op_sel:[1,1,0] op_sel_hi:[0,1,1] neg_lo:[1,0,0]
  v_cvt_pk_f16_f32 v57, v80, -v81
  v_pk_mul_f32 v[80:81], v[116:117], v[84:85] op_sel_hi:[1,0]
  v_pk_fma_f32 v[80:81], v[116:117], v[84:85], v[80:81] op_sel:[1,1,0] op_sel_hi:[0,1,1] neg_lo:[1,0,0]
  v_cvt_pk_f16_f32 v58, v80, -v81
  ds_write_addtid_b32 v56 offset:2176
  ds_write_addtid_b32 v57 offset:2448
  v_pk_mul_f32 v[82:83], v[118:119], v[84:85] op_sel_hi:[1,0]
  v_pk_fma_f32 v[82:83], v[118:119], v[84:85], v[82:83] op_sel:[1,1,0] op_sel_hi:[0,1,1] neg_lo:[1,0,0]
  v_cvt_pk_f16_f32 v59, v82, -v83
  v_pk_mul_f32 v[82:83], v[120:121], v[84:85] op_sel_hi:[1,0]
  v_pk_fma_f32 v[82:83], v[120:121], v[84:85], v[82:83] op_sel:[1,1,0] op_sel_hi:[0,1,1] neg_lo:[1,0,0]
  v_cvt_pk_f16_f32 v60, v82, -v83
  ds_write_addtid_b32 v58 offset:2720
  ds_write_addtid_b32 v59 offset:2992
  v_pk_mul_f32 v[86:87], v[122:123], v[84:85] op_sel_hi:[1,0]
  v_pk_fma_f32 v[86:87], v[122:123], v[84:85], v[86:87] op_sel:[1,1,0] op_sel_hi:[0,1,1] neg_lo:[1,0,0]
  v_cvt_pk_f16_f32 v61, v86, -v87
  v_pk_mul_f32 v[86:87], v[124:125], v[84:85] op_sel_hi:[1,0]
  v_pk_fma_f32 v[86:87], v[124:125], v[84:85], v[86:87] op_sel:[1,1,0] op_sel_hi:[0,1,1] neg_lo:[1,0,0]
  v_cvt_pk_f16_f32 v56, v86, -v87
  ds_write_addtid_b32 v60 offset:3264
  ds_write_addtid_b32 v61 offset:3536
  v_pk_mul_f32 v[118:119], v[126:127], v[84:85] op_sel_hi:[1,0]
  v_pk_fma_f32 v[118:119], v[126:127], v[84:85], v[118:119] op_sel:[1,1,0] op_sel_hi:[0,1,1] neg_lo:[1,0,0]
  v_cvt_pk_f16_f32 v57, v118, -v119
  v_pk_mul_f32 v[118:119], v[84:85], v[84:85] op_sel_hi:[1,0]
  v_pk_fma_f32 v[118:119], v[84:85], v[84:85], v[118:119] op_sel:[1,1,0] op_sel_hi:[0,1,1] neg_lo:[1,0,0]
  ds_write_addtid_b32 v56 offset:3808
  ds_write_addtid_b32 v57 offset:4080
  ds_read_b128 v[100:103], v210 offset:0
  ds_read_b128 v[104:107], v210 offset:64
  ds_read_b128 v[108:111], v210 offset:128
  ds_read_b128 v[112:115], v210 offset:192
  v_pk_mul_f32 v[84:85], v[118:119], v[118:119] op_sel_hi:[1,0]
  v_pk_fma_f32 v[84:85], v[118:119], v[118:119], v[84:85] op_sel:[1,1,0] op_sel_hi:[0,1,1] neg_lo:[1,0,0]
  v_pk_mul_f32 v[122:123], v[42:43], v[118:119] op_sel_hi:[1,0]
  v_pk_fma_f32 v[122:123], v[42:43], v[118:119], v[122:123] op_sel:[1,1,0] op_sel_hi:[0,1,1] neg_lo:[1,0,0]
  v_cvt_pk_f16_f32 v58, v122, -v123
  v_pk_mul_f32 v[126:127], v[116:117], v[118:119] op_sel_hi:[1,0]
  v_pk_fma_f32 v[126:127], v[116:117], v[118:119], v[126:127] op_sel:[1,1,0] op_sel_hi:[0,1,1] neg_lo:[1,0,0]
  v_cvt_pk_f16_f32 v59, v126, -v127
  v_pk_mul_f32 v[116:117], v[120:121], v[118:119] op_sel_hi:[1,0]
  v_pk_fma_f32 v[116:117], v[120:121], v[118:119], v[116:117] op_sel:[1,1,0] op_sel_hi:[0,1,1] neg_lo:[1,0,0]
  v_cvt_pk_f16_f32 v60, v116, -v117
  ds_write_addtid_b32 v58 offset:0
  ds_write_addtid_b32 v59 offset:272
  v_pk_mul_f32 v[126:127], v[124:125], v[118:119] op_sel_hi:[1,0]
  v_pk_fma_f32 v[126:127], v[124:125], v[118:119], v[126:127] op_sel:[1,1,0] op_sel_hi:[0,1,1] neg_lo:[1,0,0]
  s_waitcnt lgkmcnt(5)
  v_mfma_f32_16x16x32_f16 v[88:91], v[100:103], v[64:67], 0
  v_cvt_pk_f16_f32 v61, v126, -v127
  v_pk_mul_f32 v[124:125], v[62:63], v[118:119] op_sel_hi:[1,0]
  v_pk_fma_f32 v[124:125], v[62:63], v[118:119], v[124:125] op_sel:[1,1,0] op_sel_hi:[0,1,1] neg_lo:[1,0,0]
  s_waitcnt lgkmcnt(4)
  v_mfma_f32_16x16x32_f16 v[88:91], v[104:107], v[68:71], v[88:91]
  v_cvt_pk_f16_f32 v56, v124, -v125
  ds_write_addtid_b32 v60 offset:544
  ds_write_addtid_b32 v61 offset:816
  v_pk_mul_f32 v[126:127], v[80:81], v[118:119] op_sel_hi:[1,0]
  v_pk_fma_f32 v[126:127], v[80:81], v[118:119], v[126:127] op_sel:[1,1,0] op_sel_hi:[0,1,1] neg_lo:[1,0,0]
  s_waitcnt lgkmcnt(5)
  v_mfma_f32_16x16x32_f16 v[88:91], v[108:111], v[72:75], v[88:91]
  v_cvt_pk_f16_f32 v57, v126, -v127
  v_pk_mul_f32 v[80:81], v[82:83], v[118:119] op_sel_hi:[1,0]
  v_pk_fma_f32 v[80:81], v[82:83], v[118:119], v[80:81] op_sel:[1,1,0] op_sel_hi:[0,1,1] neg_lo:[1,0,0]
  s_waitcnt lgkmcnt(4)
  v_mfma_f32_16x16x32_f16 v[88:91], v[112:115], v[76:79], v[88:91]
  v_cvt_pk_f16_f32 v58, v80, -v81
  ds_write_addtid_b32 v56 offset:1088
  ds_write_addtid_b32 v57 offset:1360
  v_pk_mul_f32 v[126:127], v[86:87], v[118:119] op_sel_hi:[1,0]
  v_pk_fma_f32 v[126:127], v[86:87], v[118:119], v[126:127] op_sel:[1,1,0] op_sel_hi:[0,1,1] neg_lo:[1,0,0]
  v_cvt_pk_f16_f32 v59, v126, -v127
  v_pk_mul_f32 v[86:87], v[42:43], v[84:85] op_sel_hi:[1,0]
  v_pk_fma_f32 v[86:87], v[42:43], v[84:85], v[86:87] op_sel:[1,1,0] op_sel_hi:[0,1,1] neg_lo:[1,0,0]
  v_cvt_pk_f16_f32 v60, v86, -v87
  ds_write_addtid_b32 v58 offset:1632
  ds_write_addtid_b32 v59 offset:1904
  v_pk_mul_f32 v[118:119], v[120:121], v[84:85] op_sel_hi:[1,0]
  v_pk_fma_f32 v[118:119], v[120:121], v[84:85], v[118:119] op_sel:[1,1,0] op_sel_hi:[0,1,1] neg_lo:[1,0,0]
  v_cvt_pk_f16_f32 v61, v118, -v119
  v_pk_mul_f32 v[118:119], v[62:63], v[84:85] op_sel_hi:[1,0]
  v_pk_fma_f32 v[118:119], v[62:63], v[84:85], v[118:119] op_sel:[1,1,0] op_sel_hi:[0,1,1] neg_lo:[1,0,0]
  ds_write_b128 v211, v[88:91]
  v_cvt_pk_f16_f32 v56, v118, -v119
  ds_write_addtid_b32 v60 offset:2176
  ds_write_addtid_b32 v61 offset:2448
  v_pk_mul_f32 v[120:121], v[82:83], v[84:85] op_sel_hi:[1,0]
  v_pk_fma_f32 v[120:121], v[82:83], v[84:85], v[120:121] op_sel:[1,1,0] op_sel_hi:[0,1,1] neg_lo:[1,0,0]
  v_cvt_pk_f16_f32 v57, v120, -v121
  v_pk_mul_f32 v[82:83], v[122:123], v[84:85] op_sel_hi:[1,0]
  v_pk_fma_f32 v[82:83], v[122:123], v[84:85], v[82:83] op_sel:[1,1,0] op_sel_hi:[0,1,1] neg_lo:[1,0,0]
  v_cvt_pk_f16_f32 v58, v82, -v83
  ds_write_addtid_b32 v56 offset:2720
  ds_write_addtid_b32 v57 offset:2992
  v_pk_mul_f32 v[120:121], v[116:117], v[84:85] op_sel_hi:[1,0]
  v_pk_fma_f32 v[120:121], v[116:117], v[84:85], v[120:121] op_sel:[1,1,0] op_sel_hi:[0,1,1] neg_lo:[1,0,0]
  v_cvt_pk_f16_f32 v59, v120, -v121
  v_pk_mul_f32 v[116:117], v[124:125], v[84:85] op_sel_hi:[1,0]
  v_pk_fma_f32 v[116:117], v[124:125], v[84:85], v[116:117] op_sel:[1,1,0] op_sel_hi:[0,1,1] neg_lo:[1,0,0]
  v_cvt_pk_f16_f32 v60, v116, -v117
  ds_write_addtid_b32 v58 offset:3264
  ds_write_addtid_b32 v59 offset:3536
  v_pk_mul_f32 v[120:121], v[80:81], v[84:85] op_sel_hi:[1,0]
  v_pk_fma_f32 v[120:121], v[80:81], v[84:85], v[120:121] op_sel:[1,1,0] op_sel_hi:[0,1,1] neg_lo:[1,0,0]
  v_cvt_pk_f16_f32 v61, v120, -v121
  ds_write_addtid_b32 v60 offset:3808
  ds_write_addtid_b32 v61 offset:4080
  ds_read_b128 v[100:103], v210 offset:0
  ds_read_b128 v[104:107], v210 offset:64
  ds_read_b128 v[108:111], v210 offset:128
  ds_read_b128 v[112:115], v210 offset:192
  v_mul_f32 v84, 0x44800000, v40
  v_mul_f32 v85, 0x44800000, v41
  v_exp_f32 v84, v84
  v_fract_f32 v85, v85
  v_fmamk_f32 v85, v47, 0x44800000, v85
  v_cos_f32 v80, v85
  v_sin_f32 v81, v85
  s_nop 0
  v_pk_mul_f32 v[80:81], v[80:81], v[84:85] op_sel_hi:[1,0]
  v_pk_mul_f32 v[84:85], v[42:43], v[80:81] op_sel_hi:[1,0]
  v_pk_fma_f32 v[84:85], v[42:43], v[80:81], v[84:85] op_sel:[1,1,0] op_sel_hi:[0,1,1] neg_lo:[1,0,0]
  v_cvt_pk_f16_f32 v56, v84, -v85
  v_pk_mul_f32 v[84:85], v[62:63], v[80:81] op_sel_hi:[1,0]
  v_pk_fma_f32 v[84:85], v[62:63], v[80:81], v[84:85] op_sel:[1,1,0] op_sel_hi:[0,1,1] neg_lo:[1,0,0]
  v_cvt_pk_f16_f32 v57, v84, -v85
  v_pk_mul_f32 v[84:85], v[122:123], v[80:81] op_sel_hi:[1,0]
  v_pk_fma_f32 v[84:85], v[122:123], v[80:81], v[84:85] op_sel:[1,1,0] op_sel_hi:[0,1,1] neg_lo:[1,0,0]
  v_cvt_pk_f16_f32 v58, v84, -v85
  ds_write_addtid_b32 v56 offset:0
  ds_write_addtid_b32 v57 offset:272
  v_pk_mul_f32 v[84:85], v[124:125], v[80:81] op_sel_hi:[1,0]
  v_pk_fma_f32 v[84:85], v[124:125], v[80:81], v[84:85] op_sel:[1,1,0] op_sel_hi:[0,1,1] neg_lo:[1,0,0]
  s_waitcnt lgkmcnt(5)
  v_mfma_f32_16x16x32_f16 v[92:95], v[100:103], v[64:67], 0
  v_cvt_pk_f16_f32 v59, v84, -v85
  v_pk_mul_f32 v[84:85], v[86:87], v[80:81] op_sel_hi:[1,0]
  v_pk_fma_f32 v[84:85], v[86:87], v[80:81], v[84:85] op_sel:[1,1,0] op_sel_hi:[0,1,1] neg_lo:[1,0,0]
  s_waitcnt lgkmcnt(4)
  v_mfma_f32_16x16x32_f16 v[92:95], v[104:107], v[68:71], v[92:95]
  v_cvt_pk_f16_f32 v60, v84, -v85
  ds_write_addtid_b32 v58 offset:544
  ds_write_addtid_b32 v59 offset:816
  v_pk_mul_f32 v[84:85], v[118:119], v[80:81] op_sel_hi:[1,0]
  v_pk_fma_f32 v[84:85], v[118:119], v[80:81], v[84:85] op_sel:[1,1,0] op_sel_hi:[0,1,1] neg_lo:[1,0,0]
  s_waitcnt lgkmcnt(5)
  v_mfma_f32_16x16x32_f16 v[92:95], v[108:111], v[72:75], v[92:95]
  v_cvt_pk_f16_f32 v61, v84, -v85
  v_pk_mul_f32 v[84:85], v[82:83], v[80:81] op_sel_hi:[1,0]
  v_pk_fma_f32 v[84:85], v[82:83], v[80:81], v[84:85] op_sel:[1,1,0] op_sel_hi:[0,1,1] neg_lo:[1,0,0]
  s_waitcnt lgkmcnt(4)
  v_mfma_f32_16x16x32_f16 v[92:95], v[112:115], v[76:79], v[92:95]
  v_cvt_pk_f16_f32 v56, v84, -v85
  ds_write_addtid_b32 v60 offset:1088
  ds_write_addtid_b32 v61 offset:1360
  v_pk_mul_f32 v[84:85], v[116:117], v[80:81] op_sel_hi:[1,0]
  v_pk_fma_f32 v[84:85], v[116:117], v[80:81], v[84:85] op_sel:[1,1,0] op_sel_hi:[0,1,1] neg_lo:[1,0,0]
  v_cvt_pk_f16_f32 v57, v84, -v85
  v_pk_mul_f32 v[84:85], v[80:81], v[80:81] op_sel_hi:[1,0]
  v_pk_fma_f32 v[84:85], v[80:81], v[80:81], v[84:85] op_sel:[1,1,0] op_sel_hi:[0,1,1] neg_lo:[1,0,0]
  v_pk_mul_f32 v[120:121], v[42:43], v[84:85] op_sel_hi:[1,0]
  v_pk_fma_f32 v[120:121], v[42:43], v[84:85], v[120:121] op_sel:[1,1,0] op_sel_hi:[0,1,1] neg_lo:[1,0,0]
  v_cvt_pk_f16_f32 v58, v120, -v121
  ds_write_addtid_b32 v56 offset:1632
  ds_write_addtid_b32 v57 offset:1904
  ds_write_addtid_b32 v58 offset:2176
  ds_read_b128 v[100:103], v210 offset:0
  ds_read_b128 v[104:107], v210 offset:64
  ds_read_b128 v[108:111], v210 offset:128
  ds_read_b128 v[112:115], v210 offset:192
  ds_write_b64 v212, v[92:93]
  ds_write_b64 v215, v[94:95]
  s_waitcnt lgkmcnt(5)
  v_mfma_f32_16x16x32_f16 v[96:99], v[100:103], v[64:67], 0
  s_waitcnt lgkmcnt(4)
  v_mfma_f32_16x16x32_f16 v[96:99], v[104:107], v[68:71], v[96:99]
  s_waitcnt lgkmcnt(3)
  v_mfma_f32_16x16x32_f16 v[96:99], v[108:111], v[72:75], v[96:99]
  s_waitcnt lgkmcnt(2)
  v_mfma_f32_16x16x32_f16 v[96:99], v[112:115], v[76:79], v[96:99]
  s_mov_b32 exec_hi, 0xffff
  s_nop 6
  ds_write_b32 v213, v96 offset:2048
  s_mov_b32 exec_hi, 0
  ds_write_b32 v213, v97 offset:2112
  ds_write_b32 v213, v98 offset:2176
  ds_write_b32 v213, v99 offset:2240

  s_mov_b64 exec, 1
  ds_add_u32 v209, v249 offset:208
  s_mov_b64 exec, -1
SP_2:
  ds_read_b32 v251, v209 offset:208
  s_waitcnt lgkmcnt(0)
  v_readfirstlane_b32 s94, v251
  s_cmp_ge_u32 s94, 2
  s_cbranch_scc0 SP_2

  s_cmp_eq_u32 s43, 0
  s_cbranch_scc0 M_EXB

  ds_read2st64_b32 v[56:57], v200 offset0:0 offset1:11
  ds_read2st64_b32 v[58:59], v201 offset0:0 offset1:11
  ds_read2st64_b32 v[60:61], v205 offset0:9 offset1:20
  ds_read_b128 v[64:67], v202 offset:0
  ds_read_b128 v[72:75], v202 offset:2816
  ds_read_b128 v[68:71], v202 offset:16
  ds_read_b128 v[76:79], v202 offset:2832
  s_mov_b32 vcc_lo, 0x55555555
  s_mov_b32 vcc_hi, 0x55555555
  s_waitcnt lgkmcnt(4)
  v_add_f32 v56, v56, v57
  v_add_f32 v58, v58, v59
  v_add_f32 v60, v60, v61

  v_cndmask_b32 v57, v56, v58, vcc
  v_cvt_pk_f16_f32 v80, v58, v58
  v_cvt_pk_f16_f32 v82, v56, v56
  v_cvt_pk_f16_f32 v81, v58, v57
  v_cvt_pk_f16_f32 v84, v60, v60
  v_mov_b32 v83, v82
  v_cvt_pk_f16_f32 v85, v60, v60

  ds_write_b128 v208, v[80:83] offset:12480
  v_mov_b32 v84, v80 wave_shl:1 row_mask:0xf bank_mask:0xf
  v_mov_b32 v85, v81 wave_shl:1 row_mask:0xf bank_mask:0xf
  v_alignbit_b32 v88, v81, v80, 16
  v_alignbit_b32 v89, v82, v81, 16
  v_alignbit_b32 v90, v83, v82, 16
  v_alignbit_b32 v91, v84, v83, 16
  v_mov_b32 v92, v81
  v_mov_b32 v93, v82
  ds_write_b128 v208, v[88:91] offset:8320
  v_mov_b32 v94, v83
  v_mov_b32 v95, v84
  v_mov_b32 v96, v89
  v_mov_b32 v97, v90
  ds_write_b128 v208, v[92:95] offset:4160
  v_mov_b32 v98, v91
  v_alignbit_b32 v99, v85, v84, 16
  ds_write_b128 v208, v[96:99] offset:0

  s_waitcnt lgkmcnt(4)
  v_add_f32 v64, v64, v72
  v_add_f32 v65, v65, v73
  v_add_f32 v66, v66, v74
  v_add_f32 v67, v67, v75
  v_add_f32 v68, v68, v76
  v_add_f32 v69, v69, v77
  v_add_f32 v70, v70, v78
  v_add_f32 v71, v71, v79
  v_cvt_pk_f16_f32 v100, v71, v70
  v_cvt_pk_f16_f32 v101, v69, v68
  v_cvt_pk_f16_f32 v102, v67, v66
  v_cvt_pk_f16_f32 v103, v65, v64
  v_mov_b32 v104, 0
  v_mov_b32 v105, 0
  s_mov_b32 exec_hi, 0
  v_cvt_pk_f16_f32 v100, v68, v67
  v_cvt_pk_f16_f32 v101, v66, v66
  v_cvt_pk_f16_f32 v102, v66, v65
  v_cvt_pk_f16_f32 v103, v64, v64
  s_mov_b64 exec, -1

  ds_write_b128 v208, v[100:103] offset:15552
  v_mov_b32 v104, v100 wave_shl:1 row_mask:0xf bank_mask:0xf
  v_mov_b32 v105, v101 wave_shl:1 row_mask:0xf bank_mask:0xf
  v_alignbit_b32 v108, v101, v100, 16
  v_alignbit_b32 v109, v102, v101, 16
  v_alignbit_b32 v110, v103, v102, 16
  v_alignbit_b32 v111, v104, v103, 16
  v_mov_b32 v112, v101
  v_mov_b32 v113, v102
  ds_write_b128 v208, v[108:111] offset:11392
  v_mov_b32 v114, v103
  v_mov_b32 v115, v104
  v_mov_b32 v116, v109
  v_mov_b32 v117, v110
  ds_write_b128 v208, v[112:115] offset:7232
  v_mov_b32 v118, v111
  v_alignbit_b32 v119, v105, v104, 16
  ds_write_b128 v208, v[116:119] offset:3072

  v_mov_b32 v104, 0
  v_mov_b32 v105, 0
  v_mov_b32 v106, 0
  v_mov_b32 v107, 0
  s_mov_b64 exec, 0xff
  ds_write_b128 v214, v[104:107] offset:4096

  s_branch M_EXD
M_EXB:
  ds_read2st64_b32 v[56:57], v200 offset0:0 offset1:11
  ds_read2st64_b32 v[58:59], v201 offset0:0 offset1:11
  ds_read2st64_b32 v[60:61], v205 offset0:8 offset1:19
  ds_read2st64_b32 v[62:63], v206 offset0:8 offset1:19
  ds_read2st64_b32 v[64:65], v202 offset0:0 offset1:11
  ds_read2st64_b32 v[66:67], v203 offset0:0 offset1:11
  ds_read2st64_b32 v[68:69], v204 offset0:0 offset1:11
  ds_read2st64_b32 v[70:71], v205 offset0:6 offset1:17
  ds_read2st64_b32 v[72:73], v206 offset0:6 offset1:17
  ds_read2st64_b32 v[74:75], v207 offset0:6 offset1:17
  s_mov_b32 vcc_lo, 0x55555555
  s_mov_b32 vcc_hi, 0x55555555
  s_waitcnt lgkmcnt(6)
  v_add_f32 v56, v56, v57
  v_add_f32 v58, v58, v59
  v_add_f32 v60, v60, v61

  v_add_f32 v62, v62, v63
  v_cndmask_b32 v57, v56, v58, vcc
  v_cvt_pk_f16_f32 v80, v58, v58
  v_cvt_pk_f16_f32 v82, v56, v56
  v_cvt_pk_f16_f32 v81, v58, v57
  v_cvt_pk_f16_f32 v84, v60, v60
  v_mov_b32 v83, v82
  v_cvt_pk_f16_f32 v85, v62, v62

  ds_write_b128 v208, v[80:83] offset:13504
  v_mov_b32 v84, v80 wave_shl:1 row_mask:0xf bank_mask:0xf
  v_mov_b32 v85, v81 wave_shl:1 row_mask:0xf bank_mask:0xf
  v_alignbit_b32 v88, v81, v80, 16
  v_alignbit_b32 v89, v82, v81, 16
  v_alignbit_b32 v90, v83, v82, 16
  v_alignbit_b32 v91, v84, v83, 16
  v_mov_b32 v92, v81
  v_mov_b32 v93, v82
  ds_write_b128 v208, v[88:91] offset:9344
  v_mov_b32 v94, v83
  v_mov_b32 v95, v84
  v_mov_b32 v96, v89
  v_mov_b32 v97, v90
  ds_write_b128 v208, v[92:95] offset:5184
  v_mov_b32 v98, v91
  v_alignbit_b32 v99, v85, v84, 16
  ds_write_b128 v208, v[96:99] offset:1024

  s_waitcnt lgkmcnt(4)
  v_add_f32 v64, v64, v65
  v_add_f32 v66, v66, v67
  v_add_f32 v68, v68, v69
  v_add_f32 v70, v70, v71
  v_add_f32 v72, v72, v73
  v_add_f32 v74, v74, v75
  v_cvt_pk_f16_f32 v100, v68, v68
  v_cvt_pk_f16_f32 v101, v66, v66
  v_cvt_pk_f16_f32 v102, v66, v64
  v_cvt_pk_f16_f32 v103, v64, v64
  v_cvt_pk_f16_f32 v104, v70, v72
  v_cvt_pk_f16_f32 v105, v74, v74

  ds_write_b128 v208, v[100:103] offset:14528
  v_mov_b32 v104, v100 wave_shl:1 row_mask:0xf bank_mask:0xf
  v_mov_b32 v105, v101 wave_shl:1 row_mask:0xf bank_mask:0xf
  v_alignbit_b32 v108, v101, v100, 16
  v_alignbit_b32 v109, v102, v101, 16
  v_alignbit_b32 v110, v103, v102, 16
  v_alignbit_b32 v111, v104, v103, 16
  v_mov_b32 v112, v101
  v_mov_b32 v113, v102
  ds_write_b128 v208, v[108:111] offset:10368
  v_mov_b32 v114, v103
  v_mov_b32 v115, v104
  v_mov_b32 v116, v109
  v_mov_b32 v117, v110
  ds_write_b128 v208, v[112:115] offset:6208
  v_mov_b32 v118, v111
  v_alignbit_b32 v119, v105, v104, 16
  ds_write_b128 v208, v[116:119] offset:2048

M_EXD:
  s_mov_b64 exec, 1
  ds_add_u32 v209, v249 offset:224
  s_mov_b64 exec, -1
  s_cmp_ge_u32 s3, 2
  s_cbranch_scc1 NI_3
  global_load_dwordx4 v[224:227], v252, s[36:37] offset:0 sc1
  global_load_dwordx4 v[228:231], v252, s[36:37] offset:1024 sc1
  global_load_dwordx4 v[232:235], v252, s[36:37] offset:2048 sc1
  global_load_dwordx4 v[236:239], v252, s[36:37] offset:3072 sc1
NI_3:
  s_mov_b32 s73, 0
  s_branch M_CSET
M_MOD:
  s_cmp_ge_u32 s2, 243
  s_cbranch_scc1 M_MODX

  global_load_dwordx4 v[64:67], v216, s[30:31] offset:3456 nt
  global_load_dwordx4 v[68:71], v217, s[30:31] offset:3456 nt
  global_load_dwordx4 v[72:75], v218, s[30:31] offset:3456 nt
  global_load_dwordx4 v[76:79], v219, s[30:31] offset:3456 nt
M_MODX:
  v_add_u32 v250, 8, v247
  v_mov_b32 v253, v246
  s_setprio 0
  s_cmp_lg_u32 s3, 6
  s_cbranch_scc1 M_W7X

SP_4:
  ds_read_b32 v251, v248 offset:208
  s_waitcnt lgkmcnt(0)
  v_readfirstlane_b32 s94, v251
  s_cmp_ge_u32 s94, 1
  s_cbranch_scc0 SP_4

  global_load_ushort v243, v243, s[16:17]
  global_load_dwordx2 v[100:101], v240, s[36:37] sc1
  global_load_dwordx2 v[102:103], v241, s[36:37] sc1
  global_load_dwordx2 v[104:105], v242, s[36:37] sc1
  s_mov_b32 s41, 65536
M_MP:
  s_waitcnt vmcnt(0)
  v_xor_b32 v16, s38, v101
  v_xor_b32 v17, s38, v103
  v_xor_b32 v18, s38, v105
  v_or3_b32 v16, v16, v17, v18
  v_cmp_ne_u32 vcc, 0, v16
  s_cbranch_vccz M_MPD

  global_load_dwordx2 v[100:101], v240, s[36:37] sc1
  global_load_dwordx2 v[102:103], v241, s[36:37] sc1
  global_load_dwordx2 v[104:105], v242, s[36:37] sc1
  s_waitcnt vmcnt(0)
  s_sub_u32 s41, s41, 1
  s_cbranch_scc0 M_MP
M_MPD:
  s_mov_b32 exec_lo, 0xfe00fe00
  s_mov_b32 exec_hi, 0xfe00fe00
  v_mov_b32 v100, 0
  v_mov_b32 v102, 0
  v_mov_b32 v104, 0
  s_mov_b64 exec, -1

  v_add_f32 v100, v100, v100 row_shr:1 row_mask:0xf bank_mask:0xf bound_ctrl:0
  v_add_f32 v102, v102, v102 row_shr:1 row_mask:0xf bank_mask:0xf bound_ctrl:0
  v_add_f32 v104, v104, v104 row_shr:1 row_mask:0xf bank_mask:0xf bound_ctrl:0
  v_add_f32 v100, v100, v100 row_shr:2 row_mask:0xf bank_mask:0xf bound_ctrl:0
  v_add_f32 v102, v102, v102 row_shr:2 row_mask:0xf bank_mask:0xf bound_ctrl:0
  v_add_f32 v104, v104, v104 row_shr:2 row_mask:0xf bank_mask:0xf bound_ctrl:0
  v_add_f32 v100, v100, v100 row_shr:4 row_mask:0xf bank_mask:0xf bound_ctrl:0
  v_add_f32 v102, v102, v102 row_shr:4 row_mask:0xf bank_mask:0xf bound_ctrl:0
  v_add_f32 v104, v104, v104 row_shr:4 row_mask:0xf bank_mask:0xf bound_ctrl:0
  v_add_f32 v100, v100, v100 row_shr:8 row_mask:0xf bank_mask:0xf bound_ctrl:0
  v_add_f32 v102, v102, v102 row_shr:8 row_mask:0xf bank_mask:0xf bound_ctrl:0
  v_add_f32 v104, v104, v104 row_shr:8 row_mask:0xf bank_mask:0xf bound_ctrl:0
  v_cvt_pk_bf16_f32 v17, v100, v102
  v_cvt_pk_bf16_f32 v18, v104, v104
  v_lshlrev_b32 v16, 16, v17
  v_and_b32 v17, 0xffff0000, v17
  v_add_f32 v17, 1.0, v17
  v_cvt_pk_bf16_f32 v17, v17, v17
  v_and_b32 v17, 0xffff0000, v17
  v_mul_f32 v19, 0x42800000, v17
  v_add_f32 v19, abs(v19), abs(v16)
  v_frexp_exp_i32_f32 v19, v19
  v_sub_u32 v19, 15, v19
  v_ldexp_f32 v17, v17, v19
  v_ldexp_f32 v16, v16, v19
  v_sub_u32 v19, 0, v19
  v_lshlrev_b32 v243, 16, v243
  v_lshlrev_b32 v18, 16, v18
  v_ldexp_f32 v243, v243, v19
  v_lshrrev_b32 v20, 2, v2
  v_and_b32 v20, 12, v20
  s_mov_b32 exec_lo, 0x80008000
  s_mov_b32 exec_hi, 0x00008000
  ds_write_b32 v20, v17 offset:0
  ds_write_b32 v20, v16 offset:16
  ds_write_b32 v248, v33 offset:276
  ds_write_b32 v20, v243 offset:32
  ds_write_b32 v20, v18 offset:48
  ds_write_b32 v20, v19 offset:64
  s_mov_b64 exec, -1

  s_mov_b64 exec, 1
  ds_add_u32 v248, v249 offset:272
  s_mov_b64 exec, -1
  s_branch M_NI2
M_W7X:
  s_cmp_ge_u32 s2, 243
  s_cbranch_scc1 M_NI2
  v_mov_b32 v112, 0
  v_mov_b32 v113, 0
  v_mov_b32 v114, 0
  v_mov_b32 v115, 0
  v_mov_b32 v116, 0
  v_mov_b32 v117, 0
  v_mov_b32 v118, 0
  v_mov_b32 v119, 0
  s_waitcnt vmcnt(3)
  v_dot2c_f32_bf16 v112, v64, v28
  v_dot2c_f32_bf16 v113, v64, v24
  v_dot2c_f32_bf16 v114, v65, v28
  v_dot2c_f32_bf16 v115, v65, v24
  v_dot2c_f32_bf16 v116, v66, v28
  v_dot2c_f32_bf16 v117, v66, v24
  v_dot2c_f32_bf16 v118, v67, v28
  v_dot2c_f32_bf16 v119, v67, v24
  s_waitcnt vmcnt(2)
  v_dot2c_f32_bf16 v112, v68, v29
  v_dot2c_f32_bf16 v113, v68, v25
  v_dot2c_f32_bf16 v114, v69, v29
  v_dot2c_f32_bf16 v115, v69, v25
  v_dot2c_f32_bf16 v116, v70, v29
  v_dot2c_f32_bf16 v117, v70, v25
  v_dot2c_f32_bf16 v118, v71, v29
  v_dot2c_f32_bf16 v119, v71, v25
  s_waitcnt vmcnt(1)
  v_dot2c_f32_bf16 v112, v72, v30
  v_dot2c_f32_bf16 v113, v72, v26
  v_dot2c_f32_bf16 v114, v73, v30
  v_dot2c_f32_bf16 v115, v73, v26
  v_dot2c_f32_bf16 v116, v74, v30
  v_dot2c_f32_bf16 v117, v74, v26
  v_dot2c_f32_bf16 v118, v75, v30
  v_dot2c_f32_bf16 v119, v75, v26
  s_waitcnt vmcnt(0)
  v_dot2c_f32_bf16 v112, v76, v31
  v_dot2c_f32_bf16 v113, v76, v27
  v_dot2c_f32_bf16 v114, v77, v31
  v_dot2c_f32_bf16 v115, v77, v27
  v_dot2c_f32_bf16 v116, v78, v31
  v_dot2c_f32_bf16 v117, v78, v27
  v_dot2c_f32_bf16 v118, v79, v31
  v_dot2c_f32_bf16 v119, v79, v27
  s_nop 2
  v_permlane32_swap_b32 v112, v116
  v_permlane32_swap_b32 v113, v117
  v_permlane32_swap_b32 v114, v118
  v_permlane32_swap_b32 v115, v119
  v_add_f32 v112, v112, v116
  v_add_f32 v113, v113, v117
  v_add_f32 v114, v114, v118
  v_add_f32 v115, v115, v119
  s_nop 0
  v_permlane16_swap_b32 v112, v114
  v_permlane16_swap_b32 v113, v115
  v_add_f32 v112, v112, v114
  v_add_f32 v113, v113, v115
  s_nop 1
  v_add_f32 v32, v112, v112 row_ror:8 row_mask:0xf bank_mask:0x3
  v_add_f32 v32, v113, v113 row_ror:8 row_mask:0xf bank_mask:0xc
  s_nop 1
  v_add_f32 v32, v32, v32 row_shl:4 row_mask:0xf bank_mask:0x5
  s_mov_b32 exec_lo, 0x0f0f0f0f
  s_mov_b32 exec_hi, 0x0f0f0f0f
  global_store_dwordx2 v35, v[32:33], s[36:37] sc1
  s_mov_b64 exec, -1
M_NI2:
SP_5:
  ds_read_b32 v251, v248 offset:224
  s_waitcnt lgkmcnt(0)
  v_readfirstlane_b32 s94, v251
  s_cmp_ge_u32 s94, 1
  s_cbranch_scc0 SP_5

  global_load_dwordx4 v[224:227], v252, s[36:37] offset:0 sc1
  global_load_dwordx4 v[228:231], v252, s[36:37] offset:1024 sc1
  global_load_dwordx4 v[232:235], v252, s[36:37] offset:2048 sc1
  global_load_dwordx4 v[236:239], v252, s[36:37] offset:3072 sc1
  s_mov_b32 s73, 0
  s_cmp_lg_u32 s3, 6
  s_cbranch_scc1 M_CSET
  s_cmp_ge_u32 s2, 243
  s_cbranch_scc1 M_CSET
  v_mov_b32 v112, 0
  v_mov_b32 v113, 0
  v_mov_b32 v114, 0
  v_mov_b32 v115, 0
  v_mov_b32 v116, 0
  v_mov_b32 v117, 0
  v_mov_b32 v118, 0
  v_mov_b32 v119, 0
  s_waitcnt vmcnt(7)
  v_dot2c_f32_bf16 v112, v64, v28
  v_dot2c_f32_bf16 v113, v64, v24
  v_dot2c_f32_bf16 v114, v65, v28
  v_dot2c_f32_bf16 v115, v65, v24
  v_dot2c_f32_bf16 v116, v66, v28
  v_dot2c_f32_bf16 v117, v66, v24
  v_dot2c_f32_bf16 v118, v67, v28
  v_dot2c_f32_bf16 v119, v67, v24
  s_waitcnt vmcnt(6)
  v_dot2c_f32_bf16 v112, v68, v29
  v_dot2c_f32_bf16 v113, v68, v25
  v_dot2c_f32_bf16 v114, v69, v29
  v_dot2c_f32_bf16 v115, v69, v25
  v_dot2c_f32_bf16 v116, v70, v29
  v_dot2c_f32_bf16 v117, v70, v25
  v_dot2c_f32_bf16 v118, v71, v29
  v_dot2c_f32_bf16 v119, v71, v25
  s_waitcnt vmcnt(5)
  v_dot2c_f32_bf16 v112, v72, v30
  v_dot2c_f32_bf16 v113, v72, v26
  v_dot2c_f32_bf16 v114, v73, v30
  v_dot2c_f32_bf16 v115, v73, v26
  v_dot2c_f32_bf16 v116, v74, v30
  v_dot2c_f32_bf16 v117, v74, v26
  v_dot2c_f32_bf16 v118, v75, v30
  v_dot2c_f32_bf16 v119, v75, v26
  s_waitcnt vmcnt(4)
  v_dot2c_f32_bf16 v112, v76, v31
  v_dot2c_f32_bf16 v113, v76, v27
  v_dot2c_f32_bf16 v114, v77, v31
  v_dot2c_f32_bf16 v115, v77, v27
  v_dot2c_f32_bf16 v116, v78, v31
  v_dot2c_f32_bf16 v117, v78, v27
  v_dot2c_f32_bf16 v118, v79, v31
  v_dot2c_f32_bf16 v119, v79, v27
  s_nop 2
  v_permlane32_swap_b32 v112, v116
  v_permlane32_swap_b32 v113, v117
  v_permlane32_swap_b32 v114, v118
  v_permlane32_swap_b32 v115, v119
  v_add_f32 v112, v112, v116
  v_add_f32 v113, v113, v117
  v_add_f32 v114, v114, v118
  v_add_f32 v115, v115, v119
  s_nop 0
  v_permlane16_swap_b32 v112, v114
  v_permlane16_swap_b32 v113, v115
  v_add_f32 v112, v112, v114
  v_add_f32 v113, v113, v115
  s_nop 1
  v_add_f32 v32, v112, v112 row_ror:8 row_mask:0xf bank_mask:0x3
  v_add_f32 v32, v113, v113 row_ror:8 row_mask:0xf bank_mask:0xc
  s_nop 1
  v_add_f32 v32, v32, v32 row_shl:4 row_mask:0xf bank_mask:0x5
  s_mov_b32 exec_lo, 0x0f0f0f0f
  s_mov_b32 exec_hi, 0x0f0f0f0f
  global_store_dwordx2 v35, v[32:33], s[36:37] sc1
  s_mov_b64 exec, -1
  s_mov_b32 s73, 1
M_CSET:
  s_lshl_b32 s40, s3, 2
  s_lshr_b32 s40, 0x31242010, s40
  s_and_b32 s62, s40, 15
  s_and_b32 s40, s2, 3
  s_cmp_eq_u32 s62, 4
  s_cselect_b32 s40, s40, 0
  s_add_u32 s62, s62, s40

  s_cmp_ge_u32 s3, 6
  s_cbranch_scc1 M_TGS
M_PL0:
SP_6:
  ds_read_b32 v251, v1 offset:224
  s_waitcnt lgkmcnt(0)
  v_readfirstlane_b32 s94, v251
  s_cmp_ge_u32 s94, 2
  s_cbranch_scc0 SP_6

  s_cmp_eq_u32 s62, 0
  s_cbranch_scc1 M_PLA
  s_cmp_eq_u32 s62, 1
  s_cbranch_scc1 M_PLB
  s_cmp_eq_u32 s62, 2
  s_cbranch_scc1 M_PLC
  s_cmp_eq_u32 s62, 3
  s_cbranch_scc1 M_PLD
  s_cmp_eq_u32 s62, 4
  s_cbranch_scc1 M_PLK0
  s_cmp_eq_u32 s62, 5
  s_cbranch_scc1 M_PLK1
  s_cmp_eq_u32 s62, 6
  s_cbranch_scc1 M_PLK2
  s_branch M_PLK3
M_PLA:
  ds_read_b64 v[92:93], v4 offset:2048
  ds_read_b64 v[94:95], v4 offset:2056
  ds_read_b64 v[124:125], v4 offset:1536
  ds_read_b64 v[126:127], v4 offset:1544
  ds_read_b64 v[156:157], v4 offset:1024
  ds_read_b64 v[158:159], v4 offset:1032
  ds_read_b64 v[188:189], v4 offset:512
  ds_read_b64 v[190:191], v4 offset:520
  ds_read_b64 v[220:221], v4 offset:0
  ds_read_b64 v[222:223], v4 offset:8
  ds_read_b64 v[88:89], v4 offset:2112
  ds_read_b64 v[90:91], v4 offset:2120
  ds_read_b64 v[120:121], v4 offset:1600
  ds_read_b64 v[122:123], v4 offset:1608
  ds_read_b64 v[152:153], v4 offset:1088
  ds_read_b64 v[154:155], v4 offset:1096
  ds_read_b64 v[184:185], v4 offset:576
  ds_read_b64 v[186:187], v4 offset:584
  ds_read_b64 v[216:217], v4 offset:64
  ds_read_b64 v[218:219], v4 offset:72
  ds_read_b64 v[84:85], v4 offset:2176
  ds_read_b64 v[86:87], v4 offset:2184
  ds_read_b64 v[116:117], v4 offset:1664
  ds_read_b64 v[118:119], v4 offset:1672
  ds_read_b64 v[148:149], v4 offset:1152
  ds_read_b64 v[150:151], v4 offset:1160
  ds_read_b64 v[180:181], v4 offset:640
  ds_read_b64 v[182:183], v4 offset:648
  ds_read_b64 v[212:213], v4 offset:128
  ds_read_b64 v[214:215], v4 offset:136
  ds_read_b64 v[80:81], v4 offset:2240
  ds_read_b64 v[82:83], v4 offset:2248
  ds_read_b64 v[112:113], v4 offset:1728
  ds_read_b64 v[114:115], v4 offset:1736
  ds_read_b64 v[144:145], v4 offset:1216
  ds_read_b64 v[146:147], v4 offset:1224
  ds_read_b64 v[176:177], v4 offset:704
  ds_read_b64 v[178:179], v4 offset:712
  ds_read_b64 v[208:209], v4 offset:192
  ds_read_b64 v[210:211], v4 offset:200
  ds_read_b64 v[76:77], v4 offset:2304
  ds_read_b64 v[78:79], v4 offset:2312
  ds_read_b64 v[108:109], v4 offset:1792
  ds_read_b64 v[110:111], v4 offset:1800
  ds_read_b64 v[140:141], v4 offset:1280
  ds_read_b64 v[142:143], v4 offset:1288
  ds_read_b64 v[172:173], v4 offset:768
  ds_read_b64 v[174:175], v4 offset:776
  ds_read_b64 v[204:205], v4 offset:256
  ds_read_b64 v[206:207], v4 offset:264
  ds_read_b64 v[72:73], v4 offset:2368
  ds_read_b64 v[74:75], v4 offset:2376
  ds_read_b64 v[104:105], v4 offset:1856
  ds_read_b64 v[106:107], v4 offset:1864
  ds_read_b64 v[136:137], v4 offset:1344
  ds_read_b64 v[138:139], v4 offset:1352
  ds_read_b64 v[168:169], v4 offset:832
  ds_read_b64 v[170:171], v4 offset:840
  ds_read_b64 v[200:201], v4 offset:320
  ds_read_b64 v[202:203], v4 offset:328
  ds_read_b64 v[68:69], v4 offset:2432
  ds_read_b64 v[70:71], v4 offset:2440
  ds_read_b64 v[100:101], v4 offset:1920
  ds_read_b64 v[102:103], v4 offset:1928
  ds_read_b64 v[132:133], v4 offset:1408
  ds_read_b64 v[134:135], v4 offset:1416
  ds_read_b64 v[164:165], v4 offset:896
  ds_read_b64 v[166:167], v4 offset:904
  ds_read_b64 v[196:197], v4 offset:384
  ds_read_b64 v[198:199], v4 offset:392
  ds_read_b64 v[64:65], v4 offset:2496
  ds_read_b64 v[66:67], v4 offset:2504
  ds_read_b64 v[96:97], v4 offset:1984
  ds_read_b64 v[98:99], v4 offset:1992
  ds_read_b64 v[128:129], v4 offset:1472
  ds_read_b64 v[130:131], v4 offset:1480
  ds_read_b64 v[160:161], v4 offset:960
  ds_read_b64 v[162:163], v4 offset:968
  ds_read_b64 v[192:193], v4 offset:448
  ds_read_b64 v[194:195], v4 offset:456
  s_branch M_STG
M_PLB:
  ds_read_b64 v[92:93], v4 offset:3584
  ds_read_b64 v[94:95], v4 offset:3592
  ds_read_b64 v[124:125], v4 offset:3072
  ds_read_b64 v[126:127], v4 offset:3080
  ds_read_b64 v[156:157], v4 offset:2560
  ds_read_b64 v[158:159], v4 offset:2568
  ds_read_b64 v[88:89], v4 offset:3648
  ds_read_b64 v[90:91], v4 offset:3656
  ds_read_b64 v[120:121], v4 offset:3136
  ds_read_b64 v[122:123], v4 offset:3144
  ds_read_b64 v[152:153], v4 offset:2624
  ds_read_b64 v[154:155], v4 offset:2632
  ds_read_b64 v[84:85], v4 offset:3712
  ds_read_b64 v[86:87], v4 offset:3720
  ds_read_b64 v[116:117], v4 offset:3200
  ds_read_b64 v[118:119], v4 offset:3208
  ds_read_b64 v[148:149], v4 offset:2688
  ds_read_b64 v[150:151], v4 offset:2696
  ds_read_b64 v[80:81], v4 offset:3776
  ds_read_b64 v[82:83], v4 offset:3784
  ds_read_b64 v[112:113], v4 offset:3264
  ds_read_b64 v[114:115], v4 offset:3272
  ds_read_b64 v[144:145], v4 offset:2752
  ds_read_b64 v[146:147], v4 offset:2760
  ds_read_b64 v[76:77], v4 offset:3840
  ds_read_b64 v[78:79], v4 offset:3848
  ds_read_b64 v[108:109], v4 offset:3328
  ds_read_b64 v[110:111], v4 offset:3336
  ds_read_b64 v[140:141], v4 offset:2816
  ds_read_b64 v[142:143], v4 offset:2824
  ds_read_b64 v[72:73], v4 offset:3904
  ds_read_b64 v[74:75], v4 offset:3912
  ds_read_b64 v[104:105], v4 offset:3392
  ds_read_b64 v[106:107], v4 offset:3400
  ds_read_b64 v[136:137], v4 offset:2880
  ds_read_b64 v[138:139], v4 offset:2888
  ds_read_b64 v[68:69], v4 offset:3968
  ds_read_b64 v[70:71], v4 offset:3976
  ds_read_b64 v[100:101], v4 offset:3456
  ds_read_b64 v[102:103], v4 offset:3464
  ds_read_b64 v[132:133], v4 offset:2944
  ds_read_b64 v[134:135], v4 offset:2952
  ds_read_b64 v[64:65], v4 offset:4032
  ds_read_b64 v[66:67], v4 offset:4040
  ds_read_b64 v[96:97], v4 offset:3520
  ds_read_b64 v[98:99], v4 offset:3528
  ds_read_b64 v[128:129], v4 offset:3008
  ds_read_b64 v[130:131], v4 offset:3016
  s_branch M_STG
M_PLC:
  ds_read_b64 v[92:93], v4 offset:3584
  ds_read_b64 v[94:95], v4 offset:3592
  ds_read_b64 v[124:125], v4 offset:3072
  ds_read_b64 v[126:127], v4 offset:3080
  ds_read_b64 v[156:157], v4 offset:2560
  ds_read_b64 v[158:159], v4 offset:2568
  ds_read_b64 v[188:189], v4 offset:2048
  ds_read_b64 v[190:191], v4 offset:2056
  ds_read_b64 v[220:221], v4 offset:1536
  ds_read_b64 v[222:223], v4 offset:1544
  ds_read_b64 v[88:89], v4 offset:3648
  ds_read_b64 v[90:91], v4 offset:3656
  ds_read_b64 v[120:121], v4 offset:3136
  ds_read_b64 v[122:123], v4 offset:3144
  ds_read_b64 v[152:153], v4 offset:2624
  ds_read_b64 v[154:155], v4 offset:2632
  ds_read_b64 v[184:185], v4 offset:2112
  ds_read_b64 v[186:187], v4 offset:2120
  ds_read_b64 v[216:217], v4 offset:1600
  ds_read_b64 v[218:219], v4 offset:1608
  ds_read_b64 v[84:85], v4 offset:3712
  ds_read_b64 v[86:87], v4 offset:3720
  ds_read_b64 v[116:117], v4 offset:3200
  ds_read_b64 v[118:119], v4 offset:3208
  ds_read_b64 v[148:149], v4 offset:2688
  ds_read_b64 v[150:151], v4 offset:2696
  ds_read_b64 v[180:181], v4 offset:2176
  ds_read_b64 v[182:183], v4 offset:2184
  ds_read_b64 v[212:213], v4 offset:1664
  ds_read_b64 v[214:215], v4 offset:1672
  ds_read_b64 v[80:81], v4 offset:3776
  ds_read_b64 v[82:83], v4 offset:3784
  ds_read_b64 v[112:113], v4 offset:3264
  ds_read_b64 v[114:115], v4 offset:3272
  ds_read_b64 v[144:145], v4 offset:2752
  ds_read_b64 v[146:147], v4 offset:2760
  ds_read_b64 v[176:177], v4 offset:2240
  ds_read_b64 v[178:179], v4 offset:2248
  ds_read_b64 v[208:209], v4 offset:1728
  ds_read_b64 v[210:211], v4 offset:1736
  ds_read_b64 v[76:77], v4 offset:3840
  ds_read_b64 v[78:79], v4 offset:3848
  ds_read_b64 v[108:109], v4 offset:3328
  ds_read_b64 v[110:111], v4 offset:3336
  ds_read_b64 v[140:141], v4 offset:2816
  ds_read_b64 v[142:143], v4 offset:2824
  ds_read_b64 v[172:173], v4 offset:2304
  ds_read_b64 v[174:175], v4 offset:2312
  ds_read_b64 v[204:205], v4 offset:1792
  ds_read_b64 v[206:207], v4 offset:1800
  ds_read_b64 v[72:73], v4 offset:3904
  ds_read_b64 v[74:75], v4 offset:3912
  ds_read_b64 v[104:105], v4 offset:3392
  ds_read_b64 v[106:107], v4 offset:3400
  ds_read_b64 v[136:137], v4 offset:2880
  ds_read_b64 v[138:139], v4 offset:2888
  ds_read_b64 v[168:169], v4 offset:2368
  ds_read_b64 v[170:171], v4 offset:2376
  ds_read_b64 v[200:201], v4 offset:1856
  ds_read_b64 v[202:203], v4 offset:1864
  ds_read_b64 v[68:69], v4 offset:3968
  ds_read_b64 v[70:71], v4 offset:3976
  ds_read_b64 v[100:101], v4 offset:3456
  ds_read_b64 v[102:103], v4 offset:3464
  ds_read_b64 v[132:133], v4 offset:2944
  ds_read_b64 v[134:135], v4 offset:2952
  ds_read_b64 v[164:165], v4 offset:2432
  ds_read_b64 v[166:167], v4 offset:2440
  ds_read_b64 v[196:197], v4 offset:1920
  ds_read_b64 v[198:199], v4 offset:1928
  ds_read_b64 v[64:65], v4 offset:4032
  ds_read_b64 v[66:67], v4 offset:4040
  ds_read_b64 v[96:97], v4 offset:3520
  ds_read_b64 v[98:99], v4 offset:3528
  ds_read_b64 v[128:129], v4 offset:3008
  ds_read_b64 v[130:131], v4 offset:3016
  ds_read_b64 v[160:161], v4 offset:2496
  ds_read_b64 v[162:163], v4 offset:2504
  ds_read_b64 v[192:193], v4 offset:1984
  ds_read_b64 v[194:195], v4 offset:1992
  s_branch M_STG
M_PLD:
SP_7:
  ds_read_b32 v251, v248 offset:228
  s_waitcnt lgkmcnt(0)
  v_readfirstlane_b32 s94, v251
  s_cmp_ge_u32 s94, 2
  s_cbranch_scc0 SP_7

  ds_read_b64 v[92:93], v4 offset:3584
  ds_read_b64 v[94:95], v4 offset:3592
  ds_read_b64 v[124:125], v5 offset:3584
  ds_read_b64 v[126:127], v5 offset:3592
  ds_read_b64 v[156:157], v4 offset:3072
  ds_read_b64 v[158:159], v4 offset:3080
  ds_read_b64 v[188:189], v5 offset:3072
  ds_read_b64 v[190:191], v5 offset:3080
  ds_read_b64 v[220:221], v4 offset:2560
  ds_read_b64 v[222:223], v4 offset:2568
  ds_read_b64 v[88:89], v4 offset:3648
  ds_read_b64 v[90:91], v4 offset:3656
  ds_read_b64 v[120:121], v5 offset:3648
  ds_read_b64 v[122:123], v5 offset:3656
  ds_read_b64 v[152:153], v4 offset:3136
  ds_read_b64 v[154:155], v4 offset:3144
  ds_read_b64 v[184:185], v5 offset:3136
  ds_read_b64 v[186:187], v5 offset:3144
  ds_read_b64 v[216:217], v4 offset:2624
  ds_read_b64 v[218:219], v4 offset:2632
  ds_read_b64 v[84:85], v4 offset:3712
  ds_read_b64 v[86:87], v4 offset:3720
  ds_read_b64 v[116:117], v5 offset:3712
  ds_read_b64 v[118:119], v5 offset:3720
  ds_read_b64 v[148:149], v4 offset:3200
  ds_read_b64 v[150:151], v4 offset:3208
  ds_read_b64 v[180:181], v5 offset:3200
  ds_read_b64 v[182:183], v5 offset:3208
  ds_read_b64 v[212:213], v4 offset:2688
  ds_read_b64 v[214:215], v4 offset:2696
  ds_read_b64 v[80:81], v4 offset:3776
  ds_read_b64 v[82:83], v4 offset:3784
  ds_read_b64 v[112:113], v5 offset:3776
  ds_read_b64 v[114:115], v5 offset:3784
  ds_read_b64 v[144:145], v4 offset:3264
  ds_read_b64 v[146:147], v4 offset:3272
  ds_read_b64 v[176:177], v5 offset:3264
  ds_read_b64 v[178:179], v5 offset:3272
  ds_read_b64 v[208:209], v4 offset:2752
  ds_read_b64 v[210:211], v4 offset:2760
  ds_read_b64 v[76:77], v4 offset:3840
  ds_read_b64 v[78:79], v4 offset:3848
  ds_read_b64 v[108:109], v5 offset:3840
  ds_read_b64 v[110:111], v5 offset:3848
  ds_read_b64 v[140:141], v4 offset:3328
  ds_read_b64 v[142:143], v4 offset:3336
  ds_read_b64 v[172:173], v5 offset:3328
  ds_read_b64 v[174:175], v5 offset:3336
  ds_read_b64 v[204:205], v4 offset:2816
  ds_read_b64 v[206:207], v4 offset:2824
  ds_read_b64 v[72:73], v4 offset:3904
  ds_read_b64 v[74:75], v4 offset:3912
  ds_read_b64 v[104:105], v5 offset:3904
  ds_read_b64 v[106:107], v5 offset:3912
  ds_read_b64 v[136:137], v4 offset:3392
  ds_read_b64 v[138:139], v4 offset:3400
  ds_read_b64 v[168:169], v5 offset:3392
  ds_read_b64 v[170:171], v5 offset:3400
  ds_read_b64 v[200:201], v4 offset:2880
  ds_read_b64 v[202:203], v4 offset:2888
  ds_read_b64 v[68:69], v4 offset:3968
  ds_read_b64 v[70:71], v4 offset:3976
  ds_read_b64 v[100:101], v5 offset:3968
  ds_read_b64 v[102:103], v5 offset:3976
  ds_read_b64 v[132:133], v4 offset:3456
  ds_read_b64 v[134:135], v4 offset:3464
  ds_read_b64 v[164:165], v5 offset:3456
  ds_read_b64 v[166:167], v5 offset:3464
  ds_read_b64 v[196:197], v4 offset:2944
  ds_read_b64 v[198:199], v4 offset:2952
  ds_read_b64 v[64:65], v4 offset:4032
  ds_read_b64 v[66:67], v4 offset:4040
  ds_read_b64 v[96:97], v5 offset:4032
  ds_read_b64 v[98:99], v5 offset:4040
  ds_read_b64 v[128:129], v4 offset:3520
  ds_read_b64 v[130:131], v4 offset:3528
  ds_read_b64 v[160:161], v5 offset:3520
  ds_read_b64 v[162:163], v5 offset:3528
  ds_read_b64 v[192:193], v4 offset:3008
  ds_read_b64 v[194:195], v4 offset:3016
  s_branch M_STG
M_PLK0:
  v_add_u32 v5, 2048, v4
  ds_read2_b64 v[92:95], v5 offset0:192 offset1:193
  ds_read2_b64 v[124:127], v5 offset0:128 offset1:129
  ds_read2_b64 v[156:159], v5 offset0:64 offset1:65
  ds_read2_b64 v[188:191], v5 offset0:0 offset1:1
  ds_read2_b64 v[220:223], v4 offset0:192 offset1:193
  ds_read2_b64 v[88:91], v5 offset0:200 offset1:201
  ds_read2_b64 v[120:123], v5 offset0:136 offset1:137
  ds_read2_b64 v[152:155], v5 offset0:72 offset1:73
  ds_read2_b64 v[184:187], v5 offset0:8 offset1:9
  ds_read2_b64 v[216:219], v4 offset0:200 offset1:201
  s_branch M_STG
M_PLK1:
  v_add_u32 v5, 2048, v4
  ds_read2_b64 v[92:95], v5 offset0:192 offset1:193
  ds_read2_b64 v[124:127], v5 offset0:128 offset1:129
  ds_read2_b64 v[156:159], v5 offset0:64 offset1:65
  ds_read2_b64 v[188:191], v5 offset0:0 offset1:1
  ds_read2_b64 v[220:223], v4 offset0:192 offset1:193
  ds_read2_b64 v[88:91], v5 offset0:200 offset1:201
  ds_read2_b64 v[120:123], v5 offset0:136 offset1:137
  ds_read2_b64 v[152:155], v5 offset0:72 offset1:73
  ds_read2_b64 v[184:187], v5 offset0:8 offset1:9
  ds_read2_b64 v[216:219], v4 offset0:200 offset1:201
  s_branch M_STG
M_PLK2:
  v_add_u32 v5, 2048, v4
  ds_read2_b64 v[92:95], v5 offset0:192 offset1:193
  ds_read2_b64 v[124:127], v5 offset0:128 offset1:129
  ds_read2_b64 v[156:159], v5 offset0:64 offset1:65
  ds_read2_b64 v[188:191], v5 offset0:0 offset1:1
  ds_read2_b64 v[220:223], v4 offset0:192 offset1:193
  ds_read2_b64 v[88:91], v5 offset0:200 offset1:201
  ds_read2_b64 v[120:123], v5 offset0:136 offset1:137
  ds_read2_b64 v[152:155], v5 offset0:72 offset1:73
  ds_read2_b64 v[184:187], v5 offset0:8 offset1:9
  ds_read2_b64 v[216:219], v4 offset0:200 offset1:201
  s_branch M_STG
M_PLK3:
  v_add_u32 v5, 2048, v4
  ds_read2_b64 v[92:95], v5 offset0:192 offset1:193
  ds_read2_b64 v[124:127], v5 offset0:128 offset1:129
  ds_read2_b64 v[156:159], v5 offset0:64 offset1:65
  ds_read2_b64 v[188:191], v5 offset0:0 offset1:1
  ds_read2_b64 v[220:223], v4 offset0:192 offset1:193
  ds_read2_b64 v[88:91], v5 offset0:200 offset1:201
  ds_read2_b64 v[120:123], v5 offset0:136 offset1:137
  ds_read2_b64 v[152:155], v5 offset0:72 offset1:73
  ds_read2_b64 v[184:187], v5 offset0:8 offset1:9
  ds_read2_b64 v[216:219], v4 offset0:200 offset1:201
  s_branch M_STG
M_STG:
  s_cmp_ge_u32 s3, 4
  s_cbranch_scc1 M_HW
  s_cmp_ge_u32 s3, 2
  s_cbranch_scc1 M_U3

M_TGS:
  ds_read_b64 v[16:17], v248 offset:272
  ds_read_b128 v[20:23], v248 offset:0
  ds_read_b128 v[24:27], v248 offset:16
  s_lshl_b32 s40, s63, 8
  s_add_u32 s40, s40, 55648
  s_mov_b32 m0, s40
  s_mov_b32 s41, 65536
  v_mov_b32 v30, 0x3f80
  v_mov_b32 v31, 0x3f800000
  s_waitcnt lgkmcnt(0)
  v_readfirstlane_b32 s94, v16
  v_readfirstlane_b32 s38, v17
  v_readfirstlane_b32 s66, v20
  v_readfirstlane_b32 s69, v22
  v_readfirstlane_b32 s67, v21
  v_readfirstlane_b32 s70, v24
  v_readfirstlane_b32 s71, v25
  v_readfirstlane_b32 s72, v26
  s_lshr_b32 s66, s66, 16
  s_lshr_b32 s68, s69, 16
  s_cmp_ge_u32 s94, 1
  s_cbranch_scc0 M_TGS
  s_waitcnt vmcnt(1)
  s_cmp_eq_u32 s73, 1
  s_cbranch_scc1 M_XP1
M_XP:
  s_waitcnt vmcnt(0)
M_XP1:
  v_xor_b32 v16, s38, v227
  v_xor_b32 v17, s38, v231
  v_xor_b32 v18, s38, v235
  v_xor_b32 v19, s38, v239
  v_or_b32 v18, v18, v19

  v_or3_b32 v16, v16, v17, v18
  v_cmp_ne_u32 vcc, 0, v16
  s_cbranch_vccz M_XD
  s_mov_b64 exec, vcc

  global_load_dwordx4 v[224:227], v252, s[36:37] offset:0 sc1
  global_load_dwordx4 v[228:231], v252, s[36:37] offset:1024 sc1
  global_load_dwordx4 v[232:235], v252, s[36:37] offset:2048 sc1
  global_load_dwordx4 v[236:239], v252, s[36:37] offset:3072 sc1
  s_mov_b64 exec, -1
  s_sub_u32 s41, s41, 1
  s_cbranch_scc0 M_XP
M_XD:

  v_dot2_f32_bf16 v32, v224, s66, 0
  v_dot2_f32_bf16 v33, v225, s66, 0
  v_dot2_f32_bf16 v34, v224, s67, 0
  v_dot2_f32_bf16 v35, v225, s67, 0
  v_dot2_f32_bf16 v36, v226, s68, 0
  v_dot2_f32_bf16 v37, v226, s69, 0
  v_dot2_f32_bf16 v38, v228, s66, 0
  v_dot2_f32_bf16 v39, v229, s66, 0
  v_dot2_f32_bf16 v40, v228, s67, 0
  v_dot2_f32_bf16 v41, v229, s67, 0
  v_dot2_f32_bf16 v42, v230, s68, 0
  v_dot2_f32_bf16 v43, v230, s69, 0
  v_cvt_pk_bf16_f32 v33, v32, v33
  v_cvt_pk_bf16_f32 v35, v34, v35
  v_cvt_pk_bf16_f32 v37, v36, v37
  v_cvt_pk_bf16_f32 v39, v38, v39
  v_cvt_pk_bf16_f32 v41, v40, v41
  v_cvt_pk_bf16_f32 v43, v42, v43
  v_dot2_f32_bf16 v32, v33, v30, s70
  v_dot2_f32_bf16 v33, v33, v31, s70
  v_dot2_f32_bf16 v34, v35, v30, s71
  v_dot2_f32_bf16 v35, v35, v31, s71
  v_dot2_f32_bf16 v36, v37, v30, s72
  v_dot2_f32_bf16 v37, v37, v31, s72
  v_dot2_f32_bf16 v38, v39, v30, s70
  v_dot2_f32_bf16 v39, v39, v31, s70
  v_dot2_f32_bf16 v40, v41, v30, s71
  v_dot2_f32_bf16 v41, v41, v31, s71
  v_dot2_f32_bf16 v42, v43, v30, s72
  v_dot2_f32_bf16 v43, v43, v31, s72
  s_nop 1
  v_cvt_pk_bf16_f32 v33, v32, v33
  v_cvt_pk_bf16_f32 v35, v34, v35
  v_cvt_pk_bf16_f32 v37, v36, v37
  v_cvt_pk_bf16_f32 v39, v38, v39
  v_cvt_pk_bf16_f32 v41, v40, v41
  v_cvt_pk_bf16_f32 v43, v42, v43
  v_lshlrev_b32 v32, 16, v33
  v_and_b32 v33, 0xffff0000, v33
  v_lshlrev_b32 v34, 16, v35
  v_and_b32 v35, 0xffff0000, v35
  v_lshlrev_b32 v36, 16, v37
  v_and_b32 v37, 0xffff0000, v37
  v_lshlrev_b32 v38, 16, v39
  v_and_b32 v39, 0xffff0000, v39
  v_lshlrev_b32 v40, 16, v41
  v_and_b32 v41, 0xffff0000, v41
  v_lshlrev_b32 v42, 16, v43
  v_and_b32 v43, 0xffff0000, v43
  v_cvt_pk_f16_f32 v16, v32, v33
  v_cvt_pk_f16_f32 v17, v34, v35
  v_cvt_pk_f16_f32 v18, v36, v37
  v_cvt_pk_f16_f32 v19, v38, v39
  v_cvt_pk_f16_f32 v20, v40, v41
  v_cvt_pk_f16_f32 v21, v42, v43
  ds_write_addtid_b32 v16 offset:0
  ds_write_addtid_b32 v17 offset:4608
  ds_write_addtid_b32 v18 offset:9216
  ds_write_addtid_b32 v19 offset:256
  ds_write_addtid_b32 v20 offset:4864
  ds_write_addtid_b32 v21 offset:9472
  v_dot2_f32_bf16 v32, v232, s66, 0
  v_dot2_f32_bf16 v33, v233, s66, 0
  v_dot2_f32_bf16 v34, v232, s67, 0
  v_dot2_f32_bf16 v35, v233, s67, 0
  v_dot2_f32_bf16 v36, v234, s68, 0
  v_dot2_f32_bf16 v37, v234, s69, 0
  v_dot2_f32_bf16 v38, v236, s66, 0
  v_dot2_f32_bf16 v39, v237, s66, 0
  v_dot2_f32_bf16 v40, v236, s67, 0
  v_dot2_f32_bf16 v41, v237, s67, 0
  v_dot2_f32_bf16 v42, v238, s68, 0
  v_dot2_f32_bf16 v43, v238, s69, 0
  v_cvt_pk_bf16_f32 v33, v32, v33
  v_cvt_pk_bf16_f32 v35, v34, v35
  v_cvt_pk_bf16_f32 v37, v36, v37
  v_cvt_pk_bf16_f32 v39, v38, v39
  v_cvt_pk_bf16_f32 v41, v40, v41
  v_cvt_pk_bf16_f32 v43, v42, v43
  v_dot2_f32_bf16 v32, v33, v30, s70
  v_dot2_f32_bf16 v33, v33, v31, s70
  v_dot2_f32_bf16 v34, v35, v30, s71
  v_dot2_f32_bf16 v35, v35, v31, s71
  v_dot2_f32_bf16 v36, v37, v30, s72
  v_dot2_f32_bf16 v37, v37, v31, s72
  v_dot2_f32_bf16 v38, v39, v30, s70
  v_dot2_f32_bf16 v39, v39, v31, s70
  v_dot2_f32_bf16 v40, v41, v30, s71
  v_dot2_f32_bf16 v41, v41, v31, s71
  v_dot2_f32_bf16 v42, v43, v30, s72
  v_dot2_f32_bf16 v43, v43, v31, s72
  s_nop 1
  v_cvt_pk_bf16_f32 v33, v32, v33
  v_cvt_pk_bf16_f32 v35, v34, v35
  v_cvt_pk_bf16_f32 v37, v36, v37
  v_cvt_pk_bf16_f32 v39, v38, v39
  v_cvt_pk_bf16_f32 v41, v40, v41
  v_cvt_pk_bf16_f32 v43, v42, v43
  v_lshlrev_b32 v32, 16, v33
  v_and_b32 v33, 0xffff0000, v33
  v_lshlrev_b32 v34, 16, v35
  v_and_b32 v35, 0xffff0000, v35
  v_lshlrev_b32 v36, 16, v37
  v_and_b32 v37, 0xffff0000, v37
  v_lshlrev_b32 v38, 16, v39
  v_and_b32 v39, 0xffff0000, v39
  v_lshlrev_b32 v40, 16, v41
  v_and_b32 v41, 0xffff0000, v41
  v_lshlrev_b32 v42, 16, v43
  v_and_b32 v43, 0xffff0000, v43
  v_cvt_pk_f16_f32 v22, v32, v33
  v_cvt_pk_f16_f32 v23, v34, v35
  v_cvt_pk_f16_f32 v24, v36, v37
  v_cvt_pk_f16_f32 v25, v38, v39
  v_cvt_pk_f16_f32 v26, v40, v41
  v_cvt_pk_f16_f32 v27, v42, v43
  ds_write_addtid_b32 v22 offset:512
  ds_write_addtid_b32 v23 offset:5120
  ds_write_addtid_b32 v24 offset:9728
  ds_write_addtid_b32 v25 offset:768
  ds_write_addtid_b32 v26 offset:5376
  ds_write_addtid_b32 v27 offset:9984
M_U3:
  s_mov_b64 exec, 1
  ds_add_u32 v248, v249 offset:240
  s_mov_b64 exec, -1
  s_cmp_ge_u32 s3, 6
  s_cbranch_scc1 M_PL0
M_HW:
  s_and_b32 s40, s2, 7
  s_mul_i32 s40, s40, 18
  s_lshr_b32 s41, s2, 3
  s_add_u32 s46, s40, s41

  s_cmp_lt_u32 s3, 4
  s_cselect_b32 s47, 144, 0
  s_bitcmp1_b32 s3, 1
  s_cselect_b32 s78, s24, s22
  s_cselect_b32 s79, s25, s23

  s_cmp_lg_u32 s3, 4
  s_cbranch_scc1 M_NP4
  s_setprio 1
M_NP4:
M_HS:
  ds_read_b32 v251, v248 offset:240
  ds_read_b32 v15, v248 offset:196
  s_waitcnt lgkmcnt(0)
  v_readfirstlane_b32 s94, v251
  v_readfirstlane_b32 s38, v15
  s_cmp_ge_u32 s94, 8
  s_cbranch_scc0 M_HS

  s_cmp_eq_u32 s62, 0
  s_cbranch_scc1 M_RUNA
  s_cmp_eq_u32 s62, 1
  s_cbranch_scc1 M_RUNB
  s_cmp_eq_u32 s62, 2
  s_cbranch_scc1 M_RUNC
  s_cmp_eq_u32 s62, 3
  s_cbranch_scc1 M_RUND
  s_cmp_eq_u32 s62, 4
  s_cbranch_scc1 M_RUNK0
  s_cmp_eq_u32 s62, 5
  s_cbranch_scc1 M_RUNK1
  s_cmp_eq_u32 s62, 6
  s_cbranch_scc1 M_RUNK2
  s_branch M_RUNK3
M_RUNA:
  ds_read_b128 v[32:35], v6 offset:0
  ds_read_b128 v[36:39], v6 offset:64
  ds_read_b128 v[40:43], v6 offset:128
  s_waitcnt lgkmcnt(2)
  v_mfma_f32_16x16x32_f16 v[224:227], v[92:95], v[32:35], 0
  v_mfma_f32_16x16x32_f16 v[228:231], v[124:127], v[32:35], 0
  v_mfma_f32_16x16x32_f16 v[232:235], v[156:159], v[32:35], 0
  s_lshr_b32 s64, s2, 3
  s_mul_i32 s64, s64, 162
  v_mfma_f32_16x16x32_f16 v[236:239], v[188:191], v[32:35], 0
  s_add_u32 s64, s64, 0
  s_and_b32 s65, s2, 7
  v_mfma_f32_16x16x32_f16 v[240:243], v[220:223], v[32:35], 0
  s_mul_i32 s65, s65, 9
  v_min_u32 v252, 53, v2
  ds_read_b128 v[44:47], v6 offset:192
  s_waitcnt lgkmcnt(2)
  v_mfma_f32_16x16x32_f16 v[224:227], v[88:91], v[36:39], v[224:227]
  v_add_u32 v252, s64, v252
  v_mul_u32_u24 v254, 7282, v252
  v_mfma_f32_16x16x32_f16 v[228:231], v[120:123], v[36:39], v[228:231]
  v_lshrrev_b32 v254, 16, v254
  v_mul_u32_u24 v253, 9, v254
  v_mfma_f32_16x16x32_f16 v[232:235], v[152:155], v[36:39], v[232:235]
  v_sub_u32 v253, v252, v253
  v_add_u32 v253, s65, v253
  v_mfma_f32_16x16x32_f16 v[236:239], v[184:187], v[36:39], v[236:239]
  v_mul_u32_u24 v254, 9216, v254
  v_lshl_add_u32 v254, v253, 7, v254
  v_mfma_f32_16x16x32_f16 v[240:243], v[216:219], v[36:39], v[240:243]
  global_load_dword v250, v254, s[78:79]
  ds_read_b128 v[48:51], v6 offset:256
  s_waitcnt lgkmcnt(2)
  v_mfma_f32_16x16x32_f16 v[224:227], v[84:87], v[40:43], v[224:227]
  v_mfma_f32_16x16x32_f16 v[228:231], v[116:119], v[40:43], v[228:231]
  v_mfma_f32_16x16x32_f16 v[232:235], v[148:151], v[40:43], v[232:235]
  v_mfma_f32_16x16x32_f16 v[236:239], v[180:183], v[40:43], v[236:239]
  v_mfma_f32_16x16x32_f16 v[240:243], v[212:215], v[40:43], v[240:243]
  ds_read_b128 v[52:55], v6 offset:320
  s_waitcnt lgkmcnt(2)
  v_mfma_f32_16x16x32_f16 v[224:227], v[80:83], v[44:47], v[224:227]
  v_mfma_f32_16x16x32_f16 v[228:231], v[112:115], v[44:47], v[228:231]
  v_mfma_f32_16x16x32_f16 v[232:235], v[144:147], v[44:47], v[232:235]
  v_mfma_f32_16x16x32_f16 v[236:239], v[176:179], v[44:47], v[236:239]
  v_mfma_f32_16x16x32_f16 v[240:243], v[208:211], v[44:47], v[240:243]
  ds_read_b128 v[56:59], v6 offset:384
  s_waitcnt lgkmcnt(2)
  v_mfma_f32_16x16x32_f16 v[224:227], v[76:79], v[48:51], v[224:227]
  v_mfma_f32_16x16x32_f16 v[228:231], v[108:111], v[48:51], v[228:231]
  v_mfma_f32_16x16x32_f16 v[232:235], v[140:143], v[48:51], v[232:235]
  v_mfma_f32_16x16x32_f16 v[236:239], v[172:175], v[48:51], v[236:239]
  v_mfma_f32_16x16x32_f16 v[240:243], v[204:207], v[48:51], v[240:243]
  ds_read_b128 v[60:63], v6 offset:448
  s_waitcnt lgkmcnt(2)
  v_mfma_f32_16x16x32_f16 v[224:227], v[72:75], v[52:55], v[224:227]
  v_mfma_f32_16x16x32_f16 v[228:231], v[104:107], v[52:55], v[228:231]
  v_mfma_f32_16x16x32_f16 v[232:235], v[136:139], v[52:55], v[232:235]
  v_mfma_f32_16x16x32_f16 v[236:239], v[168:171], v[52:55], v[236:239]
  v_mfma_f32_16x16x32_f16 v[240:243], v[200:203], v[52:55], v[240:243]
  ds_read_b128 v[32:35], v6 offset:512
  s_waitcnt lgkmcnt(2)
  v_mfma_f32_16x16x32_f16 v[224:227], v[68:71], v[56:59], v[224:227]
  v_mfma_f32_16x16x32_f16 v[228:231], v[100:103], v[56:59], v[228:231]
  v_mfma_f32_16x16x32_f16 v[232:235], v[132:135], v[56:59], v[232:235]
  v_mfma_f32_16x16x32_f16 v[236:239], v[164:167], v[56:59], v[236:239]
  ds_read_b128 v[36:39], v6 offset:576
  v_mfma_f32_16x16x32_f16 v[240:243], v[196:199], v[56:59], v[240:243]
  s_waitcnt lgkmcnt(2)
  v_mfma_f32_16x16x32_f16 v[224:227], v[64:67], v[60:63], v[224:227]
  v_mfma_f32_16x16x32_f16 v[228:231], v[96:99], v[60:63], v[228:231]
  v_mfma_f32_16x16x32_f16 v[232:235], v[128:131], v[60:63], v[232:235]
  ds_read_b128 v[40:43], v6 offset:640
  v_mfma_f32_16x16x32_f16 v[236:239], v[160:163], v[60:63], v[236:239]
  v_mfma_f32_16x16x32_f16 v[240:243], v[192:195], v[60:63], v[240:243]
  s_waitcnt lgkmcnt(2)
  v_mfma_f32_16x16x32_f16 v[228:231], v[92:95], v[32:35], v[228:231]
  v_mfma_f32_16x16x32_f16 v[232:235], v[124:127], v[32:35], v[232:235]
  ds_read_b128 v[44:47], v6 offset:704
  v_mfma_f32_16x16x32_f16 v[236:239], v[156:159], v[32:35], v[236:239]
  v_mfma_f32_16x16x32_f16 v[240:243], v[188:191], v[32:35], v[240:243]
  s_waitcnt lgkmcnt(2)
  v_mfma_f32_16x16x32_f16 v[228:231], v[88:91], v[36:39], v[228:231]
  ds_write_b128 v8, v[224:227] offset:0
  v_mfma_f32_16x16x32_f16 v[232:235], v[120:123], v[36:39], v[232:235]
  ds_read_b128 v[48:51], v6 offset:768
  v_mfma_f32_16x16x32_f16 v[236:239], v[152:155], v[36:39], v[236:239]
  v_mfma_f32_16x16x32_f16 v[240:243], v[184:187], v[36:39], v[240:243]
  s_waitcnt lgkmcnt(3)
  v_mfma_f32_16x16x32_f16 v[228:231], v[84:87], v[40:43], v[228:231]
  v_mfma_f32_16x16x32_f16 v[232:235], v[116:119], v[40:43], v[232:235]
  ds_read_b128 v[52:55], v6 offset:832
  v_mfma_f32_16x16x32_f16 v[236:239], v[148:151], v[40:43], v[236:239]
  v_mfma_f32_16x16x32_f16 v[240:243], v[180:183], v[40:43], v[240:243]
  s_waitcnt lgkmcnt(3)
  v_mfma_f32_16x16x32_f16 v[228:231], v[80:83], v[44:47], v[228:231]
  v_mfma_f32_16x16x32_f16 v[232:235], v[112:115], v[44:47], v[232:235]
  ds_read_b128 v[56:59], v6 offset:896
  v_mfma_f32_16x16x32_f16 v[236:239], v[144:147], v[44:47], v[236:239]
  v_mfma_f32_16x16x32_f16 v[240:243], v[176:179], v[44:47], v[240:243]
  s_waitcnt lgkmcnt(2)
  v_mfma_f32_16x16x32_f16 v[228:231], v[76:79], v[48:51], v[228:231]
  v_mfma_f32_16x16x32_f16 v[232:235], v[108:111], v[48:51], v[232:235]
  ds_read_b128 v[60:63], v6 offset:960
  v_mfma_f32_16x16x32_f16 v[236:239], v[140:143], v[48:51], v[236:239]
  v_mfma_f32_16x16x32_f16 v[240:243], v[172:175], v[48:51], v[240:243]
  s_waitcnt lgkmcnt(2)
  v_mfma_f32_16x16x32_f16 v[228:231], v[72:75], v[52:55], v[228:231]
  v_mfma_f32_16x16x32_f16 v[232:235], v[104:107], v[52:55], v[232:235]
  ds_read_b128 v[32:35], v6 offset:1024
  v_mfma_f32_16x16x32_f16 v[236:239], v[136:139], v[52:55], v[236:239]
  v_mfma_f32_16x16x32_f16 v[240:243], v[168:171], v[52:55], v[240:243]
  ds_read_b128 v[36:39], v6 offset:1088
  s_waitcnt lgkmcnt(3)
  v_mfma_f32_16x16x32_f16 v[228:231], v[68:71], v[56:59], v[228:231]
  v_mfma_f32_16x16x32_f16 v[232:235], v[100:103], v[56:59], v[232:235]
  ds_read_b128 v[40:43], v6 offset:1152
  v_mfma_f32_16x16x32_f16 v[236:239], v[132:135], v[56:59], v[236:239]
  v_mfma_f32_16x16x32_f16 v[240:243], v[164:167], v[56:59], v[240:243]
  ds_read_b128 v[44:47], v6 offset:1216
  s_waitcnt lgkmcnt(4)
  v_mfma_f32_16x16x32_f16 v[228:231], v[64:67], v[60:63], v[228:231]
  v_mfma_f32_16x16x32_f16 v[232:235], v[96:99], v[60:63], v[232:235]
  ds_read_b128 v[48:51], v6 offset:1280
  v_mfma_f32_16x16x32_f16 v[236:239], v[128:131], v[60:63], v[236:239]
  v_mfma_f32_16x16x32_f16 v[240:243], v[160:163], v[60:63], v[240:243]
  ds_read_b128 v[52:55], v6 offset:1344
  s_waitcnt lgkmcnt(5)
  v_mfma_f32_16x16x32_f16 v[232:235], v[92:95], v[32:35], v[232:235]
  v_mfma_f32_16x16x32_f16 v[236:239], v[124:127], v[32:35], v[236:239]
  ds_read_b128 v[56:59], v6 offset:1408
  s_waitcnt lgkmcnt(5)
  v_mfma_f32_16x16x32_f16 v[232:235], v[88:91], v[36:39], v[232:235]
  v_mfma_f32_16x16x32_f16 v[236:239], v[120:123], v[36:39], v[236:239]
  ds_read_b128 v[60:63], v6 offset:1472
  s_waitcnt lgkmcnt(5)
  v_mfma_f32_16x16x32_f16 v[232:235], v[84:87], v[40:43], v[232:235]
  v_mfma_f32_16x16x32_f16 v[236:239], v[116:119], v[40:43], v[236:239]
  ds_write_b128 v8, v[228:231] offset:1024
  s_waitcnt lgkmcnt(5)
  v_mfma_f32_16x16x32_f16 v[232:235], v[80:83], v[44:47], v[232:235]
  v_mfma_f32_16x16x32_f16 v[236:239], v[112:115], v[44:47], v[236:239]
  s_waitcnt lgkmcnt(4)
  v_mfma_f32_16x16x32_f16 v[232:235], v[76:79], v[48:51], v[232:235]
  v_mfma_f32_16x16x32_f16 v[236:239], v[108:111], v[48:51], v[236:239]
  s_waitcnt lgkmcnt(3)
  v_mfma_f32_16x16x32_f16 v[232:235], v[72:75], v[52:55], v[232:235]
  v_mfma_f32_16x16x32_f16 v[236:239], v[104:107], v[52:55], v[236:239]
  s_waitcnt lgkmcnt(2)
  v_mfma_f32_16x16x32_f16 v[232:235], v[68:71], v[56:59], v[232:235]
  v_mfma_f32_16x16x32_f16 v[236:239], v[100:103], v[56:59], v[236:239]
  s_waitcnt lgkmcnt(1)
  v_mfma_f32_16x16x32_f16 v[232:235], v[64:67], v[60:63], v[232:235]
  v_mfma_f32_16x16x32_f16 v[236:239], v[96:99], v[60:63], v[236:239]
  v_mfma_f32_16x16x32_f16 v[240:243], v[156:159], v[32:35], v[240:243]
  v_mfma_f32_16x16x32_f16 v[240:243], v[152:155], v[36:39], v[240:243]
  v_mfma_f32_16x16x32_f16 v[240:243], v[148:151], v[40:43], v[240:243]
  v_mfma_f32_16x16x32_f16 v[240:243], v[144:147], v[44:47], v[240:243]
  v_mfma_f32_16x16x32_f16 v[240:243], v[140:143], v[48:51], v[240:243]
  v_mfma_f32_16x16x32_f16 v[240:243], v[136:139], v[52:55], v[240:243]
  v_mfma_f32_16x16x32_f16 v[240:243], v[132:135], v[56:59], v[240:243]
  v_mfma_f32_16x16x32_f16 v[240:243], v[128:131], v[60:63], v[240:243]
  ds_write_b128 v8, v[232:235] offset:2048
  s_nop 7
  ds_write_b128 v8, v[236:239] offset:3072
  ds_write_b128 v8, v[240:243] offset:4096
  s_branch M_FIN
M_RUNB:
  ds_read_b128 v[32:35], v6 offset:0
  ds_read_b128 v[36:39], v6 offset:64
  ds_read_b128 v[40:43], v6 offset:128
  ds_read_b128 v[44:47], v6 offset:192
  s_waitcnt lgkmcnt(3)
  v_mfma_f32_16x16x32_f16 v[224:227], v[92:95], v[32:35], 0
  v_mfma_f32_16x16x32_f16 v[228:231], v[124:127], v[32:35], 0
  ds_read_b128 v[48:51], v6 offset:256
  v_mfma_f32_16x16x32_f16 v[232:235], v[156:159], v[32:35], 0
  s_lshr_b32 s64, s2, 3
  s_mul_i32 s64, s64, 162
  s_waitcnt lgkmcnt(3)
  v_mfma_f32_16x16x32_f16 v[224:227], v[88:91], v[36:39], v[224:227]
  s_add_u32 s64, s64, 54
  s_and_b32 s65, s2, 7
  v_mfma_f32_16x16x32_f16 v[228:231], v[120:123], v[36:39], v[228:231]
  s_mul_i32 s65, s65, 9
  v_min_u32 v252, 53, v2
  ds_read_b128 v[52:55], v6 offset:320
  v_mfma_f32_16x16x32_f16 v[232:235], v[152:155], v[36:39], v[232:235]
  v_add_u32 v252, s64, v252
  v_mul_u32_u24 v254, 7282, v252
  s_waitcnt lgkmcnt(3)
  v_mfma_f32_16x16x32_f16 v[224:227], v[84:87], v[40:43], v[224:227]
  v_lshrrev_b32 v254, 16, v254
  v_mul_u32_u24 v253, 9, v254
  v_mfma_f32_16x16x32_f16 v[228:231], v[116:119], v[40:43], v[228:231]
  v_sub_u32 v253, v252, v253
  v_add_u32 v253, s65, v253
  ds_read_b128 v[56:59], v6 offset:384
  v_mfma_f32_16x16x32_f16 v[232:235], v[148:151], v[40:43], v[232:235]
  v_mul_u32_u24 v254, 9216, v254
  v_lshl_add_u32 v254, v253, 7, v254
  s_waitcnt lgkmcnt(3)
  v_mfma_f32_16x16x32_f16 v[224:227], v[80:83], v[44:47], v[224:227]
  global_load_dword v250, v254, s[78:79]
  v_mfma_f32_16x16x32_f16 v[228:231], v[112:115], v[44:47], v[228:231]
  ds_read_b128 v[60:63], v6 offset:448
  v_mfma_f32_16x16x32_f16 v[232:235], v[144:147], v[44:47], v[232:235]
  s_waitcnt lgkmcnt(3)
  v_mfma_f32_16x16x32_f16 v[224:227], v[76:79], v[48:51], v[224:227]
  v_mfma_f32_16x16x32_f16 v[228:231], v[108:111], v[48:51], v[228:231]
  ds_read_b128 v[32:35], v6 offset:512
  v_mfma_f32_16x16x32_f16 v[232:235], v[140:143], v[48:51], v[232:235]
  s_waitcnt lgkmcnt(3)
  v_mfma_f32_16x16x32_f16 v[224:227], v[72:75], v[52:55], v[224:227]
  v_mfma_f32_16x16x32_f16 v[228:231], v[104:107], v[52:55], v[228:231]
  ds_read_b128 v[36:39], v6 offset:576
  v_mfma_f32_16x16x32_f16 v[232:235], v[136:139], v[52:55], v[232:235]
  s_waitcnt lgkmcnt(3)
  v_mfma_f32_16x16x32_f16 v[224:227], v[68:71], v[56:59], v[224:227]
  v_mfma_f32_16x16x32_f16 v[228:231], v[100:103], v[56:59], v[228:231]
  ds_read_b128 v[40:43], v6 offset:640
  v_mfma_f32_16x16x32_f16 v[232:235], v[132:135], v[56:59], v[232:235]
  s_waitcnt lgkmcnt(3)
  v_mfma_f32_16x16x32_f16 v[224:227], v[64:67], v[60:63], v[224:227]
  v_mfma_f32_16x16x32_f16 v[228:231], v[96:99], v[60:63], v[228:231]
  ds_read_b128 v[44:47], v6 offset:704
  v_mfma_f32_16x16x32_f16 v[232:235], v[128:131], v[60:63], v[232:235]
  s_waitcnt lgkmcnt(3)
  v_mfma_f32_16x16x32_f16 v[228:231], v[92:95], v[32:35], v[228:231]
  v_mfma_f32_16x16x32_f16 v[232:235], v[124:127], v[32:35], v[232:235]
  ds_read_b128 v[48:51], v6 offset:768
  v_mfma_f32_16x16x32_f16 v[236:239], v[156:159], v[32:35], 0
  s_waitcnt lgkmcnt(3)
  v_mfma_f32_16x16x32_f16 v[228:231], v[88:91], v[36:39], v[228:231]
  v_mfma_f32_16x16x32_f16 v[232:235], v[120:123], v[36:39], v[232:235]
  ds_read_b128 v[52:55], v6 offset:832
  v_mfma_f32_16x16x32_f16 v[236:239], v[152:155], v[36:39], v[236:239]
  s_waitcnt lgkmcnt(3)
  v_mfma_f32_16x16x32_f16 v[228:231], v[84:87], v[40:43], v[228:231]
  ds_write_b128 v8, v[224:227] offset:5120
  v_mfma_f32_16x16x32_f16 v[232:235], v[116:119], v[40:43], v[232:235]
  ds_read_b128 v[56:59], v6 offset:896
  v_mfma_f32_16x16x32_f16 v[236:239], v[148:151], v[40:43], v[236:239]
  s_cmp_lg_u32 s3, 1
  s_cbranch_scc1 M_NRI
  s_cmp_lt_u32 s2, 229
  s_cbranch_scc1 M_NRI
  s_sub_u32 s40, s2, 202
  s_mul_i32 s40, s40, 4608
  s_add_u32 s40, s40, 524288
  v_lshl_add_u32 v178, v2, 3, s40
  v_add_u32 v179, 4096, v178

  global_load_dwordx2 v[160:161], v178, s[36:37] offset:0 sc1
  global_load_dwordx2 v[162:163], v178, s[36:37] offset:512 sc1
  global_load_dwordx2 v[164:165], v178, s[36:37] offset:1024 sc1
  global_load_dwordx2 v[166:167], v178, s[36:37] offset:1536 sc1
  global_load_dwordx2 v[168:169], v178, s[36:37] offset:2048 sc1
  global_load_dwordx2 v[170:171], v178, s[36:37] offset:2560 sc1
  global_load_dwordx2 v[172:173], v178, s[36:37] offset:3072 sc1
  global_load_dwordx2 v[174:175], v178, s[36:37] offset:3584 sc1
  global_load_dwordx2 v[176:177], v179, s[36:37] sc1
M_NRI:
  s_waitcnt lgkmcnt(4)
  v_mfma_f32_16x16x32_f16 v[228:231], v[80:83], v[44:47], v[228:231]
  v_mfma_f32_16x16x32_f16 v[232:235], v[112:115], v[44:47], v[232:235]
  ds_read_b128 v[60:63], v6 offset:960
  v_mfma_f32_16x16x32_f16 v[236:239], v[144:147], v[44:47], v[236:239]
  s_waitcnt lgkmcnt(4)
  v_mfma_f32_16x16x32_f16 v[228:231], v[76:79], v[48:51], v[228:231]
  v_mfma_f32_16x16x32_f16 v[232:235], v[108:111], v[48:51], v[232:235]
  ds_read_b128 v[32:35], v6 offset:1024
  v_mfma_f32_16x16x32_f16 v[236:239], v[140:143], v[48:51], v[236:239]
  s_waitcnt lgkmcnt(4)
  v_mfma_f32_16x16x32_f16 v[228:231], v[72:75], v[52:55], v[228:231]
  ds_read_b128 v[36:39], v6 offset:1088
  v_mfma_f32_16x16x32_f16 v[232:235], v[104:107], v[52:55], v[232:235]
  v_mfma_f32_16x16x32_f16 v[236:239], v[136:139], v[52:55], v[236:239]
  ds_read_b128 v[40:43], v6 offset:1152
  s_waitcnt lgkmcnt(4)
  v_mfma_f32_16x16x32_f16 v[228:231], v[68:71], v[56:59], v[228:231]
  v_mfma_f32_16x16x32_f16 v[232:235], v[100:103], v[56:59], v[232:235]
  ds_read_b128 v[44:47], v6 offset:1216
  v_mfma_f32_16x16x32_f16 v[236:239], v[132:135], v[56:59], v[236:239]
  s_waitcnt lgkmcnt(4)
  v_mfma_f32_16x16x32_f16 v[228:231], v[64:67], v[60:63], v[228:231]
  ds_read_b128 v[48:51], v6 offset:1280
  v_mfma_f32_16x16x32_f16 v[232:235], v[96:99], v[60:63], v[232:235]
  v_mfma_f32_16x16x32_f16 v[236:239], v[128:131], v[60:63], v[236:239]
  ds_read_b128 v[52:55], v6 offset:1344
  s_waitcnt lgkmcnt(5)
  v_mfma_f32_16x16x32_f16 v[232:235], v[92:95], v[32:35], v[232:235]
  v_mfma_f32_16x16x32_f16 v[236:239], v[124:127], v[32:35], v[236:239]
  ds_read_b128 v[56:59], v6 offset:1408
  s_waitcnt lgkmcnt(5)
  v_mfma_f32_16x16x32_f16 v[232:235], v[88:91], v[36:39], v[232:235]
  v_mfma_f32_16x16x32_f16 v[236:239], v[120:123], v[36:39], v[236:239]
  ds_read_b128 v[60:63], v6 offset:1472
  s_waitcnt lgkmcnt(5)
  v_mfma_f32_16x16x32_f16 v[232:235], v[84:87], v[40:43], v[232:235]
  v_mfma_f32_16x16x32_f16 v[236:239], v[116:119], v[40:43], v[236:239]
  s_waitcnt lgkmcnt(4)
  v_mfma_f32_16x16x32_f16 v[232:235], v[80:83], v[44:47], v[232:235]
  ds_write_b128 v8, v[228:231] offset:6144
  v_mfma_f32_16x16x32_f16 v[236:239], v[112:115], v[44:47], v[236:239]
  s_waitcnt lgkmcnt(4)
  v_mfma_f32_16x16x32_f16 v[232:235], v[76:79], v[48:51], v[232:235]
  v_mfma_f32_16x16x32_f16 v[236:239], v[108:111], v[48:51], v[236:239]
  s_waitcnt lgkmcnt(3)
  v_mfma_f32_16x16x32_f16 v[232:235], v[72:75], v[52:55], v[232:235]
  v_mfma_f32_16x16x32_f16 v[236:239], v[104:107], v[52:55], v[236:239]
  s_waitcnt lgkmcnt(2)
  v_mfma_f32_16x16x32_f16 v[232:235], v[68:71], v[56:59], v[232:235]
  v_mfma_f32_16x16x32_f16 v[236:239], v[100:103], v[56:59], v[236:239]
  s_waitcnt lgkmcnt(1)
  v_mfma_f32_16x16x32_f16 v[232:235], v[64:67], v[60:63], v[232:235]
  v_mfma_f32_16x16x32_f16 v[236:239], v[96:99], v[60:63], v[236:239]
  v_mfma_f32_16x16x32_f16 v[240:243], v[156:159], v[32:35], 0
  v_mfma_f32_16x16x32_f16 v[240:243], v[152:155], v[36:39], v[240:243]
  v_mfma_f32_16x16x32_f16 v[240:243], v[148:151], v[40:43], v[240:243]
  v_mfma_f32_16x16x32_f16 v[240:243], v[144:147], v[44:47], v[240:243]
  v_mfma_f32_16x16x32_f16 v[240:243], v[140:143], v[48:51], v[240:243]
  v_mfma_f32_16x16x32_f16 v[240:243], v[136:139], v[52:55], v[240:243]
  v_mfma_f32_16x16x32_f16 v[240:243], v[132:135], v[56:59], v[240:243]
  v_mfma_f32_16x16x32_f16 v[240:243], v[128:131], v[60:63], v[240:243]
  ds_write_b128 v8, v[232:235] offset:7168
  s_nop 7
  ds_write_b128 v8, v[236:239] offset:8192
  ds_write_b128 v8, v[240:243] offset:9216
  s_branch M_FIN
M_RUNC:
  ds_read_b128 v[32:35], v6 offset:1536
  ds_read_b128 v[36:39], v6 offset:1600
  ds_read_b128 v[40:43], v6 offset:1664
  s_waitcnt lgkmcnt(2)
  v_mfma_f32_16x16x32_f16 v[224:227], v[92:95], v[32:35], 0
  v_mfma_f32_16x16x32_f16 v[228:231], v[124:127], v[32:35], 0
  v_mfma_f32_16x16x32_f16 v[232:235], v[156:159], v[32:35], 0
  s_lshr_b32 s64, s2, 3
  s_mul_i32 s64, s64, 162
  v_mfma_f32_16x16x32_f16 v[236:239], v[188:191], v[32:35], 0
  s_add_u32 s64, s64, 108
  s_and_b32 s65, s2, 7
  v_mfma_f32_16x16x32_f16 v[240:243], v[220:223], v[32:35], 0
  s_mul_i32 s65, s65, 9
  v_min_u32 v252, 53, v2
  ds_read_b128 v[44:47], v6 offset:1728
  s_waitcnt lgkmcnt(2)
  v_mfma_f32_16x16x32_f16 v[224:227], v[88:91], v[36:39], v[224:227]
  v_add_u32 v252, s64, v252
  v_mul_u32_u24 v254, 7282, v252
  v_mfma_f32_16x16x32_f16 v[228:231], v[120:123], v[36:39], v[228:231]
  v_lshrrev_b32 v254, 16, v254
  v_mul_u32_u24 v253, 9, v254
  v_mfma_f32_16x16x32_f16 v[232:235], v[152:155], v[36:39], v[232:235]
  v_sub_u32 v253, v252, v253
  v_add_u32 v253, s65, v253
  v_mfma_f32_16x16x32_f16 v[236:239], v[184:187], v[36:39], v[236:239]
  v_mul_u32_u24 v254, 9216, v254
  v_lshl_add_u32 v254, v253, 7, v254
  v_mfma_f32_16x16x32_f16 v[240:243], v[216:219], v[36:39], v[240:243]
  global_load_dword v250, v254, s[78:79]
  ds_read_b128 v[48:51], v6 offset:1792
  s_waitcnt lgkmcnt(2)
  v_mfma_f32_16x16x32_f16 v[224:227], v[84:87], v[40:43], v[224:227]
  v_mfma_f32_16x16x32_f16 v[228:231], v[116:119], v[40:43], v[228:231]
  v_mfma_f32_16x16x32_f16 v[232:235], v[148:151], v[40:43], v[232:235]
  v_mfma_f32_16x16x32_f16 v[236:239], v[180:183], v[40:43], v[236:239]
  v_mfma_f32_16x16x32_f16 v[240:243], v[212:215], v[40:43], v[240:243]
  ds_read_b128 v[52:55], v6 offset:1856
  s_waitcnt lgkmcnt(2)
  v_mfma_f32_16x16x32_f16 v[224:227], v[80:83], v[44:47], v[224:227]
  v_mfma_f32_16x16x32_f16 v[228:231], v[112:115], v[44:47], v[228:231]
  v_mfma_f32_16x16x32_f16 v[232:235], v[144:147], v[44:47], v[232:235]
  v_mfma_f32_16x16x32_f16 v[236:239], v[176:179], v[44:47], v[236:239]
  v_mfma_f32_16x16x32_f16 v[240:243], v[208:211], v[44:47], v[240:243]
  ds_read_b128 v[56:59], v6 offset:1920
  s_waitcnt lgkmcnt(2)
  v_mfma_f32_16x16x32_f16 v[224:227], v[76:79], v[48:51], v[224:227]
  v_mfma_f32_16x16x32_f16 v[228:231], v[108:111], v[48:51], v[228:231]
  v_mfma_f32_16x16x32_f16 v[232:235], v[140:143], v[48:51], v[232:235]
  v_mfma_f32_16x16x32_f16 v[236:239], v[172:175], v[48:51], v[236:239]
  v_mfma_f32_16x16x32_f16 v[240:243], v[204:207], v[48:51], v[240:243]
  ds_read_b128 v[60:63], v6 offset:1984
  s_waitcnt lgkmcnt(2)
  v_mfma_f32_16x16x32_f16 v[224:227], v[72:75], v[52:55], v[224:227]
  v_mfma_f32_16x16x32_f16 v[228:231], v[104:107], v[52:55], v[228:231]
  v_mfma_f32_16x16x32_f16 v[232:235], v[136:139], v[52:55], v[232:235]
  v_mfma_f32_16x16x32_f16 v[236:239], v[168:171], v[52:55], v[236:239]
  v_mfma_f32_16x16x32_f16 v[240:243], v[200:203], v[52:55], v[240:243]
  ds_read_b128 v[32:35], v6 offset:2048
  s_waitcnt lgkmcnt(2)
  v_mfma_f32_16x16x32_f16 v[224:227], v[68:71], v[56:59], v[224:227]
  v_mfma_f32_16x16x32_f16 v[228:231], v[100:103], v[56:59], v[228:231]
  ds_read_b128 v[36:39], v6 offset:2112
  v_mfma_f32_16x16x32_f16 v[232:235], v[132:135], v[56:59], v[232:235]
  v_mfma_f32_16x16x32_f16 v[236:239], v[164:167], v[56:59], v[236:239]
  ds_read_b128 v[40:43], v6 offset:2176
  v_mfma_f32_16x16x32_f16 v[240:243], v[196:199], v[56:59], v[240:243]
  s_waitcnt lgkmcnt(3)
  v_mfma_f32_16x16x32_f16 v[224:227], v[64:67], v[60:63], v[224:227]
  ds_read_b128 v[44:47], v6 offset:2240
  v_mfma_f32_16x16x32_f16 v[228:231], v[96:99], v[60:63], v[228:231]
  v_mfma_f32_16x16x32_f16 v[232:235], v[128:131], v[60:63], v[232:235]
  ds_read_b128 v[48:51], v6 offset:2304
  v_mfma_f32_16x16x32_f16 v[236:239], v[160:163], v[60:63], v[236:239]
  v_mfma_f32_16x16x32_f16 v[240:243], v[192:195], v[60:63], v[240:243]
  ds_read_b128 v[52:55], v6 offset:2368
  s_waitcnt lgkmcnt(5)
  v_mfma_f32_16x16x32_f16 v[228:231], v[92:95], v[32:35], v[228:231]
  v_mfma_f32_16x16x32_f16 v[232:235], v[124:127], v[32:35], v[232:235]
  ds_read_b128 v[56:59], v6 offset:2432
  s_waitcnt lgkmcnt(5)
  v_mfma_f32_16x16x32_f16 v[228:231], v[88:91], v[36:39], v[228:231]
  v_mfma_f32_16x16x32_f16 v[232:235], v[120:123], v[36:39], v[232:235]
  ds_read_b128 v[60:63], v6 offset:2496
  s_waitcnt lgkmcnt(5)
  v_mfma_f32_16x16x32_f16 v[228:231], v[84:87], v[40:43], v[228:231]
  ds_write_b128 v8, v[224:227] offset:10240
  v_mfma_f32_16x16x32_f16 v[232:235], v[116:119], v[40:43], v[232:235]
  s_waitcnt lgkmcnt(5)
  v_mfma_f32_16x16x32_f16 v[228:231], v[80:83], v[44:47], v[228:231]
  v_mfma_f32_16x16x32_f16 v[232:235], v[112:115], v[44:47], v[232:235]
  s_waitcnt lgkmcnt(4)
  v_mfma_f32_16x16x32_f16 v[228:231], v[76:79], v[48:51], v[228:231]
  v_mfma_f32_16x16x32_f16 v[232:235], v[108:111], v[48:51], v[232:235]
  s_waitcnt lgkmcnt(3)
  v_mfma_f32_16x16x32_f16 v[228:231], v[72:75], v[52:55], v[228:231]
  v_mfma_f32_16x16x32_f16 v[232:235], v[104:107], v[52:55], v[232:235]
  s_waitcnt lgkmcnt(2)
  v_mfma_f32_16x16x32_f16 v[228:231], v[68:71], v[56:59], v[228:231]
  v_mfma_f32_16x16x32_f16 v[232:235], v[100:103], v[56:59], v[232:235]
  s_waitcnt lgkmcnt(1)
  v_mfma_f32_16x16x32_f16 v[228:231], v[64:67], v[60:63], v[228:231]
  v_mfma_f32_16x16x32_f16 v[232:235], v[96:99], v[60:63], v[232:235]
  v_mfma_f32_16x16x32_f16 v[236:239], v[156:159], v[32:35], v[236:239]
  v_mfma_f32_16x16x32_f16 v[236:239], v[152:155], v[36:39], v[236:239]
  v_mfma_f32_16x16x32_f16 v[236:239], v[148:151], v[40:43], v[236:239]
  v_mfma_f32_16x16x32_f16 v[236:239], v[144:147], v[44:47], v[236:239]
  v_mfma_f32_16x16x32_f16 v[236:239], v[140:143], v[48:51], v[236:239]
  v_mfma_f32_16x16x32_f16 v[236:239], v[136:139], v[52:55], v[236:239]
  v_mfma_f32_16x16x32_f16 v[236:239], v[132:135], v[56:59], v[236:239]
  v_mfma_f32_16x16x32_f16 v[236:239], v[128:131], v[60:63], v[236:239]
  ds_write_b128 v8, v[228:231] offset:11264
  v_mfma_f32_16x16x32_f16 v[240:243], v[188:191], v[32:35], v[240:243]
  ds_write_b128 v8, v[232:235] offset:12288
  v_mfma_f32_16x16x32_f16 v[240:243], v[184:187], v[36:39], v[240:243]
  v_mfma_f32_16x16x32_f16 v[240:243], v[180:183], v[40:43], v[240:243]
  v_mfma_f32_16x16x32_f16 v[240:243], v[176:179], v[44:47], v[240:243]
  v_mfma_f32_16x16x32_f16 v[240:243], v[172:175], v[48:51], v[240:243]
  v_mfma_f32_16x16x32_f16 v[240:243], v[168:171], v[52:55], v[240:243]
  v_mfma_f32_16x16x32_f16 v[240:243], v[164:167], v[56:59], v[240:243]
  v_mfma_f32_16x16x32_f16 v[240:243], v[160:163], v[60:63], v[240:243]
  s_nop 7
  ds_write_b128 v8, v[236:239] offset:13312
  ds_write_b128 v8, v[240:243] offset:14336
  s_branch M_FIN
M_RUND:
  ds_read_b128 v[32:35], v7 offset:2560
  ds_read_b64 v[16:17], v5 offset:2560
  ds_read_b64 v[18:19], v5 offset:2568
  ds_read_b128 v[36:39], v7 offset:2624
  ds_read_b64 v[20:21], v5 offset:2624
  ds_read_b64 v[22:23], v5 offset:2632
  ds_read_b128 v[40:43], v7 offset:2688
  ds_read_b64 v[24:25], v5 offset:2688
  ds_read_b64 v[26:27], v5 offset:2696
  ds_read_b128 v[44:47], v7 offset:2752
  s_waitcnt lgkmcnt(9)
  v_mfma_f32_16x16x32_f16 v[224:227], v[124:127], v[32:35], 0
  ds_read_b64 v[28:29], v5 offset:2752
  ds_read_b64 v[30:31], v5 offset:2760
  v_mfma_f32_16x16x32_f16 v[228:231], v[188:191], v[32:35], 0
  ds_read_b128 v[48:51], v7 offset:2816
  s_waitcnt lgkmcnt(10)
  v_mfma_f32_16x16x32_f16 v[232:235], v[16:19], v[32:35], 0
  s_waitcnt lgkmcnt(9)
  v_mfma_f32_16x16x32_f16 v[224:227], v[120:123], v[36:39], v[224:227]
  ds_read_b64 v[16:17], v5 offset:2816
  ds_read_b64 v[18:19], v5 offset:2824
  v_mfma_f32_16x16x32_f16 v[228:231], v[184:187], v[36:39], v[228:231]
  ds_read_b128 v[52:55], v7 offset:2880
  s_waitcnt lgkmcnt(10)
  v_mfma_f32_16x16x32_f16 v[232:235], v[20:23], v[36:39], v[232:235]
  s_waitcnt lgkmcnt(9)
  v_mfma_f32_16x16x32_f16 v[224:227], v[116:119], v[40:43], v[224:227]
  ds_read_b64 v[20:21], v5 offset:2880
  ds_read_b64 v[22:23], v5 offset:2888
  v_mfma_f32_16x16x32_f16 v[228:231], v[180:183], v[40:43], v[228:231]
  ds_read_b128 v[56:59], v7 offset:2944
  s_waitcnt lgkmcnt(10)
  v_mfma_f32_16x16x32_f16 v[232:235], v[24:27], v[40:43], v[232:235]
  s_waitcnt lgkmcnt(9)
  v_mfma_f32_16x16x32_f16 v[224:227], v[112:115], v[44:47], v[224:227]
  ds_read_b64 v[24:25], v5 offset:2944
  ds_read_b64 v[26:27], v5 offset:2952
  v_mfma_f32_16x16x32_f16 v[228:231], v[176:179], v[44:47], v[228:231]
  ds_read_b128 v[60:63], v7 offset:3008
  s_waitcnt lgkmcnt(10)
  v_mfma_f32_16x16x32_f16 v[232:235], v[28:31], v[44:47], v[232:235]
  s_waitcnt lgkmcnt(9)
  v_mfma_f32_16x16x32_f16 v[224:227], v[108:111], v[48:51], v[224:227]
  ds_read_b64 v[28:29], v5 offset:3008
  ds_read_b64 v[30:31], v5 offset:3016
  v_mfma_f32_16x16x32_f16 v[228:231], v[172:175], v[48:51], v[228:231]
  ds_read_b128 v[32:35], v7 offset:3072
  s_waitcnt lgkmcnt(10)
  v_mfma_f32_16x16x32_f16 v[232:235], v[16:19], v[48:51], v[232:235]
  s_waitcnt lgkmcnt(9)
  v_mfma_f32_16x16x32_f16 v[224:227], v[104:107], v[52:55], v[224:227]
  ds_read_b128 v[36:39], v7 offset:3136
  v_mfma_f32_16x16x32_f16 v[228:231], v[168:171], v[52:55], v[228:231]
  s_waitcnt lgkmcnt(8)
  v_mfma_f32_16x16x32_f16 v[232:235], v[20:23], v[52:55], v[232:235]
  ds_read_b128 v[40:43], v7 offset:3200
  s_waitcnt lgkmcnt(8)
  v_mfma_f32_16x16x32_f16 v[224:227], v[100:103], v[56:59], v[224:227]
  v_mfma_f32_16x16x32_f16 v[228:231], v[164:167], v[56:59], v[228:231]
  ds_read_b128 v[44:47], v7 offset:3264
  s_waitcnt lgkmcnt(7)
  v_mfma_f32_16x16x32_f16 v[232:235], v[24:27], v[56:59], v[232:235]
  s_waitcnt lgkmcnt(6)
  v_mfma_f32_16x16x32_f16 v[224:227], v[96:99], v[60:63], v[224:227]
  ds_read_b128 v[48:51], v7 offset:3328
  v_mfma_f32_16x16x32_f16 v[228:231], v[160:163], v[60:63], v[228:231]
  s_waitcnt lgkmcnt(5)
  v_mfma_f32_16x16x32_f16 v[232:235], v[28:31], v[60:63], v[232:235]
  ds_read_b128 v[52:55], v7 offset:3392
  s_waitcnt lgkmcnt(5)
  v_mfma_f32_16x16x32_f16 v[228:231], v[124:127], v[32:35], v[228:231]
  v_mfma_f32_16x16x32_f16 v[232:235], v[188:191], v[32:35], v[232:235]
  ds_read_b128 v[56:59], v7 offset:3456
  s_waitcnt lgkmcnt(5)
  v_mfma_f32_16x16x32_f16 v[228:231], v[120:123], v[36:39], v[228:231]
  v_mfma_f32_16x16x32_f16 v[232:235], v[184:187], v[36:39], v[232:235]
  ds_read_b128 v[60:63], v7 offset:3520
  s_waitcnt lgkmcnt(5)
  v_mfma_f32_16x16x32_f16 v[228:231], v[116:119], v[40:43], v[228:231]
  v_mfma_f32_16x16x32_f16 v[232:235], v[180:183], v[40:43], v[232:235]
  ds_read_b128 v[32:35], v7 offset:3584
  s_waitcnt lgkmcnt(5)
  v_mfma_f32_16x16x32_f16 v[228:231], v[112:115], v[44:47], v[228:231]
  ds_write_b128 v9, v[224:227] offset:15360
  ds_read_b128 v[36:39], v7 offset:3648
  v_mfma_f32_16x16x32_f16 v[232:235], v[176:179], v[44:47], v[232:235]
  ds_read_b128 v[40:43], v7 offset:3712
  s_waitcnt lgkmcnt(7)
  v_mfma_f32_16x16x32_f16 v[228:231], v[108:111], v[48:51], v[228:231]
  ds_read_b128 v[44:47], v7 offset:3776
  v_mfma_f32_16x16x32_f16 v[232:235], v[172:175], v[48:51], v[232:235]
  ds_read_b128 v[48:51], v7 offset:3840
  s_waitcnt lgkmcnt(8)
  v_mfma_f32_16x16x32_f16 v[228:231], v[104:107], v[52:55], v[228:231]
  v_mfma_f32_16x16x32_f16 v[232:235], v[168:171], v[52:55], v[232:235]
  ds_read_b128 v[52:55], v7 offset:3904
  s_waitcnt lgkmcnt(8)
  v_mfma_f32_16x16x32_f16 v[228:231], v[100:103], v[56:59], v[228:231]
  v_mfma_f32_16x16x32_f16 v[232:235], v[164:167], v[56:59], v[232:235]
  ds_read_b128 v[56:59], v7 offset:3968
  s_waitcnt lgkmcnt(8)
  v_mfma_f32_16x16x32_f16 v[228:231], v[96:99], v[60:63], v[228:231]
  v_mfma_f32_16x16x32_f16 v[232:235], v[160:163], v[60:63], v[232:235]
  ds_read_b128 v[60:63], v7 offset:4032
  s_waitcnt lgkmcnt(8)
  v_mfma_f32_16x16x32_f16 v[232:235], v[124:127], v[32:35], v[232:235]
  ds_read_b128 v[32:35], v6 offset:2560
  s_waitcnt lgkmcnt(7)
  v_mfma_f32_16x16x32_f16 v[232:235], v[120:123], v[36:39], v[232:235]
  ds_read_b128 v[36:39], v6 offset:2624
  s_waitcnt lgkmcnt(7)
  v_mfma_f32_16x16x32_f16 v[232:235], v[116:119], v[40:43], v[232:235]
  s_waitcnt lgkmcnt(6)
  v_mfma_f32_16x16x32_f16 v[232:235], v[112:115], v[44:47], v[232:235]
  ds_read_b128 v[40:43], v6 offset:2688
  s_waitcnt lgkmcnt(6)
  v_mfma_f32_16x16x32_f16 v[232:235], v[108:111], v[48:51], v[232:235]
  s_waitcnt lgkmcnt(5)
  v_mfma_f32_16x16x32_f16 v[232:235], v[104:107], v[52:55], v[232:235]
  s_waitcnt lgkmcnt(4)
  v_mfma_f32_16x16x32_f16 v[232:235], v[100:103], v[56:59], v[232:235]
  ds_read_b128 v[44:47], v6 offset:2752
  s_waitcnt lgkmcnt(4)
  v_mfma_f32_16x16x32_f16 v[232:235], v[96:99], v[60:63], v[232:235]
  ds_write_b128 v9, v[228:231] offset:16384
  s_waitcnt lgkmcnt(4)
  v_mfma_f32_16x16x32_f16 v[236:239], v[92:95], v[32:35], 0
  v_mfma_f32_16x16x32_f16 v[240:243], v[156:159], v[32:35], 0
  ds_read_b128 v[48:51], v6 offset:2816
  v_mfma_f32_16x16x32_f16 v[244:247], v[220:223], v[32:35], 0
  s_waitcnt lgkmcnt(4)
  v_mfma_f32_16x16x32_f16 v[236:239], v[88:91], v[36:39], v[236:239]
  v_mfma_f32_16x16x32_f16 v[240:243], v[152:155], v[36:39], v[240:243]
  ds_read_b128 v[52:55], v6 offset:2880
  v_mfma_f32_16x16x32_f16 v[244:247], v[216:219], v[36:39], v[244:247]
  s_waitcnt lgkmcnt(4)
  v_mfma_f32_16x16x32_f16 v[236:239], v[84:87], v[40:43], v[236:239]
  v_mfma_f32_16x16x32_f16 v[240:243], v[148:151], v[40:43], v[240:243]
  ds_read_b128 v[56:59], v6 offset:2944
  v_mfma_f32_16x16x32_f16 v[244:247], v[212:215], v[40:43], v[244:247]
  ds_write_b128 v9, v[232:235] offset:17408
  s_waitcnt lgkmcnt(5)
  v_mfma_f32_16x16x32_f16 v[236:239], v[80:83], v[44:47], v[236:239]
  v_mfma_f32_16x16x32_f16 v[240:243], v[144:147], v[44:47], v[240:243]
  ds_read_b128 v[60:63], v6 offset:3008
  v_mfma_f32_16x16x32_f16 v[244:247], v[208:211], v[44:47], v[244:247]
  s_waitcnt lgkmcnt(4)
  v_mfma_f32_16x16x32_f16 v[236:239], v[76:79], v[48:51], v[236:239]
  v_mfma_f32_16x16x32_f16 v[240:243], v[140:143], v[48:51], v[240:243]
  ds_read_b128 v[32:35], v6 offset:3072
  v_mfma_f32_16x16x32_f16 v[244:247], v[204:207], v[48:51], v[244:247]
  s_waitcnt lgkmcnt(4)
  v_mfma_f32_16x16x32_f16 v[236:239], v[72:75], v[52:55], v[236:239]
  ds_read_b128 v[36:39], v6 offset:3136
  v_mfma_f32_16x16x32_f16 v[240:243], v[136:139], v[52:55], v[240:243]
  v_mfma_f32_16x16x32_f16 v[244:247], v[200:203], v[52:55], v[244:247]
  ds_read_b128 v[40:43], v6 offset:3200
  s_waitcnt lgkmcnt(5)
  v_mfma_f32_16x16x32_f16 v[236:239], v[68:71], v[56:59], v[236:239]
  v_mfma_f32_16x16x32_f16 v[240:243], v[132:135], v[56:59], v[240:243]
  ds_read_b128 v[44:47], v6 offset:3264
  v_mfma_f32_16x16x32_f16 v[244:247], v[196:199], v[56:59], v[244:247]
  s_waitcnt lgkmcnt(4)
  v_mfma_f32_16x16x32_f16 v[236:239], v[64:67], v[60:63], v[236:239]
  ds_read_b128 v[48:51], v6 offset:3328
  v_mfma_f32_16x16x32_f16 v[240:243], v[128:131], v[60:63], v[240:243]
  v_mfma_f32_16x16x32_f16 v[244:247], v[192:195], v[60:63], v[244:247]
  ds_read_b128 v[52:55], v6 offset:3392
  s_waitcnt lgkmcnt(5)
  v_mfma_f32_16x16x32_f16 v[240:243], v[92:95], v[32:35], v[240:243]
  v_mfma_f32_16x16x32_f16 v[244:247], v[156:159], v[32:35], v[244:247]
  ds_read_b128 v[56:59], v6 offset:3456
  s_waitcnt lgkmcnt(5)
  v_mfma_f32_16x16x32_f16 v[240:243], v[88:91], v[36:39], v[240:243]
  v_mfma_f32_16x16x32_f16 v[244:247], v[152:155], v[36:39], v[244:247]
  ds_read_b128 v[60:63], v6 offset:3520
  s_waitcnt lgkmcnt(5)
  v_mfma_f32_16x16x32_f16 v[240:243], v[84:87], v[40:43], v[240:243]
  v_mfma_f32_16x16x32_f16 v[244:247], v[148:151], v[40:43], v[244:247]
  ds_read_b128 v[32:35], v6 offset:3584
  s_waitcnt lgkmcnt(5)
  v_mfma_f32_16x16x32_f16 v[240:243], v[80:83], v[44:47], v[240:243]
  ds_write_b128 v8, v[236:239] offset:15360
  ds_read_b128 v[36:39], v6 offset:3648
  v_mfma_f32_16x16x32_f16 v[244:247], v[144:147], v[44:47], v[244:247]
  ds_read_b128 v[40:43], v6 offset:3712
  s_waitcnt lgkmcnt(7)
  v_mfma_f32_16x16x32_f16 v[240:243], v[76:79], v[48:51], v[240:243]
  ds_read_b128 v[44:47], v6 offset:3776
  v_mfma_f32_16x16x32_f16 v[244:247], v[140:143], v[48:51], v[244:247]
  ds_read_b128 v[48:51], v6 offset:3840
  s_waitcnt lgkmcnt(8)
  v_mfma_f32_16x16x32_f16 v[240:243], v[72:75], v[52:55], v[240:243]
  v_mfma_f32_16x16x32_f16 v[244:247], v[136:139], v[52:55], v[244:247]
  ds_read_b128 v[52:55], v6 offset:3904
  s_waitcnt lgkmcnt(8)
  v_mfma_f32_16x16x32_f16 v[240:243], v[68:71], v[56:59], v[240:243]
  v_mfma_f32_16x16x32_f16 v[244:247], v[132:135], v[56:59], v[244:247]
  ds_read_b128 v[56:59], v6 offset:3968
  s_waitcnt lgkmcnt(8)
  v_mfma_f32_16x16x32_f16 v[240:243], v[64:67], v[60:63], v[240:243]
  v_mfma_f32_16x16x32_f16 v[244:247], v[128:131], v[60:63], v[244:247]
  ds_read_b128 v[60:63], v6 offset:4032
  s_waitcnt lgkmcnt(8)
  v_mfma_f32_16x16x32_f16 v[244:247], v[92:95], v[32:35], v[244:247]
  s_waitcnt lgkmcnt(6)
  v_mfma_f32_16x16x32_f16 v[244:247], v[88:91], v[36:39], v[244:247]
  s_waitcnt lgkmcnt(5)
  v_mfma_f32_16x16x32_f16 v[244:247], v[84:87], v[40:43], v[244:247]
  s_waitcnt lgkmcnt(4)
  v_mfma_f32_16x16x32_f16 v[244:247], v[80:83], v[44:47], v[244:247]
  s_waitcnt lgkmcnt(3)
  v_mfma_f32_16x16x32_f16 v[244:247], v[76:79], v[48:51], v[244:247]
  s_waitcnt lgkmcnt(2)
  v_mfma_f32_16x16x32_f16 v[244:247], v[72:75], v[52:55], v[244:247]
  s_waitcnt lgkmcnt(1)
  v_mfma_f32_16x16x32_f16 v[244:247], v[68:71], v[56:59], v[244:247]
  s_waitcnt lgkmcnt(0)
  v_mfma_f32_16x16x32_f16 v[244:247], v[64:67], v[60:63], v[244:247]
  ds_write_b128 v8, v[240:243] offset:16384
  s_nop 7
  ds_write_b128 v8, v[244:247] offset:17408
  s_branch M_FIN
M_RUNK0:
  ds_read_b128 v[32:35], v6 offset:0
  ds_read2_b64 v[16:19], v4 offset0:0 offset1:1
  ds_read_b128 v[36:39], v6 offset:64
  ds_read2_b64 v[20:23], v4 offset0:8 offset1:9
  ds_read_b128 v[40:43], v6 offset:128
  ds_read2_b64 v[84:87], v5 offset0:208 offset1:209
  ds_read2_b64 v[24:27], v4 offset0:16 offset1:17
  ds_read_b128 v[44:47], v6 offset:192
  ds_read2_b64 v[80:83], v5 offset0:216 offset1:217
  ds_read2_b64 v[28:31], v4 offset0:24 offset1:25
  ds_read_b128 v[48:51], v6 offset:256
  ds_read2_b64 v[76:79], v5 offset0:224 offset1:225
  ds_read2_b64 v[232:235], v4 offset0:32 offset1:33
  ds_read_b128 v[52:55], v6 offset:320
  ds_read2_b64 v[72:75], v5 offset0:232 offset1:233
  s_waitcnt lgkmcnt(14)
  v_mfma_f32_16x16x32_f16 v[224:227], v[92:95], v[32:35], 0
  ds_read2_b64 v[236:239], v4 offset0:40 offset1:41
  s_waitcnt lgkmcnt(14)
  v_mfma_f32_16x16x32_f16 v[228:231], v[16:19], v[32:35], 0
  ds_read_b128 v[56:59], v6 offset:384
  ds_read2_b64 v[68:71], v5 offset0:240 offset1:241
  s_waitcnt lgkmcnt(15)
  v_mfma_f32_16x16x32_f16 v[224:227], v[88:91], v[36:39], v[224:227]
  ds_read2_b64 v[240:243], v4 offset0:48 offset1:49
  s_waitcnt lgkmcnt(15)
  v_mfma_f32_16x16x32_f16 v[228:231], v[20:23], v[36:39], v[228:231]
  ds_read_b128 v[60:63], v6 offset:448
  ds_read2_b64 v[64:67], v5 offset0:248 offset1:249
  s_waitcnt lgkmcnt(15)
  v_mfma_f32_16x16x32_f16 v[224:227], v[84:87], v[40:43], v[224:227]
  ds_read2_b64 v[244:247], v4 offset0:56 offset1:57
  s_waitcnt lgkmcnt(15)
  v_mfma_f32_16x16x32_f16 v[228:231], v[24:27], v[40:43], v[228:231]
  ds_read_b128 v[32:35], v6 offset:512
  ds_read2_b64 v[16:19], v4 offset0:64 offset1:65
  s_waitcnt lgkmcnt(15)
  v_mfma_f32_16x16x32_f16 v[224:227], v[80:83], v[44:47], v[224:227]
  ds_read_b128 v[36:39], v6 offset:576
  ds_read2_b64 v[20:23], v4 offset0:72 offset1:73
  s_waitcnt lgkmcnt(15)
  v_mfma_f32_16x16x32_f16 v[228:231], v[28:31], v[44:47], v[228:231]
  ds_read_b128 v[40:43], v6 offset:640
  ds_read2_b64 v[24:27], v4 offset0:80 offset1:81
  s_waitcnt lgkmcnt(15)
  v_mfma_f32_16x16x32_f16 v[224:227], v[76:79], v[48:51], v[224:227]
  ds_read_b128 v[44:47], v6 offset:704
  ds_read2_b64 v[28:31], v4 offset0:88 offset1:89
  v_mfma_f32_16x16x32_f16 v[228:231], v[232:235], v[48:51], v[228:231]
  ds_read_b128 v[48:51], v6 offset:768
  ds_read2_b64 v[232:235], v4 offset0:96 offset1:97
  s_waitcnt lgkmcnt(15)
  v_mfma_f32_16x16x32_f16 v[224:227], v[72:75], v[52:55], v[224:227]
  v_mfma_f32_16x16x32_f16 v[228:231], v[236:239], v[52:55], v[228:231]
  ds_read_b128 v[52:55], v6 offset:832
  ds_read2_b64 v[236:239], v4 offset0:104 offset1:105
  s_waitcnt lgkmcnt(15)
  v_mfma_f32_16x16x32_f16 v[224:227], v[68:71], v[56:59], v[224:227]
  v_mfma_f32_16x16x32_f16 v[228:231], v[240:243], v[56:59], v[228:231]
  ds_read_b128 v[56:59], v6 offset:896
  ds_read2_b64 v[240:243], v4 offset0:112 offset1:113
  s_waitcnt lgkmcnt(15)
  v_mfma_f32_16x16x32_f16 v[224:227], v[64:67], v[60:63], v[224:227]
  s_waitcnt lgkmcnt(14)
  v_mfma_f32_16x16x32_f16 v[228:231], v[244:247], v[60:63], v[228:231]
  ds_read_b128 v[60:63], v6 offset:960
  ds_read2_b64 v[244:247], v4 offset0:120 offset1:121
  s_waitcnt lgkmcnt(14)
  v_mfma_f32_16x16x32_f16 v[228:231], v[16:19], v[32:35], v[228:231]
  ds_read_b128 v[32:35], v6 offset:1024
  ds_read2_b64 v[16:19], v4 offset0:128 offset1:129
  s_waitcnt lgkmcnt(14)
  v_mfma_f32_16x16x32_f16 v[228:231], v[20:23], v[36:39], v[228:231]
  ds_read_b128 v[36:39], v6 offset:1088
  ds_read2_b64 v[20:23], v4 offset0:136 offset1:137
  s_waitcnt lgkmcnt(14)
  v_mfma_f32_16x16x32_f16 v[228:231], v[24:27], v[40:43], v[228:231]
  ds_read_b128 v[40:43], v6 offset:1152
  ds_read2_b64 v[24:27], v4 offset0:144 offset1:145
  s_waitcnt lgkmcnt(14)
  v_mfma_f32_16x16x32_f16 v[228:231], v[28:31], v[44:47], v[228:231]
  ds_read_b128 v[44:47], v6 offset:1216
  ds_read2_b64 v[28:31], v4 offset0:152 offset1:153
  s_waitcnt lgkmcnt(14)
  v_mfma_f32_16x16x32_f16 v[228:231], v[232:235], v[48:51], v[228:231]
  ds_read_b128 v[48:51], v6 offset:1280
  ds_read2_b64 v[232:235], v4 offset0:160 offset1:161
  s_waitcnt lgkmcnt(14)
  v_mfma_f32_16x16x32_f16 v[228:231], v[236:239], v[52:55], v[228:231]
  ds_read_b128 v[52:55], v6 offset:1344
  ds_read2_b64 v[236:239], v4 offset0:168 offset1:169
  s_waitcnt lgkmcnt(14)
  v_mfma_f32_16x16x32_f16 v[228:231], v[240:243], v[56:59], v[228:231]
  ds_read_b128 v[56:59], v6 offset:1408
  ds_read2_b64 v[240:243], v4 offset0:176 offset1:177
  s_waitcnt lgkmcnt(14)
  v_mfma_f32_16x16x32_f16 v[228:231], v[244:247], v[60:63], v[228:231]
  ds_read_b128 v[60:63], v6 offset:1472
  ds_read2_b64 v[244:247], v4 offset0:184 offset1:185
  s_waitcnt lgkmcnt(14)
  v_mfma_f32_16x16x32_f16 v[228:231], v[16:19], v[32:35], v[228:231]
  ds_read_b128 v[32:35], v6 offset:1536
  s_waitcnt lgkmcnt(13)
  v_mfma_f32_16x16x32_f16 v[228:231], v[20:23], v[36:39], v[228:231]
  ds_read_b128 v[36:39], v6 offset:1600
  s_waitcnt lgkmcnt(12)
  v_mfma_f32_16x16x32_f16 v[228:231], v[24:27], v[40:43], v[228:231]
  ds_read_b128 v[40:43], v6 offset:1664
  ds_read2_b64 v[212:215], v4 offset0:208 offset1:209
  s_waitcnt lgkmcnt(12)
  v_mfma_f32_16x16x32_f16 v[228:231], v[28:31], v[44:47], v[228:231]
  ds_read_b128 v[44:47], v6 offset:1728
  ds_read2_b64 v[208:211], v4 offset0:216 offset1:217
  s_waitcnt lgkmcnt(12)
  v_mfma_f32_16x16x32_f16 v[228:231], v[232:235], v[48:51], v[228:231]
  ds_read_b128 v[48:51], v6 offset:1792
  ds_read2_b64 v[204:207], v4 offset0:224 offset1:225
  s_waitcnt lgkmcnt(12)
  v_mfma_f32_16x16x32_f16 v[228:231], v[236:239], v[52:55], v[228:231]
  ds_read_b128 v[52:55], v6 offset:1856
  ds_read2_b64 v[200:203], v4 offset0:232 offset1:233
  s_waitcnt lgkmcnt(12)
  v_mfma_f32_16x16x32_f16 v[228:231], v[240:243], v[56:59], v[228:231]
  ds_read_b128 v[56:59], v6 offset:1920
  ds_read2_b64 v[196:199], v4 offset0:240 offset1:241
  s_waitcnt lgkmcnt(12)
  v_mfma_f32_16x16x32_f16 v[228:231], v[244:247], v[60:63], v[228:231]
  ds_read_b128 v[60:63], v6 offset:1984
  ds_read2_b64 v[192:195], v4 offset0:248 offset1:249
  s_waitcnt lgkmcnt(13)
  v_mfma_f32_16x16x32_f16 v[228:231], v[220:223], v[32:35], v[228:231]
  ds_read_b128 v[32:35], v6 offset:2048
  s_waitcnt lgkmcnt(13)
  v_mfma_f32_16x16x32_f16 v[228:231], v[216:219], v[36:39], v[228:231]
  ds_read_b128 v[36:39], v6 offset:2112
  s_waitcnt lgkmcnt(12)
  v_mfma_f32_16x16x32_f16 v[228:231], v[212:215], v[40:43], v[228:231]
  ds_read_b128 v[40:43], v6 offset:2176
  ds_read2_b64 v[180:183], v5 offset0:16 offset1:17
  s_waitcnt lgkmcnt(12)
  v_mfma_f32_16x16x32_f16 v[228:231], v[208:211], v[44:47], v[228:231]
  ds_read_b128 v[44:47], v6 offset:2240
  ds_read2_b64 v[176:179], v5 offset0:24 offset1:25
  s_waitcnt lgkmcnt(12)
  v_mfma_f32_16x16x32_f16 v[228:231], v[204:207], v[48:51], v[228:231]
  ds_read_b128 v[48:51], v6 offset:2304
  ds_read2_b64 v[172:175], v5 offset0:32 offset1:33
  s_waitcnt lgkmcnt(12)
  v_mfma_f32_16x16x32_f16 v[228:231], v[200:203], v[52:55], v[228:231]
  ds_read_b128 v[52:55], v6 offset:2368
  ds_read2_b64 v[168:171], v5 offset0:40 offset1:41
  s_waitcnt lgkmcnt(12)
  v_mfma_f32_16x16x32_f16 v[228:231], v[196:199], v[56:59], v[228:231]
  ds_read_b128 v[56:59], v6 offset:2432
  ds_read2_b64 v[164:167], v5 offset0:48 offset1:49
  s_waitcnt lgkmcnt(12)
  v_mfma_f32_16x16x32_f16 v[228:231], v[192:195], v[60:63], v[228:231]
  ds_read_b128 v[60:63], v6 offset:2496
  ds_read2_b64 v[160:163], v5 offset0:56 offset1:57
  s_waitcnt lgkmcnt(13)
  v_mfma_f32_16x16x32_f16 v[228:231], v[188:191], v[32:35], v[228:231]
  ds_read_b128 v[32:35], v6 offset:2560
  s_waitcnt lgkmcnt(13)
  v_mfma_f32_16x16x32_f16 v[228:231], v[184:187], v[36:39], v[228:231]
  ds_read_b128 v[36:39], v6 offset:2624
  s_waitcnt lgkmcnt(12)
  v_mfma_f32_16x16x32_f16 v[228:231], v[180:183], v[40:43], v[228:231]
  ds_read_b128 v[40:43], v6 offset:2688
  ds_read2_b64 v[148:151], v5 offset0:80 offset1:81
  s_waitcnt lgkmcnt(12)
  v_mfma_f32_16x16x32_f16 v[228:231], v[176:179], v[44:47], v[228:231]
  ds_read_b128 v[44:47], v6 offset:2752
  ds_read2_b64 v[144:147], v5 offset0:88 offset1:89
  s_waitcnt lgkmcnt(12)
  v_mfma_f32_16x16x32_f16 v[228:231], v[172:175], v[48:51], v[228:231]
  ds_read_b128 v[48:51], v6 offset:2816
  ds_read2_b64 v[140:143], v5 offset0:96 offset1:97
  s_waitcnt lgkmcnt(12)
  v_mfma_f32_16x16x32_f16 v[228:231], v[168:171], v[52:55], v[228:231]
  ds_read_b128 v[52:55], v6 offset:2880
  ds_read2_b64 v[136:139], v5 offset0:104 offset1:105
  s_waitcnt lgkmcnt(12)
  v_mfma_f32_16x16x32_f16 v[228:231], v[164:167], v[56:59], v[228:231]
  ds_read_b128 v[56:59], v6 offset:2944
  ds_read2_b64 v[132:135], v5 offset0:112 offset1:113
  s_waitcnt lgkmcnt(12)
  v_mfma_f32_16x16x32_f16 v[228:231], v[160:163], v[60:63], v[228:231]
  ds_read_b128 v[60:63], v6 offset:3008
  ds_read2_b64 v[128:131], v5 offset0:120 offset1:121
  s_waitcnt lgkmcnt(13)
  v_mfma_f32_16x16x32_f16 v[228:231], v[156:159], v[32:35], v[228:231]
  ds_read_b128 v[32:35], v6 offset:3072
  s_waitcnt lgkmcnt(13)
  v_mfma_f32_16x16x32_f16 v[228:231], v[152:155], v[36:39], v[228:231]
  ds_read_b128 v[36:39], v6 offset:3136
  s_waitcnt lgkmcnt(12)
  v_mfma_f32_16x16x32_f16 v[228:231], v[148:151], v[40:43], v[228:231]
  ds_read_b128 v[40:43], v6 offset:3200
  ds_read2_b64 v[116:119], v5 offset0:144 offset1:145
  s_waitcnt lgkmcnt(12)
  v_mfma_f32_16x16x32_f16 v[228:231], v[144:147], v[44:47], v[228:231]
  ds_read_b128 v[44:47], v6 offset:3264
  ds_read2_b64 v[112:115], v5 offset0:152 offset1:153
  s_waitcnt lgkmcnt(12)
  v_mfma_f32_16x16x32_f16 v[228:231], v[140:143], v[48:51], v[228:231]
  ds_read_b128 v[48:51], v6 offset:3328
  ds_read2_b64 v[108:111], v5 offset0:160 offset1:161
  s_waitcnt lgkmcnt(12)
  v_mfma_f32_16x16x32_f16 v[228:231], v[136:139], v[52:55], v[228:231]
  ds_read_b128 v[52:55], v6 offset:3392
  ds_read2_b64 v[104:107], v5 offset0:168 offset1:169
  s_waitcnt lgkmcnt(12)
  v_mfma_f32_16x16x32_f16 v[228:231], v[132:135], v[56:59], v[228:231]
  ds_read_b128 v[56:59], v6 offset:3456
  ds_read2_b64 v[100:103], v5 offset0:176 offset1:177
  s_waitcnt lgkmcnt(12)
  v_mfma_f32_16x16x32_f16 v[228:231], v[128:131], v[60:63], v[228:231]
  ds_read_b128 v[60:63], v6 offset:3520
  ds_read2_b64 v[96:99], v5 offset0:184 offset1:185
  s_waitcnt lgkmcnt(13)
  v_mfma_f32_16x16x32_f16 v[228:231], v[124:127], v[32:35], v[228:231]
  ds_read_b128 v[32:35], v6 offset:3584
  s_waitcnt lgkmcnt(13)
  v_mfma_f32_16x16x32_f16 v[228:231], v[120:123], v[36:39], v[228:231]
  ds_read_b128 v[36:39], v6 offset:3648
  s_waitcnt lgkmcnt(12)
  v_mfma_f32_16x16x32_f16 v[228:231], v[116:119], v[40:43], v[228:231]
  ds_read_b128 v[40:43], v6 offset:3712
  s_waitcnt lgkmcnt(11)
  v_mfma_f32_16x16x32_f16 v[228:231], v[112:115], v[44:47], v[228:231]
  ds_read_b128 v[44:47], v6 offset:3776
  s_waitcnt lgkmcnt(10)
  v_mfma_f32_16x16x32_f16 v[228:231], v[108:111], v[48:51], v[228:231]
  ds_read_b128 v[48:51], v6 offset:3840
  s_waitcnt lgkmcnt(9)
  v_mfma_f32_16x16x32_f16 v[228:231], v[104:107], v[52:55], v[228:231]
  ds_read_b128 v[52:55], v6 offset:3904
  s_waitcnt lgkmcnt(8)
  v_mfma_f32_16x16x32_f16 v[228:231], v[100:103], v[56:59], v[228:231]
  ds_read_b128 v[56:59], v6 offset:3968
  s_waitcnt lgkmcnt(7)
  v_mfma_f32_16x16x32_f16 v[228:231], v[96:99], v[60:63], v[228:231]
  ds_read_b128 v[60:63], v6 offset:4032
  s_waitcnt lgkmcnt(7)
  v_mfma_f32_16x16x32_f16 v[228:231], v[92:95], v[32:35], v[228:231]
  s_waitcnt lgkmcnt(6)
  v_mfma_f32_16x16x32_f16 v[228:231], v[88:91], v[36:39], v[228:231]
  s_waitcnt lgkmcnt(5)
  v_mfma_f32_16x16x32_f16 v[228:231], v[84:87], v[40:43], v[228:231]
  s_waitcnt lgkmcnt(4)
  v_mfma_f32_16x16x32_f16 v[228:231], v[80:83], v[44:47], v[228:231]
  s_waitcnt lgkmcnt(3)
  v_mfma_f32_16x16x32_f16 v[228:231], v[76:79], v[48:51], v[228:231]
  s_waitcnt lgkmcnt(2)
  v_mfma_f32_16x16x32_f16 v[228:231], v[72:75], v[52:55], v[228:231]
  s_waitcnt lgkmcnt(1)
  v_mfma_f32_16x16x32_f16 v[228:231], v[68:71], v[56:59], v[228:231]
  s_waitcnt lgkmcnt(0)
  v_mfma_f32_16x16x32_f16 v[228:231], v[64:67], v[60:63], v[228:231]
  s_nop 7
  ds_read_b32 v40, v248 offset:40
  ds_read_b32 v41, v248 offset:56
  ds_read_b32 v42, v248 offset:72
  ds_read_b32 v43, v248 offset:88
  ds_read_b64 v[44:45], v3 offset:9216
  ds_read_b64 v[46:47], v3 offset:12800
  v_and_b32 v16, 15, v2
  v_mul_u32_u24 v16, 96, v16
  v_lshrrev_b32 v17, 5, v2
  v_mul_u32_u24 v17, 48, v17
  v_bfe_u32 v18, v2, 4, 1
  v_lshl_add_u32 v17, v18, 3, v17
  v_add_u32 v16, v16, v17
  v_add_u32 v16, 69152, v16
  s_waitcnt lgkmcnt(0)
  v_ldexp_f32 v43, v43, v42

  v_mul_f32 v224, v43, v224
  v_mul_f32 v225, v43, v225
  v_mul_f32 v226, v43, v226
  v_mul_f32 v227, v43, v227
  v_mul_f32 v228, v43, v228
  v_mul_f32 v229, v43, v229
  v_mul_f32 v230, v43, v230
  v_mul_f32 v231, v43, v231
  v_fma_mix_f32 v48, v44, v40, 0 op_sel:[0,0,0] op_sel_hi:[1,0,0]
  v_fma_mix_f32 v49, v44, v40, 0 op_sel:[1,0,0] op_sel_hi:[1,0,0]
  v_fma_mix_f32 v50, v45, v40, 0 op_sel:[0,0,0] op_sel_hi:[1,0,0]
  v_fma_mix_f32 v51, v45, v40, 0 op_sel:[1,0,0] op_sel_hi:[1,0,0]
  v_fma_mix_f32 v52, v46, v40, 0 op_sel:[0,0,0] op_sel_hi:[1,0,0]
  v_fma_mix_f32 v53, v46, v40, 0 op_sel:[1,0,0] op_sel_hi:[1,0,0]
  v_fma_mix_f32 v54, v47, v40, 0 op_sel:[0,0,0] op_sel_hi:[1,0,0]
  v_fma_mix_f32 v55, v47, v40, 0 op_sel:[1,0,0] op_sel_hi:[1,0,0]
  v_cvt_pk_bf16_f32 v225, v224, v225
  v_cvt_pk_bf16_f32 v227, v226, v227
  v_cvt_pk_bf16_f32 v229, v228, v229
  v_cvt_pk_bf16_f32 v231, v230, v231
  v_cvt_pk_bf16_f32 v49, v48, v49
  v_cvt_pk_bf16_f32 v51, v50, v51
  v_cvt_pk_bf16_f32 v53, v52, v53
  v_cvt_pk_bf16_f32 v55, v54, v55
  v_lshlrev_b32 v224, 16, v225
  v_and_b32 v225, 0xffff0000, v225
  v_lshlrev_b32 v226, 16, v227
  v_and_b32 v227, 0xffff0000, v227
  v_lshlrev_b32 v228, 16, v229
  v_and_b32 v229, 0xffff0000, v229
  v_lshlrev_b32 v230, 16, v231
  v_and_b32 v231, 0xffff0000, v231
  v_lshlrev_b32 v48, 16, v49
  v_and_b32 v49, 0xffff0000, v49
  v_lshlrev_b32 v50, 16, v51
  v_and_b32 v51, 0xffff0000, v51
  v_lshlrev_b32 v52, 16, v53
  v_and_b32 v53, 0xffff0000, v53
  v_lshlrev_b32 v54, 16, v55
  v_and_b32 v55, 0xffff0000, v55
  v_add_f32 v224, v224, v48
  v_add_f32 v225, v225, v49
  v_add_f32 v226, v226, v50
  v_add_f32 v227, v227, v51
  v_add_f32 v228, v228, v52
  v_add_f32 v229, v229, v53
  v_add_f32 v230, v230, v54
  v_add_f32 v231, v231, v55
  v_cvt_pk_bf16_f32 v225, v224, v225
  v_cvt_pk_bf16_f32 v227, v226, v227
  v_cvt_pk_bf16_f32 v229, v228, v229
  v_cvt_pk_bf16_f32 v231, v230, v231
  v_lshlrev_b32 v224, 16, v225
  v_and_b32 v225, 0xffff0000, v225
  v_lshlrev_b32 v226, 16, v227
  v_and_b32 v227, 0xffff0000, v227
  v_lshlrev_b32 v228, 16, v229
  v_and_b32 v229, 0xffff0000, v229
  v_lshlrev_b32 v230, 16, v231
  v_and_b32 v231, 0xffff0000, v231
  v_mul_f32 v224, v41, v224
  v_mul_f32 v225, v41, v225
  v_mul_f32 v226, v41, v226
  v_mul_f32 v227, v41, v227
  v_mul_f32 v228, v41, v228
  v_mul_f32 v229, v41, v229
  v_mul_f32 v230, v41, v230
  v_mul_f32 v231, v41, v231
  v_cvt_pk_bf16_f32 v48, v224, v225
  v_cvt_pk_bf16_f32 v49, v226, v227
  v_cvt_pk_bf16_f32 v50, v228, v229
  v_cvt_pk_bf16_f32 v51, v230, v231
  ds_write_b64 v16, v[48:49] offset:0
  ds_write_b64 v16, v[50:51] offset:10752
  s_branch M_FIN
M_RUNK1:
  ds_read_b128 v[32:35], v6 offset:0
  ds_read2_b64 v[16:19], v4 offset0:64 offset1:65
  ds_read_b128 v[36:39], v6 offset:64
  ds_read2_b64 v[20:23], v4 offset0:72 offset1:73
  ds_read_b128 v[40:43], v6 offset:128
  ds_read2_b64 v[116:119], v5 offset0:144 offset1:145
  ds_read2_b64 v[24:27], v4 offset0:80 offset1:81
  ds_read_b128 v[44:47], v6 offset:192
  ds_read2_b64 v[112:115], v5 offset0:152 offset1:153
  ds_read2_b64 v[28:31], v4 offset0:88 offset1:89
  ds_read_b128 v[48:51], v6 offset:256
  ds_read2_b64 v[108:111], v5 offset0:160 offset1:161
  ds_read2_b64 v[232:235], v4 offset0:96 offset1:97
  ds_read_b128 v[52:55], v6 offset:320
  ds_read2_b64 v[104:107], v5 offset0:168 offset1:169
  s_waitcnt lgkmcnt(14)
  v_mfma_f32_16x16x32_f16 v[224:227], v[124:127], v[32:35], 0
  ds_read2_b64 v[236:239], v4 offset0:104 offset1:105
  s_waitcnt lgkmcnt(14)
  v_mfma_f32_16x16x32_f16 v[228:231], v[16:19], v[32:35], 0
  ds_read_b128 v[56:59], v6 offset:384
  ds_read2_b64 v[100:103], v5 offset0:176 offset1:177
  s_waitcnt lgkmcnt(15)
  v_mfma_f32_16x16x32_f16 v[224:227], v[120:123], v[36:39], v[224:227]
  ds_read2_b64 v[240:243], v4 offset0:112 offset1:113
  s_waitcnt lgkmcnt(15)
  v_mfma_f32_16x16x32_f16 v[228:231], v[20:23], v[36:39], v[228:231]
  ds_read_b128 v[60:63], v6 offset:448
  ds_read2_b64 v[96:99], v5 offset0:184 offset1:185
  s_waitcnt lgkmcnt(15)
  v_mfma_f32_16x16x32_f16 v[224:227], v[116:119], v[40:43], v[224:227]
  ds_read2_b64 v[244:247], v4 offset0:120 offset1:121
  s_waitcnt lgkmcnt(15)
  v_mfma_f32_16x16x32_f16 v[228:231], v[24:27], v[40:43], v[228:231]
  ds_read_b128 v[32:35], v6 offset:512
  s_waitcnt lgkmcnt(14)
  v_mfma_f32_16x16x32_f16 v[224:227], v[112:115], v[44:47], v[224:227]
  ds_read2_b64 v[16:19], v4 offset0:128 offset1:129
  s_waitcnt lgkmcnt(14)
  v_mfma_f32_16x16x32_f16 v[228:231], v[28:31], v[44:47], v[228:231]
  ds_read_b128 v[36:39], v6 offset:576
  s_waitcnt lgkmcnt(13)
  v_mfma_f32_16x16x32_f16 v[224:227], v[108:111], v[48:51], v[224:227]
  ds_read2_b64 v[20:23], v4 offset0:136 offset1:137
  s_waitcnt lgkmcnt(13)
  v_mfma_f32_16x16x32_f16 v[228:231], v[232:235], v[48:51], v[228:231]
  ds_read_b128 v[40:43], v6 offset:640
  ds_read2_b64 v[84:87], v5 offset0:208 offset1:209
  s_waitcnt lgkmcnt(13)
  v_mfma_f32_16x16x32_f16 v[224:227], v[104:107], v[52:55], v[224:227]
  ds_read2_b64 v[24:27], v4 offset0:144 offset1:145
  s_waitcnt lgkmcnt(13)
  v_mfma_f32_16x16x32_f16 v[228:231], v[236:239], v[52:55], v[228:231]
  ds_read_b128 v[44:47], v6 offset:704
  ds_read2_b64 v[80:83], v5 offset0:216 offset1:217
  s_waitcnt lgkmcnt(13)
  v_mfma_f32_16x16x32_f16 v[224:227], v[100:103], v[56:59], v[224:227]
  ds_read2_b64 v[28:31], v4 offset0:152 offset1:153
  s_waitcnt lgkmcnt(13)
  v_mfma_f32_16x16x32_f16 v[228:231], v[240:243], v[56:59], v[228:231]
  ds_read_b128 v[48:51], v6 offset:768
  ds_read2_b64 v[76:79], v5 offset0:224 offset1:225
  s_waitcnt lgkmcnt(13)
  v_mfma_f32_16x16x32_f16 v[224:227], v[96:99], v[60:63], v[224:227]
  ds_read2_b64 v[232:235], v4 offset0:160 offset1:161
  s_waitcnt lgkmcnt(13)
  v_mfma_f32_16x16x32_f16 v[228:231], v[244:247], v[60:63], v[228:231]
  ds_read_b128 v[52:55], v6 offset:832
  ds_read2_b64 v[72:75], v5 offset0:232 offset1:233
  s_waitcnt lgkmcnt(14)
  v_mfma_f32_16x16x32_f16 v[224:227], v[92:95], v[32:35], v[224:227]
  ds_read2_b64 v[236:239], v4 offset0:168 offset1:169
  s_waitcnt lgkmcnt(14)
  v_mfma_f32_16x16x32_f16 v[228:231], v[16:19], v[32:35], v[228:231]
  ds_read_b128 v[56:59], v6 offset:896
  ds_read2_b64 v[68:71], v5 offset0:240 offset1:241
  s_waitcnt lgkmcnt(15)
  v_mfma_f32_16x16x32_f16 v[224:227], v[88:91], v[36:39], v[224:227]
  ds_read2_b64 v[240:243], v4 offset0:176 offset1:177
  s_waitcnt lgkmcnt(15)
  v_mfma_f32_16x16x32_f16 v[228:231], v[20:23], v[36:39], v[228:231]
  ds_read_b128 v[60:63], v6 offset:960
  ds_read2_b64 v[64:67], v5 offset0:248 offset1:249
  s_waitcnt lgkmcnt(15)
  v_mfma_f32_16x16x32_f16 v[224:227], v[84:87], v[40:43], v[224:227]
  ds_read2_b64 v[244:247], v4 offset0:184 offset1:185
  s_waitcnt lgkmcnt(15)
  v_mfma_f32_16x16x32_f16 v[228:231], v[24:27], v[40:43], v[228:231]
  ds_read_b128 v[32:35], v6 offset:1024
  s_waitcnt lgkmcnt(14)
  v_mfma_f32_16x16x32_f16 v[224:227], v[80:83], v[44:47], v[224:227]
  ds_read_b128 v[36:39], v6 offset:1088
  s_waitcnt lgkmcnt(14)
  v_mfma_f32_16x16x32_f16 v[228:231], v[28:31], v[44:47], v[228:231]
  ds_read_b128 v[40:43], v6 offset:1152
  ds_read2_b64 v[212:215], v4 offset0:208 offset1:209
  s_waitcnt lgkmcnt(14)
  v_mfma_f32_16x16x32_f16 v[224:227], v[76:79], v[48:51], v[224:227]
  ds_read_b128 v[44:47], v6 offset:1216
  ds_read2_b64 v[208:211], v4 offset0:216 offset1:217
  s_waitcnt lgkmcnt(15)
  v_mfma_f32_16x16x32_f16 v[228:231], v[232:235], v[48:51], v[228:231]
  ds_read_b128 v[48:51], v6 offset:1280
  ds_read2_b64 v[204:207], v4 offset0:224 offset1:225
  s_waitcnt lgkmcnt(15)
  v_mfma_f32_16x16x32_f16 v[224:227], v[72:75], v[52:55], v[224:227]
  s_waitcnt lgkmcnt(14)
  v_mfma_f32_16x16x32_f16 v[228:231], v[236:239], v[52:55], v[228:231]
  ds_read_b128 v[52:55], v6 offset:1344
  ds_read2_b64 v[200:203], v4 offset0:232 offset1:233
  s_waitcnt lgkmcnt(14)
  v_mfma_f32_16x16x32_f16 v[224:227], v[68:71], v[56:59], v[224:227]
  s_waitcnt lgkmcnt(13)
  v_mfma_f32_16x16x32_f16 v[228:231], v[240:243], v[56:59], v[228:231]
  ds_read_b128 v[56:59], v6 offset:1408
  ds_read2_b64 v[196:199], v4 offset0:240 offset1:241
  s_waitcnt lgkmcnt(13)
  v_mfma_f32_16x16x32_f16 v[224:227], v[64:67], v[60:63], v[224:227]
  s_waitcnt lgkmcnt(12)
  v_mfma_f32_16x16x32_f16 v[228:231], v[244:247], v[60:63], v[228:231]
  ds_read_b128 v[60:63], v6 offset:1472
  ds_read2_b64 v[192:195], v4 offset0:248 offset1:249
  s_waitcnt lgkmcnt(13)
  v_mfma_f32_16x16x32_f16 v[228:231], v[220:223], v[32:35], v[228:231]
  ds_read_b128 v[32:35], v6 offset:1536
  s_waitcnt lgkmcnt(13)
  v_mfma_f32_16x16x32_f16 v[228:231], v[216:219], v[36:39], v[228:231]
  ds_read_b128 v[36:39], v6 offset:1600
  s_waitcnt lgkmcnt(12)
  v_mfma_f32_16x16x32_f16 v[228:231], v[212:215], v[40:43], v[228:231]
  ds_read_b128 v[40:43], v6 offset:1664
  ds_read2_b64 v[180:183], v5 offset0:16 offset1:17
  s_waitcnt lgkmcnt(12)
  v_mfma_f32_16x16x32_f16 v[228:231], v[208:211], v[44:47], v[228:231]
  ds_read_b128 v[44:47], v6 offset:1728
  ds_read2_b64 v[176:179], v5 offset0:24 offset1:25
  s_waitcnt lgkmcnt(12)
  v_mfma_f32_16x16x32_f16 v[228:231], v[204:207], v[48:51], v[228:231]
  ds_read_b128 v[48:51], v6 offset:1792
  ds_read2_b64 v[172:175], v5 offset0:32 offset1:33
  s_waitcnt lgkmcnt(12)
  v_mfma_f32_16x16x32_f16 v[228:231], v[200:203], v[52:55], v[228:231]
  ds_read_b128 v[52:55], v6 offset:1856
  ds_read2_b64 v[168:171], v5 offset0:40 offset1:41
  s_waitcnt lgkmcnt(12)
  v_mfma_f32_16x16x32_f16 v[228:231], v[196:199], v[56:59], v[228:231]
  ds_read_b128 v[56:59], v6 offset:1920
  ds_read2_b64 v[164:167], v5 offset0:48 offset1:49
  s_waitcnt lgkmcnt(12)
  v_mfma_f32_16x16x32_f16 v[228:231], v[192:195], v[60:63], v[228:231]
  ds_read_b128 v[60:63], v6 offset:1984
  ds_read2_b64 v[160:163], v5 offset0:56 offset1:57
  s_waitcnt lgkmcnt(13)
  v_mfma_f32_16x16x32_f16 v[228:231], v[188:191], v[32:35], v[228:231]
  ds_read_b128 v[32:35], v6 offset:2048
  s_waitcnt lgkmcnt(13)
  v_mfma_f32_16x16x32_f16 v[228:231], v[184:187], v[36:39], v[228:231]
  ds_read_b128 v[36:39], v6 offset:2112
  s_waitcnt lgkmcnt(12)
  v_mfma_f32_16x16x32_f16 v[228:231], v[180:183], v[40:43], v[228:231]
  ds_read_b128 v[40:43], v6 offset:2176
  ds_read2_b64 v[148:151], v5 offset0:80 offset1:81
  s_waitcnt lgkmcnt(12)
  v_mfma_f32_16x16x32_f16 v[228:231], v[176:179], v[44:47], v[228:231]
  ds_read_b128 v[44:47], v6 offset:2240
  ds_read2_b64 v[144:147], v5 offset0:88 offset1:89
  s_waitcnt lgkmcnt(12)
  v_mfma_f32_16x16x32_f16 v[228:231], v[172:175], v[48:51], v[228:231]
  ds_read_b128 v[48:51], v6 offset:2304
  ds_read2_b64 v[140:143], v5 offset0:96 offset1:97
  s_waitcnt lgkmcnt(12)
  v_mfma_f32_16x16x32_f16 v[228:231], v[168:171], v[52:55], v[228:231]
  ds_read_b128 v[52:55], v6 offset:2368
  ds_read2_b64 v[136:139], v5 offset0:104 offset1:105
  s_waitcnt lgkmcnt(12)
  v_mfma_f32_16x16x32_f16 v[228:231], v[164:167], v[56:59], v[228:231]
  ds_read_b128 v[56:59], v6 offset:2432
  ds_read2_b64 v[132:135], v5 offset0:112 offset1:113
  s_waitcnt lgkmcnt(12)
  v_mfma_f32_16x16x32_f16 v[228:231], v[160:163], v[60:63], v[228:231]
  ds_read_b128 v[60:63], v6 offset:2496
  ds_read2_b64 v[128:131], v5 offset0:120 offset1:121
  s_waitcnt lgkmcnt(13)
  v_mfma_f32_16x16x32_f16 v[228:231], v[156:159], v[32:35], v[228:231]
  ds_read_b128 v[32:35], v6 offset:2560
  s_waitcnt lgkmcnt(13)
  v_mfma_f32_16x16x32_f16 v[228:231], v[152:155], v[36:39], v[228:231]
  ds_read_b128 v[36:39], v6 offset:2624
  s_waitcnt lgkmcnt(12)
  v_mfma_f32_16x16x32_f16 v[228:231], v[148:151], v[40:43], v[228:231]
  ds_read_b128 v[40:43], v6 offset:2688
  s_waitcnt lgkmcnt(11)
  v_mfma_f32_16x16x32_f16 v[228:231], v[144:147], v[44:47], v[228:231]
  ds_read_b128 v[44:47], v6 offset:2752
  s_waitcnt lgkmcnt(10)
  v_mfma_f32_16x16x32_f16 v[228:231], v[140:143], v[48:51], v[228:231]
  ds_read_b128 v[48:51], v6 offset:2816
  s_waitcnt lgkmcnt(9)
  v_mfma_f32_16x16x32_f16 v[228:231], v[136:139], v[52:55], v[228:231]
  ds_read_b128 v[52:55], v6 offset:2880
  s_waitcnt lgkmcnt(8)
  v_mfma_f32_16x16x32_f16 v[228:231], v[132:135], v[56:59], v[228:231]
  ds_read_b128 v[56:59], v6 offset:2944
  s_waitcnt lgkmcnt(7)
  v_mfma_f32_16x16x32_f16 v[228:231], v[128:131], v[60:63], v[228:231]
  ds_read_b128 v[60:63], v6 offset:3008
  s_waitcnt lgkmcnt(7)
  v_mfma_f32_16x16x32_f16 v[228:231], v[124:127], v[32:35], v[228:231]
  ds_read_b128 v[32:35], v6 offset:3072
  s_waitcnt lgkmcnt(7)
  v_mfma_f32_16x16x32_f16 v[228:231], v[120:123], v[36:39], v[228:231]
  ds_read_b128 v[36:39], v6 offset:3136
  s_waitcnt lgkmcnt(7)
  v_mfma_f32_16x16x32_f16 v[228:231], v[116:119], v[40:43], v[228:231]
  ds_read_b128 v[40:43], v6 offset:3200
  s_waitcnt lgkmcnt(7)
  v_mfma_f32_16x16x32_f16 v[228:231], v[112:115], v[44:47], v[228:231]
  ds_read_b128 v[44:47], v6 offset:3264
  s_waitcnt lgkmcnt(7)
  v_mfma_f32_16x16x32_f16 v[228:231], v[108:111], v[48:51], v[228:231]
  ds_read_b128 v[48:51], v6 offset:3328
  s_waitcnt lgkmcnt(7)
  v_mfma_f32_16x16x32_f16 v[228:231], v[104:107], v[52:55], v[228:231]
  ds_read_b128 v[52:55], v6 offset:3392
  s_waitcnt lgkmcnt(7)
  v_mfma_f32_16x16x32_f16 v[228:231], v[100:103], v[56:59], v[228:231]
  ds_read_b128 v[56:59], v6 offset:3456
  s_waitcnt lgkmcnt(7)
  v_mfma_f32_16x16x32_f16 v[228:231], v[96:99], v[60:63], v[228:231]
  ds_read_b128 v[60:63], v6 offset:3520
  s_waitcnt lgkmcnt(7)
  v_mfma_f32_16x16x32_f16 v[228:231], v[92:95], v[32:35], v[228:231]
  s_waitcnt lgkmcnt(6)
  v_mfma_f32_16x16x32_f16 v[228:231], v[88:91], v[36:39], v[228:231]
  s_waitcnt lgkmcnt(5)
  v_mfma_f32_16x16x32_f16 v[228:231], v[84:87], v[40:43], v[228:231]
  s_waitcnt lgkmcnt(4)
  v_mfma_f32_16x16x32_f16 v[228:231], v[80:83], v[44:47], v[228:231]
  s_waitcnt lgkmcnt(3)
  v_mfma_f32_16x16x32_f16 v[228:231], v[76:79], v[48:51], v[228:231]
  s_waitcnt lgkmcnt(2)
  v_mfma_f32_16x16x32_f16 v[228:231], v[72:75], v[52:55], v[228:231]
  s_waitcnt lgkmcnt(1)
  v_mfma_f32_16x16x32_f16 v[228:231], v[68:71], v[56:59], v[228:231]
  s_waitcnt lgkmcnt(0)
  v_mfma_f32_16x16x32_f16 v[228:231], v[64:67], v[60:63], v[228:231]
  s_nop 7
  ds_read_b32 v40, v248 offset:40
  ds_read_b32 v41, v248 offset:56
  ds_read_b32 v42, v248 offset:72
  ds_read_b32 v43, v248 offset:88
  ds_read_b64 v[44:45], v3 offset:9728
  ds_read_b64 v[46:47], v3 offset:12288
  v_and_b32 v16, 15, v2
  v_mul_u32_u24 v16, 96, v16
  v_lshrrev_b32 v17, 5, v2
  v_mul_u32_u24 v17, 48, v17
  v_bfe_u32 v18, v2, 4, 1
  v_lshl_add_u32 v17, v18, 3, v17
  v_add_u32 v16, v16, v17
  v_add_u32 v16, 69152, v16
  s_waitcnt lgkmcnt(0)
  v_ldexp_f32 v43, v43, v42

  v_mul_f32 v224, v43, v224
  v_mul_f32 v225, v43, v225
  v_mul_f32 v226, v43, v226
  v_mul_f32 v227, v43, v227
  v_mul_f32 v228, v43, v228
  v_mul_f32 v229, v43, v229
  v_mul_f32 v230, v43, v230
  v_mul_f32 v231, v43, v231
  v_fma_mix_f32 v48, v44, v40, 0 op_sel:[0,0,0] op_sel_hi:[1,0,0]
  v_fma_mix_f32 v49, v44, v40, 0 op_sel:[1,0,0] op_sel_hi:[1,0,0]
  v_fma_mix_f32 v50, v45, v40, 0 op_sel:[0,0,0] op_sel_hi:[1,0,0]
  v_fma_mix_f32 v51, v45, v40, 0 op_sel:[1,0,0] op_sel_hi:[1,0,0]
  v_fma_mix_f32 v52, v46, v40, 0 op_sel:[0,0,0] op_sel_hi:[1,0,0]
  v_fma_mix_f32 v53, v46, v40, 0 op_sel:[1,0,0] op_sel_hi:[1,0,0]
  v_fma_mix_f32 v54, v47, v40, 0 op_sel:[0,0,0] op_sel_hi:[1,0,0]
  v_fma_mix_f32 v55, v47, v40, 0 op_sel:[1,0,0] op_sel_hi:[1,0,0]
  v_cvt_pk_bf16_f32 v225, v224, v225
  v_cvt_pk_bf16_f32 v227, v226, v227
  v_cvt_pk_bf16_f32 v229, v228, v229
  v_cvt_pk_bf16_f32 v231, v230, v231
  v_cvt_pk_bf16_f32 v49, v48, v49
  v_cvt_pk_bf16_f32 v51, v50, v51
  v_cvt_pk_bf16_f32 v53, v52, v53
  v_cvt_pk_bf16_f32 v55, v54, v55
  v_lshlrev_b32 v224, 16, v225
  v_and_b32 v225, 0xffff0000, v225
  v_lshlrev_b32 v226, 16, v227
  v_and_b32 v227, 0xffff0000, v227
  v_lshlrev_b32 v228, 16, v229
  v_and_b32 v229, 0xffff0000, v229
  v_lshlrev_b32 v230, 16, v231
  v_and_b32 v231, 0xffff0000, v231
  v_lshlrev_b32 v48, 16, v49
  v_and_b32 v49, 0xffff0000, v49
  v_lshlrev_b32 v50, 16, v51
  v_and_b32 v51, 0xffff0000, v51
  v_lshlrev_b32 v52, 16, v53
  v_and_b32 v53, 0xffff0000, v53
  v_lshlrev_b32 v54, 16, v55
  v_and_b32 v55, 0xffff0000, v55
  v_add_f32 v224, v224, v48
  v_add_f32 v225, v225, v49
  v_add_f32 v226, v226, v50
  v_add_f32 v227, v227, v51
  v_add_f32 v228, v228, v52
  v_add_f32 v229, v229, v53
  v_add_f32 v230, v230, v54
  v_add_f32 v231, v231, v55
  v_cvt_pk_bf16_f32 v225, v224, v225
  v_cvt_pk_bf16_f32 v227, v226, v227
  v_cvt_pk_bf16_f32 v229, v228, v229
  v_cvt_pk_bf16_f32 v231, v230, v231
  v_lshlrev_b32 v224, 16, v225
  v_and_b32 v225, 0xffff0000, v225
  v_lshlrev_b32 v226, 16, v227
  v_and_b32 v227, 0xffff0000, v227
  v_lshlrev_b32 v228, 16, v229
  v_and_b32 v229, 0xffff0000, v229
  v_lshlrev_b32 v230, 16, v231
  v_and_b32 v231, 0xffff0000, v231
  v_mul_f32 v224, v41, v224
  v_mul_f32 v225, v41, v225
  v_mul_f32 v226, v41, v226
  v_mul_f32 v227, v41, v227
  v_mul_f32 v228, v41, v228
  v_mul_f32 v229, v41, v229
  v_mul_f32 v230, v41, v230
  v_mul_f32 v231, v41, v231
  v_cvt_pk_bf16_f32 v48, v224, v225
  v_cvt_pk_bf16_f32 v49, v226, v227
  v_cvt_pk_bf16_f32 v50, v228, v229
  v_cvt_pk_bf16_f32 v51, v230, v231
  ds_write_b64 v16, v[48:49] offset:1536
  ds_write_b64 v16, v[50:51] offset:9216
  s_branch M_FIN
M_RUNK2:
  ds_read_b128 v[32:35], v6 offset:0
  ds_read2_b64 v[16:19], v4 offset0:128 offset1:129
  ds_read_b128 v[36:39], v6 offset:64
  ds_read2_b64 v[20:23], v4 offset0:136 offset1:137
  ds_read_b128 v[40:43], v6 offset:128
  ds_read2_b64 v[148:151], v5 offset0:80 offset1:81
  ds_read2_b64 v[24:27], v4 offset0:144 offset1:145
  ds_read_b128 v[44:47], v6 offset:192
  ds_read2_b64 v[144:147], v5 offset0:88 offset1:89
  ds_read2_b64 v[28:31], v4 offset0:152 offset1:153
  ds_read_b128 v[48:51], v6 offset:256
  ds_read2_b64 v[140:143], v5 offset0:96 offset1:97
  ds_read2_b64 v[232:235], v4 offset0:160 offset1:161
  ds_read_b128 v[52:55], v6 offset:320
  ds_read2_b64 v[136:139], v5 offset0:104 offset1:105
  s_waitcnt lgkmcnt(14)
  v_mfma_f32_16x16x32_f16 v[224:227], v[156:159], v[32:35], 0
  ds_read2_b64 v[236:239], v4 offset0:168 offset1:169
  s_waitcnt lgkmcnt(14)
  v_mfma_f32_16x16x32_f16 v[228:231], v[16:19], v[32:35], 0
  ds_read_b128 v[56:59], v6 offset:384
  ds_read2_b64 v[132:135], v5 offset0:112 offset1:113
  s_waitcnt lgkmcnt(15)
  v_mfma_f32_16x16x32_f16 v[224:227], v[152:155], v[36:39], v[224:227]
  ds_read2_b64 v[240:243], v4 offset0:176 offset1:177
  s_waitcnt lgkmcnt(15)
  v_mfma_f32_16x16x32_f16 v[228:231], v[20:23], v[36:39], v[228:231]
  ds_read_b128 v[60:63], v6 offset:448
  ds_read2_b64 v[128:131], v5 offset0:120 offset1:121
  s_waitcnt lgkmcnt(15)
  v_mfma_f32_16x16x32_f16 v[224:227], v[148:151], v[40:43], v[224:227]
  ds_read2_b64 v[244:247], v4 offset0:184 offset1:185
  s_waitcnt lgkmcnt(15)
  v_mfma_f32_16x16x32_f16 v[228:231], v[24:27], v[40:43], v[228:231]
  ds_read_b128 v[32:35], v6 offset:512
  s_waitcnt lgkmcnt(14)
  v_mfma_f32_16x16x32_f16 v[224:227], v[144:147], v[44:47], v[224:227]
  s_waitcnt lgkmcnt(13)
  v_mfma_f32_16x16x32_f16 v[228:231], v[28:31], v[44:47], v[228:231]
  ds_read_b128 v[36:39], v6 offset:576
  s_waitcnt lgkmcnt(12)
  v_mfma_f32_16x16x32_f16 v[224:227], v[140:143], v[48:51], v[224:227]
  s_waitcnt lgkmcnt(11)
  v_mfma_f32_16x16x32_f16 v[228:231], v[232:235], v[48:51], v[228:231]
  ds_read_b128 v[40:43], v6 offset:640
  ds_read2_b64 v[116:119], v5 offset0:144 offset1:145
  ds_read2_b64 v[212:215], v4 offset0:208 offset1:209
  s_waitcnt lgkmcnt(12)
  v_mfma_f32_16x16x32_f16 v[224:227], v[136:139], v[52:55], v[224:227]
  s_waitcnt lgkmcnt(11)
  v_mfma_f32_16x16x32_f16 v[228:231], v[236:239], v[52:55], v[228:231]
  ds_read_b128 v[44:47], v6 offset:704
  ds_read2_b64 v[112:115], v5 offset0:152 offset1:153
  ds_read2_b64 v[208:211], v4 offset0:216 offset1:217
  s_waitcnt lgkmcnt(12)
  v_mfma_f32_16x16x32_f16 v[224:227], v[132:135], v[56:59], v[224:227]
  s_waitcnt lgkmcnt(11)
  v_mfma_f32_16x16x32_f16 v[228:231], v[240:243], v[56:59], v[228:231]
  ds_read_b128 v[48:51], v6 offset:768
  ds_read2_b64 v[108:111], v5 offset0:160 offset1:161
  ds_read2_b64 v[204:207], v4 offset0:224 offset1:225
  s_waitcnt lgkmcnt(12)
  v_mfma_f32_16x16x32_f16 v[224:227], v[128:131], v[60:63], v[224:227]
  s_waitcnt lgkmcnt(11)
  v_mfma_f32_16x16x32_f16 v[228:231], v[244:247], v[60:63], v[228:231]
  ds_read_b128 v[52:55], v6 offset:832
  ds_read2_b64 v[104:107], v5 offset0:168 offset1:169
  ds_read2_b64 v[200:203], v4 offset0:232 offset1:233
  s_waitcnt lgkmcnt(13)
  v_mfma_f32_16x16x32_f16 v[224:227], v[124:127], v[32:35], v[224:227]
  v_mfma_f32_16x16x32_f16 v[228:231], v[220:223], v[32:35], v[228:231]
  ds_read_b128 v[56:59], v6 offset:896
  ds_read2_b64 v[100:103], v5 offset0:176 offset1:177
  ds_read2_b64 v[196:199], v4 offset0:240 offset1:241
  s_waitcnt lgkmcnt(15)
  v_mfma_f32_16x16x32_f16 v[224:227], v[120:123], v[36:39], v[224:227]
  v_mfma_f32_16x16x32_f16 v[228:231], v[216:219], v[36:39], v[228:231]
  ds_read_b128 v[60:63], v6 offset:960
  ds_read2_b64 v[96:99], v5 offset0:184 offset1:185
  ds_read2_b64 v[192:195], v4 offset0:248 offset1:249
  s_waitcnt lgkmcnt(15)
  v_mfma_f32_16x16x32_f16 v[224:227], v[116:119], v[40:43], v[224:227]
  v_mfma_f32_16x16x32_f16 v[228:231], v[212:215], v[40:43], v[228:231]
  ds_read_b128 v[32:35], v6 offset:1024
  s_waitcnt lgkmcnt(14)
  v_mfma_f32_16x16x32_f16 v[224:227], v[112:115], v[44:47], v[224:227]
  s_waitcnt lgkmcnt(13)
  v_mfma_f32_16x16x32_f16 v[228:231], v[208:211], v[44:47], v[228:231]
  ds_read_b128 v[36:39], v6 offset:1088
  s_waitcnt lgkmcnt(12)
  v_mfma_f32_16x16x32_f16 v[224:227], v[108:111], v[48:51], v[224:227]
  s_waitcnt lgkmcnt(11)
  v_mfma_f32_16x16x32_f16 v[228:231], v[204:207], v[48:51], v[228:231]
  ds_read_b128 v[40:43], v6 offset:1152
  ds_read2_b64 v[84:87], v5 offset0:208 offset1:209
  ds_read2_b64 v[180:183], v5 offset0:16 offset1:17
  s_waitcnt lgkmcnt(12)
  v_mfma_f32_16x16x32_f16 v[224:227], v[104:107], v[52:55], v[224:227]
  s_waitcnt lgkmcnt(11)
  v_mfma_f32_16x16x32_f16 v[228:231], v[200:203], v[52:55], v[228:231]
  ds_read_b128 v[44:47], v6 offset:1216
  ds_read2_b64 v[80:83], v5 offset0:216 offset1:217
  ds_read2_b64 v[176:179], v5 offset0:24 offset1:25
  s_waitcnt lgkmcnt(12)
  v_mfma_f32_16x16x32_f16 v[224:227], v[100:103], v[56:59], v[224:227]
  s_waitcnt lgkmcnt(11)
  v_mfma_f32_16x16x32_f16 v[228:231], v[196:199], v[56:59], v[228:231]
  ds_read_b128 v[48:51], v6 offset:1280
  ds_read2_b64 v[76:79], v5 offset0:224 offset1:225
  ds_read2_b64 v[172:175], v5 offset0:32 offset1:33
  s_waitcnt lgkmcnt(12)
  v_mfma_f32_16x16x32_f16 v[224:227], v[96:99], v[60:63], v[224:227]
  s_waitcnt lgkmcnt(11)
  v_mfma_f32_16x16x32_f16 v[228:231], v[192:195], v[60:63], v[228:231]
  ds_read_b128 v[52:55], v6 offset:1344
  ds_read2_b64 v[72:75], v5 offset0:232 offset1:233
  ds_read2_b64 v[168:171], v5 offset0:40 offset1:41
  s_waitcnt lgkmcnt(13)
  v_mfma_f32_16x16x32_f16 v[224:227], v[92:95], v[32:35], v[224:227]
  v_mfma_f32_16x16x32_f16 v[228:231], v[188:191], v[32:35], v[228:231]
  ds_read_b128 v[56:59], v6 offset:1408
  ds_read2_b64 v[68:71], v5 offset0:240 offset1:241
  ds_read2_b64 v[164:167], v5 offset0:48 offset1:49
  s_waitcnt lgkmcnt(15)
  v_mfma_f32_16x16x32_f16 v[224:227], v[88:91], v[36:39], v[224:227]
  v_mfma_f32_16x16x32_f16 v[228:231], v[184:187], v[36:39], v[228:231]
  ds_read_b128 v[60:63], v6 offset:1472
  ds_read2_b64 v[64:67], v5 offset0:248 offset1:249
  ds_read2_b64 v[160:163], v5 offset0:56 offset1:57
  s_waitcnt lgkmcnt(15)
  v_mfma_f32_16x16x32_f16 v[224:227], v[84:87], v[40:43], v[224:227]
  v_mfma_f32_16x16x32_f16 v[228:231], v[180:183], v[40:43], v[228:231]
  ds_read_b128 v[32:35], v6 offset:1536
  s_waitcnt lgkmcnt(14)
  v_mfma_f32_16x16x32_f16 v[224:227], v[80:83], v[44:47], v[224:227]
  ds_read_b128 v[36:39], v6 offset:1600
  s_waitcnt lgkmcnt(14)
  v_mfma_f32_16x16x32_f16 v[228:231], v[176:179], v[44:47], v[228:231]
  ds_read_b128 v[40:43], v6 offset:1664
  s_waitcnt lgkmcnt(13)
  v_mfma_f32_16x16x32_f16 v[224:227], v[76:79], v[48:51], v[224:227]
  ds_read_b128 v[44:47], v6 offset:1728
  s_waitcnt lgkmcnt(13)
  v_mfma_f32_16x16x32_f16 v[228:231], v[172:175], v[48:51], v[228:231]
  ds_read_b128 v[48:51], v6 offset:1792
  s_waitcnt lgkmcnt(12)
  v_mfma_f32_16x16x32_f16 v[224:227], v[72:75], v[52:55], v[224:227]
  s_waitcnt lgkmcnt(11)
  v_mfma_f32_16x16x32_f16 v[228:231], v[168:171], v[52:55], v[228:231]
  ds_read_b128 v[52:55], v6 offset:1856
  s_waitcnt lgkmcnt(10)
  v_mfma_f32_16x16x32_f16 v[224:227], v[68:71], v[56:59], v[224:227]
  s_waitcnt lgkmcnt(9)
  v_mfma_f32_16x16x32_f16 v[228:231], v[164:167], v[56:59], v[228:231]
  ds_read_b128 v[56:59], v6 offset:1920
  s_waitcnt lgkmcnt(8)
  v_mfma_f32_16x16x32_f16 v[224:227], v[64:67], v[60:63], v[224:227]
  s_waitcnt lgkmcnt(7)
  v_mfma_f32_16x16x32_f16 v[228:231], v[160:163], v[60:63], v[228:231]
  ds_read_b128 v[60:63], v6 offset:1984
  s_waitcnt lgkmcnt(7)
  v_mfma_f32_16x16x32_f16 v[228:231], v[156:159], v[32:35], v[228:231]
  ds_read_b128 v[32:35], v6 offset:2048
  s_waitcnt lgkmcnt(7)
  v_mfma_f32_16x16x32_f16 v[228:231], v[152:155], v[36:39], v[228:231]
  ds_read_b128 v[36:39], v6 offset:2112
  s_waitcnt lgkmcnt(7)
  v_mfma_f32_16x16x32_f16 v[228:231], v[148:151], v[40:43], v[228:231]
  ds_read_b128 v[40:43], v6 offset:2176
  s_waitcnt lgkmcnt(7)
  v_mfma_f32_16x16x32_f16 v[228:231], v[144:147], v[44:47], v[228:231]
  ds_read_b128 v[44:47], v6 offset:2240
  s_waitcnt lgkmcnt(7)
  v_mfma_f32_16x16x32_f16 v[228:231], v[140:143], v[48:51], v[228:231]
  ds_read_b128 v[48:51], v6 offset:2304
  s_waitcnt lgkmcnt(7)
  v_mfma_f32_16x16x32_f16 v[228:231], v[136:139], v[52:55], v[228:231]
  ds_read_b128 v[52:55], v6 offset:2368
  s_waitcnt lgkmcnt(7)
  v_mfma_f32_16x16x32_f16 v[228:231], v[132:135], v[56:59], v[228:231]
  ds_read_b128 v[56:59], v6 offset:2432
  s_waitcnt lgkmcnt(7)
  v_mfma_f32_16x16x32_f16 v[228:231], v[128:131], v[60:63], v[228:231]
  ds_read_b128 v[60:63], v6 offset:2496
  s_waitcnt lgkmcnt(7)
  v_mfma_f32_16x16x32_f16 v[228:231], v[124:127], v[32:35], v[228:231]
  ds_read_b128 v[32:35], v6 offset:2560
  s_waitcnt lgkmcnt(7)
  v_mfma_f32_16x16x32_f16 v[228:231], v[120:123], v[36:39], v[228:231]
  ds_read_b128 v[36:39], v6 offset:2624
  s_waitcnt lgkmcnt(7)
  v_mfma_f32_16x16x32_f16 v[228:231], v[116:119], v[40:43], v[228:231]
  ds_read_b128 v[40:43], v6 offset:2688
  s_waitcnt lgkmcnt(7)
  v_mfma_f32_16x16x32_f16 v[228:231], v[112:115], v[44:47], v[228:231]
  ds_read_b128 v[44:47], v6 offset:2752
  s_waitcnt lgkmcnt(7)
  v_mfma_f32_16x16x32_f16 v[228:231], v[108:111], v[48:51], v[228:231]
  ds_read_b128 v[48:51], v6 offset:2816
  s_waitcnt lgkmcnt(7)
  v_mfma_f32_16x16x32_f16 v[228:231], v[104:107], v[52:55], v[228:231]
  ds_read_b128 v[52:55], v6 offset:2880
  s_waitcnt lgkmcnt(7)
  v_mfma_f32_16x16x32_f16 v[228:231], v[100:103], v[56:59], v[228:231]
  ds_read_b128 v[56:59], v6 offset:2944
  s_waitcnt lgkmcnt(7)
  v_mfma_f32_16x16x32_f16 v[228:231], v[96:99], v[60:63], v[228:231]
  ds_read_b128 v[60:63], v6 offset:3008
  s_waitcnt lgkmcnt(7)
  v_mfma_f32_16x16x32_f16 v[228:231], v[92:95], v[32:35], v[228:231]
  s_waitcnt lgkmcnt(6)
  v_mfma_f32_16x16x32_f16 v[228:231], v[88:91], v[36:39], v[228:231]
  s_waitcnt lgkmcnt(5)
  v_mfma_f32_16x16x32_f16 v[228:231], v[84:87], v[40:43], v[228:231]
  s_waitcnt lgkmcnt(4)
  v_mfma_f32_16x16x32_f16 v[228:231], v[80:83], v[44:47], v[228:231]
  s_waitcnt lgkmcnt(3)
  v_mfma_f32_16x16x32_f16 v[228:231], v[76:79], v[48:51], v[228:231]
  s_waitcnt lgkmcnt(2)
  v_mfma_f32_16x16x32_f16 v[228:231], v[72:75], v[52:55], v[228:231]
  s_waitcnt lgkmcnt(1)
  v_mfma_f32_16x16x32_f16 v[228:231], v[68:71], v[56:59], v[228:231]
  s_waitcnt lgkmcnt(0)
  v_mfma_f32_16x16x32_f16 v[228:231], v[64:67], v[60:63], v[228:231]
  s_nop 7
  ds_read_b32 v40, v248 offset:40
  ds_read_b32 v41, v248 offset:56
  ds_read_b32 v42, v248 offset:72
  ds_read_b32 v43, v248 offset:88
  ds_read_b64 v[44:45], v3 offset:10240
  ds_read_b64 v[46:47], v3 offset:11776
  v_and_b32 v16, 15, v2
  v_mul_u32_u24 v16, 96, v16
  v_lshrrev_b32 v17, 5, v2
  v_mul_u32_u24 v17, 48, v17
  v_bfe_u32 v18, v2, 4, 1
  v_lshl_add_u32 v17, v18, 3, v17
  v_add_u32 v16, v16, v17
  v_add_u32 v16, 69152, v16
  s_waitcnt lgkmcnt(0)
  v_ldexp_f32 v43, v43, v42

  v_mul_f32 v224, v43, v224
  v_mul_f32 v225, v43, v225
  v_mul_f32 v226, v43, v226
  v_mul_f32 v227, v43, v227
  v_mul_f32 v228, v43, v228
  v_mul_f32 v229, v43, v229
  v_mul_f32 v230, v43, v230
  v_mul_f32 v231, v43, v231
  v_fma_mix_f32 v48, v44, v40, 0 op_sel:[0,0,0] op_sel_hi:[1,0,0]
  v_fma_mix_f32 v49, v44, v40, 0 op_sel:[1,0,0] op_sel_hi:[1,0,0]
  v_fma_mix_f32 v50, v45, v40, 0 op_sel:[0,0,0] op_sel_hi:[1,0,0]
  v_fma_mix_f32 v51, v45, v40, 0 op_sel:[1,0,0] op_sel_hi:[1,0,0]
  v_fma_mix_f32 v52, v46, v40, 0 op_sel:[0,0,0] op_sel_hi:[1,0,0]
  v_fma_mix_f32 v53, v46, v40, 0 op_sel:[1,0,0] op_sel_hi:[1,0,0]
  v_fma_mix_f32 v54, v47, v40, 0 op_sel:[0,0,0] op_sel_hi:[1,0,0]
  v_fma_mix_f32 v55, v47, v40, 0 op_sel:[1,0,0] op_sel_hi:[1,0,0]
  v_cvt_pk_bf16_f32 v225, v224, v225
  v_cvt_pk_bf16_f32 v227, v226, v227
  v_cvt_pk_bf16_f32 v229, v228, v229
  v_cvt_pk_bf16_f32 v231, v230, v231
  v_cvt_pk_bf16_f32 v49, v48, v49
  v_cvt_pk_bf16_f32 v51, v50, v51
  v_cvt_pk_bf16_f32 v53, v52, v53
  v_cvt_pk_bf16_f32 v55, v54, v55
  v_lshlrev_b32 v224, 16, v225
  v_and_b32 v225, 0xffff0000, v225
  v_lshlrev_b32 v226, 16, v227
  v_and_b32 v227, 0xffff0000, v227
  v_lshlrev_b32 v228, 16, v229
  v_and_b32 v229, 0xffff0000, v229
  v_lshlrev_b32 v230, 16, v231
  v_and_b32 v231, 0xffff0000, v231
  v_lshlrev_b32 v48, 16, v49
  v_and_b32 v49, 0xffff0000, v49
  v_lshlrev_b32 v50, 16, v51
  v_and_b32 v51, 0xffff0000, v51
  v_lshlrev_b32 v52, 16, v53
  v_and_b32 v53, 0xffff0000, v53
  v_lshlrev_b32 v54, 16, v55
  v_and_b32 v55, 0xffff0000, v55
  v_add_f32 v224, v224, v48
  v_add_f32 v225, v225, v49
  v_add_f32 v226, v226, v50
  v_add_f32 v227, v227, v51
  v_add_f32 v228, v228, v52
  v_add_f32 v229, v229, v53
  v_add_f32 v230, v230, v54
  v_add_f32 v231, v231, v55
  v_cvt_pk_bf16_f32 v225, v224, v225
  v_cvt_pk_bf16_f32 v227, v226, v227
  v_cvt_pk_bf16_f32 v229, v228, v229
  v_cvt_pk_bf16_f32 v231, v230, v231
  v_lshlrev_b32 v224, 16, v225
  v_and_b32 v225, 0xffff0000, v225
  v_lshlrev_b32 v226, 16, v227
  v_and_b32 v227, 0xffff0000, v227
  v_lshlrev_b32 v228, 16, v229
  v_and_b32 v229, 0xffff0000, v229
  v_lshlrev_b32 v230, 16, v231
  v_and_b32 v231, 0xffff0000, v231
  v_mul_f32 v224, v41, v224
  v_mul_f32 v225, v41, v225
  v_mul_f32 v226, v41, v226
  v_mul_f32 v227, v41, v227
  v_mul_f32 v228, v41, v228
  v_mul_f32 v229, v41, v229
  v_mul_f32 v230, v41, v230
  v_mul_f32 v231, v41, v231
  v_cvt_pk_bf16_f32 v48, v224, v225
  v_cvt_pk_bf16_f32 v49, v226, v227
  v_cvt_pk_bf16_f32 v50, v228, v229
  v_cvt_pk_bf16_f32 v51, v230, v231
  ds_write_b64 v16, v[48:49] offset:3072
  ds_write_b64 v16, v[50:51] offset:7680
  s_branch M_FIN
M_RUNK3:
  ds_read_b128 v[32:35], v6 offset:0
  ds_read_b128 v[36:39], v6 offset:64
  ds_read_b128 v[40:43], v6 offset:128
  ds_read2_b64 v[180:183], v5 offset0:16 offset1:17
  ds_read2_b64 v[212:215], v4 offset0:208 offset1:209
  ds_read_b128 v[44:47], v6 offset:192
  ds_read2_b64 v[176:179], v5 offset0:24 offset1:25
  ds_read2_b64 v[208:211], v4 offset0:216 offset1:217
  ds_read_b128 v[48:51], v6 offset:256
  ds_read2_b64 v[172:175], v5 offset0:32 offset1:33
  ds_read2_b64 v[204:207], v4 offset0:224 offset1:225
  ds_read_b128 v[52:55], v6 offset:320
  ds_read2_b64 v[168:171], v5 offset0:40 offset1:41
  ds_read2_b64 v[200:203], v4 offset0:232 offset1:233
  s_waitcnt lgkmcnt(13)
  v_mfma_f32_16x16x32_f16 v[224:227], v[188:191], v[32:35], 0
  v_mfma_f32_16x16x32_f16 v[228:231], v[220:223], v[32:35], 0
  ds_read_b128 v[56:59], v6 offset:384
  ds_read2_b64 v[164:167], v5 offset0:48 offset1:49
  ds_read2_b64 v[196:199], v4 offset0:240 offset1:241
  s_waitcnt lgkmcnt(15)
  v_mfma_f32_16x16x32_f16 v[224:227], v[184:187], v[36:39], v[224:227]
  v_mfma_f32_16x16x32_f16 v[228:231], v[216:219], v[36:39], v[228:231]
  ds_read_b128 v[60:63], v6 offset:448
  ds_read2_b64 v[160:163], v5 offset0:56 offset1:57
  ds_read2_b64 v[192:195], v4 offset0:248 offset1:249
  s_waitcnt lgkmcnt(15)
  v_mfma_f32_16x16x32_f16 v[224:227], v[180:183], v[40:43], v[224:227]
  v_mfma_f32_16x16x32_f16 v[228:231], v[212:215], v[40:43], v[228:231]
  ds_read_b128 v[32:35], v6 offset:512
  s_waitcnt lgkmcnt(14)
  v_mfma_f32_16x16x32_f16 v[224:227], v[176:179], v[44:47], v[224:227]
  s_waitcnt lgkmcnt(13)
  v_mfma_f32_16x16x32_f16 v[228:231], v[208:211], v[44:47], v[228:231]
  ds_read_b128 v[36:39], v6 offset:576
  s_waitcnt lgkmcnt(12)
  v_mfma_f32_16x16x32_f16 v[224:227], v[172:175], v[48:51], v[224:227]
  s_waitcnt lgkmcnt(11)
  v_mfma_f32_16x16x32_f16 v[228:231], v[204:207], v[48:51], v[228:231]
  ds_read_b128 v[40:43], v6 offset:640
  ds_read2_b64 v[148:151], v5 offset0:80 offset1:81
  s_waitcnt lgkmcnt(11)
  v_mfma_f32_16x16x32_f16 v[224:227], v[168:171], v[52:55], v[224:227]
  s_waitcnt lgkmcnt(10)
  v_mfma_f32_16x16x32_f16 v[228:231], v[200:203], v[52:55], v[228:231]
  ds_read_b128 v[44:47], v6 offset:704
  ds_read2_b64 v[144:147], v5 offset0:88 offset1:89
  s_waitcnt lgkmcnt(10)
  v_mfma_f32_16x16x32_f16 v[224:227], v[164:167], v[56:59], v[224:227]
  s_waitcnt lgkmcnt(9)
  v_mfma_f32_16x16x32_f16 v[228:231], v[196:199], v[56:59], v[228:231]
  ds_read_b128 v[48:51], v6 offset:768
  ds_read2_b64 v[140:143], v5 offset0:96 offset1:97
  s_waitcnt lgkmcnt(9)
  v_mfma_f32_16x16x32_f16 v[224:227], v[160:163], v[60:63], v[224:227]
  s_waitcnt lgkmcnt(8)
  v_mfma_f32_16x16x32_f16 v[228:231], v[192:195], v[60:63], v[228:231]
  ds_read_b128 v[52:55], v6 offset:832
  ds_read2_b64 v[136:139], v5 offset0:104 offset1:105
  s_waitcnt lgkmcnt(9)
  v_mfma_f32_16x16x32_f16 v[224:227], v[156:159], v[32:35], v[224:227]
  v_mfma_f32_16x16x32_f16 v[228:231], v[188:191], v[32:35], v[228:231]
  ds_read_b128 v[56:59], v6 offset:896
  ds_read2_b64 v[132:135], v5 offset0:112 offset1:113
  s_waitcnt lgkmcnt(10)
  v_mfma_f32_16x16x32_f16 v[224:227], v[152:155], v[36:39], v[224:227]
  v_mfma_f32_16x16x32_f16 v[228:231], v[184:187], v[36:39], v[228:231]
  ds_read_b128 v[60:63], v6 offset:960
  ds_read2_b64 v[128:131], v5 offset0:120 offset1:121
  s_waitcnt lgkmcnt(10)
  v_mfma_f32_16x16x32_f16 v[224:227], v[148:151], v[40:43], v[224:227]
  v_mfma_f32_16x16x32_f16 v[228:231], v[180:183], v[40:43], v[228:231]
  ds_read_b128 v[32:35], v6 offset:1024
  s_waitcnt lgkmcnt(9)
  v_mfma_f32_16x16x32_f16 v[224:227], v[144:147], v[44:47], v[224:227]
  v_mfma_f32_16x16x32_f16 v[228:231], v[176:179], v[44:47], v[228:231]
  ds_read_b128 v[36:39], v6 offset:1088
  s_waitcnt lgkmcnt(8)
  v_mfma_f32_16x16x32_f16 v[224:227], v[140:143], v[48:51], v[224:227]
  v_mfma_f32_16x16x32_f16 v[228:231], v[172:175], v[48:51], v[228:231]
  ds_read_b128 v[40:43], v6 offset:1152
  ds_read2_b64 v[116:119], v5 offset0:144 offset1:145
  s_waitcnt lgkmcnt(8)
  v_mfma_f32_16x16x32_f16 v[224:227], v[136:139], v[52:55], v[224:227]
  v_mfma_f32_16x16x32_f16 v[228:231], v[168:171], v[52:55], v[228:231]
  ds_read_b128 v[44:47], v6 offset:1216
  ds_read2_b64 v[112:115], v5 offset0:152 offset1:153
  s_waitcnt lgkmcnt(8)
  v_mfma_f32_16x16x32_f16 v[224:227], v[132:135], v[56:59], v[224:227]
  v_mfma_f32_16x16x32_f16 v[228:231], v[164:167], v[56:59], v[228:231]
  ds_read_b128 v[48:51], v6 offset:1280
  ds_read2_b64 v[108:111], v5 offset0:160 offset1:161
  s_waitcnt lgkmcnt(8)
  v_mfma_f32_16x16x32_f16 v[224:227], v[128:131], v[60:63], v[224:227]
  v_mfma_f32_16x16x32_f16 v[228:231], v[160:163], v[60:63], v[228:231]
  ds_read_b128 v[52:55], v6 offset:1344
  ds_read2_b64 v[104:107], v5 offset0:168 offset1:169
  s_waitcnt lgkmcnt(9)
  v_mfma_f32_16x16x32_f16 v[224:227], v[124:127], v[32:35], v[224:227]
  v_mfma_f32_16x16x32_f16 v[228:231], v[156:159], v[32:35], v[228:231]
  ds_read_b128 v[56:59], v6 offset:1408
  ds_read2_b64 v[100:103], v5 offset0:176 offset1:177
  s_waitcnt lgkmcnt(10)
  v_mfma_f32_16x16x32_f16 v[224:227], v[120:123], v[36:39], v[224:227]
  v_mfma_f32_16x16x32_f16 v[228:231], v[152:155], v[36:39], v[228:231]
  ds_read_b128 v[60:63], v6 offset:1472
  ds_read2_b64 v[96:99], v5 offset0:184 offset1:185
  s_waitcnt lgkmcnt(10)
  v_mfma_f32_16x16x32_f16 v[224:227], v[116:119], v[40:43], v[224:227]
  v_mfma_f32_16x16x32_f16 v[228:231], v[148:151], v[40:43], v[228:231]
  ds_read_b128 v[32:35], v6 offset:1536
  s_waitcnt lgkmcnt(9)
  v_mfma_f32_16x16x32_f16 v[224:227], v[112:115], v[44:47], v[224:227]
  v_mfma_f32_16x16x32_f16 v[228:231], v[144:147], v[44:47], v[228:231]
  ds_read_b128 v[36:39], v6 offset:1600
  s_waitcnt lgkmcnt(8)
  v_mfma_f32_16x16x32_f16 v[224:227], v[108:111], v[48:51], v[224:227]
  v_mfma_f32_16x16x32_f16 v[228:231], v[140:143], v[48:51], v[228:231]
  ds_read_b128 v[40:43], v6 offset:1664
  ds_read2_b64 v[84:87], v5 offset0:208 offset1:209
  s_waitcnt lgkmcnt(8)
  v_mfma_f32_16x16x32_f16 v[224:227], v[104:107], v[52:55], v[224:227]
  v_mfma_f32_16x16x32_f16 v[228:231], v[136:139], v[52:55], v[228:231]
  ds_read_b128 v[44:47], v6 offset:1728
  ds_read2_b64 v[80:83], v5 offset0:216 offset1:217
  s_waitcnt lgkmcnt(8)
  v_mfma_f32_16x16x32_f16 v[224:227], v[100:103], v[56:59], v[224:227]
  v_mfma_f32_16x16x32_f16 v[228:231], v[132:135], v[56:59], v[228:231]
  ds_read_b128 v[48:51], v6 offset:1792
  ds_read2_b64 v[76:79], v5 offset0:224 offset1:225
  s_waitcnt lgkmcnt(8)
  v_mfma_f32_16x16x32_f16 v[224:227], v[96:99], v[60:63], v[224:227]
  v_mfma_f32_16x16x32_f16 v[228:231], v[128:131], v[60:63], v[228:231]
  ds_read_b128 v[52:55], v6 offset:1856
  ds_read2_b64 v[72:75], v5 offset0:232 offset1:233
  s_waitcnt lgkmcnt(9)
  v_mfma_f32_16x16x32_f16 v[224:227], v[92:95], v[32:35], v[224:227]
  v_mfma_f32_16x16x32_f16 v[228:231], v[124:127], v[32:35], v[228:231]
  ds_read_b128 v[56:59], v6 offset:1920
  ds_read2_b64 v[68:71], v5 offset0:240 offset1:241
  s_waitcnt lgkmcnt(10)
  v_mfma_f32_16x16x32_f16 v[224:227], v[88:91], v[36:39], v[224:227]
  v_mfma_f32_16x16x32_f16 v[228:231], v[120:123], v[36:39], v[228:231]
  ds_read_b128 v[60:63], v6 offset:1984
  ds_read2_b64 v[64:67], v5 offset0:248 offset1:249
  s_waitcnt lgkmcnt(10)
  v_mfma_f32_16x16x32_f16 v[224:227], v[84:87], v[40:43], v[224:227]
  v_mfma_f32_16x16x32_f16 v[228:231], v[116:119], v[40:43], v[228:231]
  ds_read_b128 v[32:35], v6 offset:2048
  s_waitcnt lgkmcnt(9)
  v_mfma_f32_16x16x32_f16 v[224:227], v[80:83], v[44:47], v[224:227]
  ds_read_b128 v[36:39], v6 offset:2112
  v_mfma_f32_16x16x32_f16 v[228:231], v[112:115], v[44:47], v[228:231]
  ds_read_b128 v[40:43], v6 offset:2176
  s_waitcnt lgkmcnt(9)
  v_mfma_f32_16x16x32_f16 v[224:227], v[76:79], v[48:51], v[224:227]
  ds_read_b128 v[44:47], v6 offset:2240
  v_mfma_f32_16x16x32_f16 v[228:231], v[108:111], v[48:51], v[228:231]
  ds_read_b128 v[48:51], v6 offset:2304
  s_waitcnt lgkmcnt(9)
  v_mfma_f32_16x16x32_f16 v[224:227], v[72:75], v[52:55], v[224:227]
  v_mfma_f32_16x16x32_f16 v[228:231], v[104:107], v[52:55], v[228:231]
  ds_read_b128 v[52:55], v6 offset:2368
  s_waitcnt lgkmcnt(8)
  v_mfma_f32_16x16x32_f16 v[224:227], v[68:71], v[56:59], v[224:227]
  v_mfma_f32_16x16x32_f16 v[228:231], v[100:103], v[56:59], v[228:231]
  ds_read_b128 v[56:59], v6 offset:2432
  s_waitcnt lgkmcnt(7)
  v_mfma_f32_16x16x32_f16 v[224:227], v[64:67], v[60:63], v[224:227]
  v_mfma_f32_16x16x32_f16 v[228:231], v[96:99], v[60:63], v[228:231]
  ds_read_b128 v[60:63], v6 offset:2496
  s_waitcnt lgkmcnt(7)
  v_mfma_f32_16x16x32_f16 v[228:231], v[92:95], v[32:35], v[228:231]
  s_waitcnt lgkmcnt(6)
  v_mfma_f32_16x16x32_f16 v[228:231], v[88:91], v[36:39], v[228:231]
  s_waitcnt lgkmcnt(5)
  v_mfma_f32_16x16x32_f16 v[228:231], v[84:87], v[40:43], v[228:231]
  s_waitcnt lgkmcnt(4)
  v_mfma_f32_16x16x32_f16 v[228:231], v[80:83], v[44:47], v[228:231]
  s_waitcnt lgkmcnt(3)
  v_mfma_f32_16x16x32_f16 v[228:231], v[76:79], v[48:51], v[228:231]
  s_waitcnt lgkmcnt(2)
  v_mfma_f32_16x16x32_f16 v[228:231], v[72:75], v[52:55], v[228:231]
  s_waitcnt lgkmcnt(1)
  v_mfma_f32_16x16x32_f16 v[228:231], v[68:71], v[56:59], v[228:231]
  s_waitcnt lgkmcnt(0)
  v_mfma_f32_16x16x32_f16 v[228:231], v[64:67], v[60:63], v[228:231]
  s_nop 7
  ds_read_b32 v40, v248 offset:40
  ds_read_b32 v41, v248 offset:56
  ds_read_b32 v42, v248 offset:72
  ds_read_b32 v43, v248 offset:88
  ds_read_b64 v[44:45], v3 offset:10752
  ds_read_b64 v[46:47], v3 offset:11264
  v_and_b32 v16, 15, v2
  v_mul_u32_u24 v16, 96, v16
  v_lshrrev_b32 v17, 5, v2
  v_mul_u32_u24 v17, 48, v17
  v_bfe_u32 v18, v2, 4, 1
  v_lshl_add_u32 v17, v18, 3, v17
  v_add_u32 v16, v16, v17
  v_add_u32 v16, 69152, v16
  s_waitcnt lgkmcnt(0)
  v_ldexp_f32 v43, v43, v42

  v_mul_f32 v224, v43, v224
  v_mul_f32 v225, v43, v225
  v_mul_f32 v226, v43, v226
  v_mul_f32 v227, v43, v227
  v_mul_f32 v228, v43, v228
  v_mul_f32 v229, v43, v229
  v_mul_f32 v230, v43, v230
  v_mul_f32 v231, v43, v231
  v_fma_mix_f32 v48, v44, v40, 0 op_sel:[0,0,0] op_sel_hi:[1,0,0]
  v_fma_mix_f32 v49, v44, v40, 0 op_sel:[1,0,0] op_sel_hi:[1,0,0]
  v_fma_mix_f32 v50, v45, v40, 0 op_sel:[0,0,0] op_sel_hi:[1,0,0]
  v_fma_mix_f32 v51, v45, v40, 0 op_sel:[1,0,0] op_sel_hi:[1,0,0]
  v_fma_mix_f32 v52, v46, v40, 0 op_sel:[0,0,0] op_sel_hi:[1,0,0]
  v_fma_mix_f32 v53, v46, v40, 0 op_sel:[1,0,0] op_sel_hi:[1,0,0]
  v_fma_mix_f32 v54, v47, v40, 0 op_sel:[0,0,0] op_sel_hi:[1,0,0]
  v_fma_mix_f32 v55, v47, v40, 0 op_sel:[1,0,0] op_sel_hi:[1,0,0]
  v_cvt_pk_bf16_f32 v225, v224, v225
  v_cvt_pk_bf16_f32 v227, v226, v227
  v_cvt_pk_bf16_f32 v229, v228, v229
  v_cvt_pk_bf16_f32 v231, v230, v231
  v_cvt_pk_bf16_f32 v49, v48, v49
  v_cvt_pk_bf16_f32 v51, v50, v51
  v_cvt_pk_bf16_f32 v53, v52, v53
  v_cvt_pk_bf16_f32 v55, v54, v55
  v_lshlrev_b32 v224, 16, v225
  v_and_b32 v225, 0xffff0000, v225
  v_lshlrev_b32 v226, 16, v227
  v_and_b32 v227, 0xffff0000, v227
  v_lshlrev_b32 v228, 16, v229
  v_and_b32 v229, 0xffff0000, v229
  v_lshlrev_b32 v230, 16, v231
  v_and_b32 v231, 0xffff0000, v231
  v_lshlrev_b32 v48, 16, v49
  v_and_b32 v49, 0xffff0000, v49
  v_lshlrev_b32 v50, 16, v51
  v_and_b32 v51, 0xffff0000, v51
  v_lshlrev_b32 v52, 16, v53
  v_and_b32 v53, 0xffff0000, v53
  v_lshlrev_b32 v54, 16, v55
  v_and_b32 v55, 0xffff0000, v55
  v_add_f32 v224, v224, v48
  v_add_f32 v225, v225, v49
  v_add_f32 v226, v226, v50
  v_add_f32 v227, v227, v51
  v_add_f32 v228, v228, v52
  v_add_f32 v229, v229, v53
  v_add_f32 v230, v230, v54
  v_add_f32 v231, v231, v55
  v_cvt_pk_bf16_f32 v225, v224, v225
  v_cvt_pk_bf16_f32 v227, v226, v227
  v_cvt_pk_bf16_f32 v229, v228, v229
  v_cvt_pk_bf16_f32 v231, v230, v231
  v_lshlrev_b32 v224, 16, v225
  v_and_b32 v225, 0xffff0000, v225
  v_lshlrev_b32 v226, 16, v227
  v_and_b32 v227, 0xffff0000, v227
  v_lshlrev_b32 v228, 16, v229
  v_and_b32 v229, 0xffff0000, v229
  v_lshlrev_b32 v230, 16, v231
  v_and_b32 v231, 0xffff0000, v231
  v_mul_f32 v224, v41, v224
  v_mul_f32 v225, v41, v225
  v_mul_f32 v226, v41, v226
  v_mul_f32 v227, v41, v227
  v_mul_f32 v228, v41, v228
  v_mul_f32 v229, v41, v229
  v_mul_f32 v230, v41, v230
  v_mul_f32 v231, v41, v231
  v_cvt_pk_bf16_f32 v48, v224, v225
  v_cvt_pk_bf16_f32 v49, v226, v227
  v_cvt_pk_bf16_f32 v50, v228, v229
  v_cvt_pk_bf16_f32 v51, v230, v231
  ds_write_b64 v16, v[48:49] offset:4608
  ds_write_b64 v16, v[50:51] offset:6144
  s_branch M_FIN
M_FIN:
  s_setprio 0
  s_cmp_lg_u32 s3, 1
  s_cbranch_scc1 M_NRED
  s_cmp_lt_u32 s2, 229
  s_cbranch_scc1 M_NRED
  s_mov_b32 s41, 65536

  s_sub_u32 s40, s2, 202
  s_mul_i32 s40, s40, 4608
  s_add_u32 s40, s40, 524288
  v_lshl_add_u32 v178, v2, 3, s40
  v_add_u32 v179, 4096, v178

  s_waitcnt vmcnt(0)
M_RP:
  v_xor_b32 v24, s38, v177

  v_xor_b32 v25, s38, v161
  v_or_b32 v24, v24, v25
  v_xor_b32 v25, s38, v163
  v_or_b32 v24, v24, v25
  v_xor_b32 v25, s38, v165
  v_or_b32 v24, v24, v25
  v_xor_b32 v25, s38, v167
  v_or_b32 v24, v24, v25
  v_xor_b32 v25, s38, v169
  v_or_b32 v24, v24, v25
  v_xor_b32 v25, s38, v171
  v_or_b32 v24, v24, v25
  v_xor_b32 v25, s38, v173
  v_or_b32 v24, v24, v25
  v_xor_b32 v25, s38, v175
  v_or_b32 v24, v24, v25
  v_cmp_ne_u32 vcc, 0, v24
  s_cbranch_vccz M_RD

  global_load_dwordx2 v[160:161], v178, s[36:37] offset:0 sc1
  global_load_dwordx2 v[162:163], v178, s[36:37] offset:512 sc1
  global_load_dwordx2 v[164:165], v178, s[36:37] offset:1024 sc1
  global_load_dwordx2 v[166:167], v178, s[36:37] offset:1536 sc1
  global_load_dwordx2 v[168:169], v178, s[36:37] offset:2048 sc1
  global_load_dwordx2 v[170:171], v178, s[36:37] offset:2560 sc1
  global_load_dwordx2 v[172:173], v178, s[36:37] offset:3072 sc1
  global_load_dwordx2 v[174:175], v178, s[36:37] offset:3584 sc1
  global_load_dwordx2 v[176:177], v179, s[36:37] sc1
  s_waitcnt vmcnt(0)
  s_sub_u32 s41, s41, 1
  s_cbranch_scc0 M_RP
M_RD:

  v_add_f32 v176, v176, v160
  v_add_f32 v176, v176, v162
  v_add_f32 v176, v176, v164
  v_add_f32 v176, v176, v166
  v_add_f32 v176, v176, v168
  v_add_f32 v176, v176, v170
  v_add_f32 v176, v176, v172
  v_add_f32 v176, v176, v174
  v_cvt_pk_bf16_f32 v24, v176, v176
  s_sub_u32 s40, s2, 238
  s_cmp_lt_u32 s40, 9
  s_cbranch_scc0 M_RNC
  v_lshlrev_b32 v24, 16, v24
  v_add_f32 v24, 1.0, v24
  v_cvt_pk_bf16_f32 v24, v24, v24
M_RNC:
  s_sub_u32 s40, s2, 229
  s_lshl_b32 s40, s40, 8
  s_add_u32 s40, s40, 458752
  v_mov_b32 v26, v24 quad_perm:[1,1,3,3] row_mask:0xf bank_mask:0xf
  v_lshl_add_u32 v27, v2, 2, s40
  v_mov_b32 v25, s38
  v_alignbit_b32 v24, v26, v24, 16
  s_mov_b32 exec_lo, 0x55555555
  s_mov_b32 exec_hi, 0x55555555
  global_store_dwordx2 v27, v[24:25], s[36:37] sc1
  s_mov_b64 exec, -1
M_NRED:
  s_cmp_lg_u32 s3, 5
  s_cbranch_scc1 M_NWR
  v_lshlrev_b32 v24, 4, v2
  s_mov_b32 m0, 159616
  s_nop 0
  global_load_lds_dwordx4 v24, s[20:21]
  s_mov_b64 exec, 0xff
  global_load_lds_dwordx4 v24, s[20:21] offset:1024
  s_mov_b64 exec, -1
M_NWR:

  s_add_u32 s50, s3, 5
  s_add_u32 s51, s3, -3
  s_add_u32 s52, s3, 7
  s_add_u32 s53, s3, 10
  s_cmp_ge_u32 s3, 5
  s_cselect_b32 s50, s53, s50
  s_lshl_b32 s50, s50, 10
  s_lshl_b32 s51, s51, 10
  s_lshl_b32 s52, s52, 10
  s_add_u32 s54, s51, 18432
  s_add_u32 s55, s52, 18432
  s_cmp_lt_u32 s3, 3
  s_cselect_b32 s51, 4294966272, s51
  s_cselect_b32 s52, 4294966272, s52
  s_cselect_b32 s54, 4294966272, s54
  s_cselect_b32 s55, 4294966272, s55
  v_lshlrev_b32 v16, 4, v2
  v_add_u32 v16, 1536, v16
  v_add_u32 v17, s51, v16
  v_add_u32 v18, s52, v16
  v_add_u32 v19, s54, v16
  v_add_u32 v20, s55, v16
  v_add_u32 v16, s50, v16
  s_lshl_b32 s40, s3, 9
  v_add_u32 v3, s40, v3
  ds_read_b64 v[64:65], v248 offset:32
  ds_read_b64 v[66:67], v248 offset:48
  ds_read_b64 v[68:69], v248 offset:64
  ds_read_b64 v[70:71], v248 offset:80
  ds_read_b64 v[72:73], v3
  ds_read_b64 v[74:75], v3 offset:4608
  s_mul_i32 s40, s3, 1536
  s_add_u32 s40, s40, 69120
  v_and_b32 v4, 15, v2
  v_mul_u32_u24 v4, 96, v4
  v_lshrrev_b32 v5, 5, v2
  v_mul_u32_u24 v5, 48, v5
  v_and_b32 v6, 16, v2
  v_add3_u32 v4, v4, v5, v6
  v_add_u32 v4, s40, v4
  v_lshrrev_b32 v6, 2, v2
  v_mul_u32_u24 v5, 96, v6
  v_and_b32 v7, 3, v2
  v_mul_u32_u24 v8, 12, v7
  v_add3_u32 v5, v5, v8, s40
  v_lshlrev_b32 v6, 15, v6
  v_lshl_add_u32 v6, v7, 4, v6
  s_lshl_b32 s40, s3, 19
  s_lshl_b32 s41, s2, 6
  s_add_u32 s40, s40, s41
  s_add_u32 s40, s40, 6291456
  v_add_u32 v6, s40, v6
  v_add_u32 v7, 16384, v6
  v_mov_b32 v119, s38
  v_mov_b32 v123, s38
  s_waitcnt lgkmcnt(0)
  v_ldexp_f32 v70, v70, v68
  v_ldexp_f32 v71, v71, v69

  v_fma_mix_f32 v104, v72, v64, 0 op_sel:[0,0,0] op_sel_hi:[1,0,0]
  v_fma_mix_f32 v105, v72, v64, 0 op_sel:[1,0,0] op_sel_hi:[1,0,0]
  v_fma_mix_f32 v106, v73, v64, 0 op_sel:[0,0,0] op_sel_hi:[1,0,0]
  v_fma_mix_f32 v107, v73, v64, 0 op_sel:[1,0,0] op_sel_hi:[1,0,0]
  v_fma_mix_f32 v108, v74, v65, 0 op_sel:[0,0,0] op_sel_hi:[1,0,0]
  v_fma_mix_f32 v109, v74, v65, 0 op_sel:[1,0,0] op_sel_hi:[1,0,0]
  v_fma_mix_f32 v110, v75, v65, 0 op_sel:[0,0,0] op_sel_hi:[1,0,0]
  v_fma_mix_f32 v111, v75, v65, 0 op_sel:[1,0,0] op_sel_hi:[1,0,0]
  v_cvt_pk_bf16_f32 v105, v104, v105
  v_cvt_pk_bf16_f32 v107, v106, v107
  v_cvt_pk_bf16_f32 v109, v108, v109
  v_cvt_pk_bf16_f32 v111, v110, v111
  v_lshlrev_b32 v104, 16, v105
  v_and_b32 v105, 0xffff0000, v105
  v_lshlrev_b32 v106, 16, v107
  v_and_b32 v107, 0xffff0000, v107
  v_lshlrev_b32 v108, 16, v109
  v_and_b32 v109, 0xffff0000, v109
  v_lshlrev_b32 v110, 16, v111
  v_and_b32 v111, 0xffff0000, v111
  v_min_u32 v124, 175, v0
  v_lshlrev_b32 v125, 4, v0
  v_lshlrev_b32 v124, 4, v124
  v_add_u32 v126, 458752, v125
  v_add_u32 v127, 462848, v124
  v_lshrrev_b32 v125, 1, v125
  v_lshrrev_b32 v124, 1, v124
  v_add_u32 v125, 156160, v125
  v_add_u32 v124, 158208, v124
  s_barrier
  ds_read_b128 v[80:83], v16
  ds_read_b128 v[84:87], v17
  ds_read_b128 v[88:91], v18
  ds_read_b128 v[92:95], v16 offset:18432
  ds_read_b128 v[96:99], v19
  ds_read_b128 v[100:103], v20
  s_cmp_ge_u32 s3, 4
  s_cbranch_scc1 M_NPL
  global_load_dwordx4 v[128:131], v126, s[36:37] sc1
  global_load_dwordx4 v[132:135], v127, s[36:37] sc1
M_NPL:

  s_waitcnt lgkmcnt(3)
  v_add_f32 v80, v80, v84
  v_add_f32 v81, v81, v85
  v_add_f32 v82, v82, v86
  v_add_f32 v83, v83, v87
  v_add_f32 v80, v80, v88
  v_add_f32 v81, v81, v89
  v_add_f32 v82, v82, v90
  v_add_f32 v83, v83, v91
  s_waitcnt lgkmcnt(0)
  v_add_f32 v84, v92, v96
  v_add_f32 v85, v93, v97
  v_add_f32 v86, v94, v98
  v_add_f32 v87, v95, v99
  v_add_f32 v84, v84, v100
  v_add_f32 v85, v85, v101
  v_add_f32 v86, v86, v102
  v_add_f32 v87, v87, v103
  v_mul_f32 v80, v70, v80
  v_mul_f32 v81, v70, v81
  v_mul_f32 v82, v70, v82
  v_mul_f32 v83, v70, v83
  v_mul_f32 v84, v71, v84
  v_mul_f32 v85, v71, v85
  v_mul_f32 v86, v71, v86
  v_mul_f32 v87, v71, v87
  v_cvt_pk_bf16_f32 v88, v80, v81
  v_cvt_pk_bf16_f32 v89, v82, v83
  v_cvt_pk_bf16_f32 v90, v84, v85
  v_cvt_pk_bf16_f32 v91, v86, v87
  v_mov_b32 v62, 0x3f80
  v_mov_b32 v63, 0x3f800000
  v_dot2_f32_bf16 v80, v88, v62, v104
  v_dot2_f32_bf16 v81, v88, v63, v105
  v_dot2_f32_bf16 v82, v89, v62, v106
  v_dot2_f32_bf16 v83, v89, v63, v107
  v_dot2_f32_bf16 v84, v90, v62, v108
  v_dot2_f32_bf16 v85, v90, v63, v109
  v_dot2_f32_bf16 v86, v91, v62, v110
  v_dot2_f32_bf16 v87, v91, v63, v111
  v_cvt_pk_bf16_f32 v81, v80, v81
  v_cvt_pk_bf16_f32 v83, v82, v83
  v_cvt_pk_bf16_f32 v85, v84, v85
  v_cvt_pk_bf16_f32 v87, v86, v87
  v_lshlrev_b32 v80, 16, v81
  v_and_b32 v81, 0xffff0000, v81
  v_lshlrev_b32 v82, 16, v83
  v_and_b32 v83, 0xffff0000, v83
  v_lshlrev_b32 v84, 16, v85
  v_and_b32 v85, 0xffff0000, v85
  v_lshlrev_b32 v86, 16, v87
  v_and_b32 v87, 0xffff0000, v87
  v_mul_f32 v80, v66, v80
  v_mul_f32 v81, v66, v81
  v_mul_f32 v82, v66, v82
  v_mul_f32 v83, v66, v83
  v_mul_f32 v84, v67, v84
  v_mul_f32 v85, v67, v85
  v_mul_f32 v86, v67, v86
  v_mul_f32 v87, v67, v87
  v_cvt_pk_bf16_f32 v88, v80, v84
  v_cvt_pk_bf16_f32 v89, v81, v85
  v_cvt_pk_bf16_f32 v90, v82, v86
  v_cvt_pk_bf16_f32 v91, v83, v87
  ds_write_b128 v4, v[88:91]
  ds_read2_b32 v[116:117], v5 offset0:0 offset1:1
  ds_read_b32 v118, v5 offset:8
  ds_read2_b32 v[120:121], v5 offset0:12 offset1:13
  ds_read_b32 v122, v5 offset:56
  s_waitcnt lgkmcnt(2)
  global_store_dwordx4 v6, v[116:119], s[36:37] sc1
  s_waitcnt lgkmcnt(0)
  global_store_dwordx4 v7, v[120:123], s[36:37] sc1

  s_cmp_lg_u32 s3, 5
  s_cbranch_scc1 T_B7
  s_waitcnt vmcnt(2)
T_B7:
  s_barrier
  s_cmp_ge_u32 s3, 4
  s_cbranch_scc1 T_ZW

  s_mov_b32 s41, 65536

  s_waitcnt vmcnt(2)
  s_branch T_PP1
T_PP:
  global_load_dwordx4 v[128:131], v126, s[36:37] sc1
  global_load_dwordx4 v[132:135], v127, s[36:37] sc1
  s_waitcnt vmcnt(0)
T_PP1:
  v_xor_b32 v129, s38, v129
  v_xor_b32 v131, s38, v131
  v_xor_b32 v133, s38, v133
  v_xor_b32 v135, s38, v135
  v_or3_b32 v129, v129, v131, v133
  v_or_b32 v129, v129, v135
  v_cmp_ne_u32 vcc, 0, v129
  s_cbranch_vccz T_PD
  s_sub_u32 s41, s41, 1
  s_cbranch_scc0 T_PP
T_PD:
  ds_write2_b32 v125, v128, v130 offset0:0 offset1:1
  ds_write2_b32 v124, v132, v134 offset0:0 offset1:1

  s_mov_b64 exec, 1
  ds_add_u32 v248, v249 offset:244
  s_mov_b64 exec, -1
  s_cmp_ge_u32 s2, 144
  s_cbranch_scc1 T_NGU
  v_lshrrev_b32 v9, 2, v2
  s_mul_i32 s40, s3, 144
  v_add_u32 v9, s40, v9
  v_mul_u32_u24 v9, 9216, v9
  v_and_b32 v8, 3, v2
  v_lshl_add_u32 v9, v8, 4, v9
  s_lshl_b32 s40, s46, 6
  v_add_u32 v9, s40, v9
  s_mul_i32 s50, s3, 9216
  s_mov_b32 s40, 147456

  s_add_u32 m0, s50, 119296
  v_mov_b32 v8, v9
  global_load_lds_dwordx4 v8, s[22:23]
  s_add_u32 m0, m0, 1024
  v_add_u32 v8, s40, v8
  global_load_lds_dwordx4 v8, s[22:23]
  s_add_u32 m0, m0, 1024
  v_add_u32 v8, s40, v8
  global_load_lds_dwordx4 v8, s[22:23]
  s_add_u32 m0, m0, 1024
  v_add_u32 v8, s40, v8
  global_load_lds_dwordx4 v8, s[22:23]
  s_add_u32 m0, m0, 1024
  v_add_u32 v8, s40, v8
  global_load_lds_dwordx4 v8, s[22:23]
  s_add_u32 m0, m0, 1024
  v_add_u32 v8, s40, v8
  global_load_lds_dwordx4 v8, s[22:23]
  s_add_u32 m0, m0, 1024
  v_add_u32 v8, s40, v8
  global_load_lds_dwordx4 v8, s[22:23]
  s_add_u32 m0, m0, 1024
  v_add_u32 v8, s40, v8
  global_load_lds_dwordx4 v8, s[22:23]
  s_add_u32 m0, m0, 1024
  v_add_u32 v8, s40, v8
  global_load_lds_dwordx4 v8, s[22:23]
T_NGU:
  s_branch T_COM
T_ZW:
  s_sub_u32 s40, s3, 4
  s_lshl_b32 s41, s40, 12
  s_lshl_b32 s50, s2, 14
  s_add_u32 s41, s41, s50
  s_add_u32 s41, s41, 6291456
  v_lshl_add_u32 v211, v2, 4, s41
  s_lshl_b32 s40, s40, 8
  v_lshrrev_b32 v64, 2, v2
  v_lshl_add_u32 v65, v64, 2, s40
  v_and_b32 v66, 3, v2
  v_mul_u32_u24 v67, 3168, v66
  v_add_u32 v208, v65, v67
  v_add_u32 v208, 1536, v208
  v_add_u32 v209, 1056, v208
  v_add_u32 v210, 2112, v208
  s_lshr_b32 s41, s2, 5
  s_sub_u32 s50, 7, s41
  s_min_u32 s41, s41, s50
  v_and_b32 v67, 3, v64
  v_and_b32 v65, -16, v65
  v_add_u32 v65, 9984, v65
  v_mov_b32 v68, 11008
  v_cmp_eq_u32 vcc, s41, v67
  s_nop 1
  v_cndmask_b32 v65, v68, v65, vcc
  v_add_u32 v67, 4, v65
  v_add_u32 v68, 8, v65
  v_add_u32 v69, 12, v65
  v_cmp_eq_u32 vcc, 2, v66
  s_nop 1
  v_cndmask_b32 v210, v210, v65, vcc
  v_cmp_eq_u32 vcc, 3, v66
  s_nop 1
  v_cndmask_b32 v208, v208, v67, vcc
  v_cndmask_b32 v209, v209, v68, vcc
  v_cndmask_b32 v210, v210, v69, vcc

T_COM:
  v_mov_b32 v64, 0
  v_mov_b32 v65, 0
  v_mov_b32 v66, 0
  v_mov_b32 v67, 0
  v_lshlrev_b32 v68, 4, v0
  v_min_u32 v69, 15, v0
  v_lshlrev_b32 v69, 4, v69
  ds_write_b128 v68, v[64:67] offset:11264
  ds_write_b128 v69, v[64:67] offset:19456
  v_mov_b32 v61, 0x3f803f80
  v_mov_b32 v15, 0x3ae38e39

  v_lshlrev_b32 v16, 16, v10
  v_and_b32 v17, 0xffff0000, v10
  v_lshlrev_b32 v18, 16, v11
  v_and_b32 v19, 0xffff0000, v11
  v_lshlrev_b32 v20, 16, v12
  v_and_b32 v21, 0xffff0000, v12
  v_lshlrev_b32 v22, 16, v13
  v_and_b32 v23, 0xffff0000, v13
  v_lshlrev_b32 v24, 16, v14
  v_lshlrev_b32 v4, 4, v2
  v_add_u32 v4, 156160, v4
  v_lshlrev_b32 v5, 1, v2
  v_add_u32 v5, 157184, v5
  s_mul_i32 s40, s3, 1056
  s_add_u32 s40, s40, 1536
  v_lshl_add_u32 v6, v2, 4, s40
  s_lshl_b32 s40, s3, 1
  s_add_u32 s40, s40, 9984
  v_lshl_add_u32 v7, v2, 4, s40

SP_8:
  ds_read_b32 v251, v248 offset:244
  s_waitcnt lgkmcnt(0)
  v_readfirstlane_b32 s94, v251
  s_cmp_ge_u32 s94, 4
  s_cbranch_scc0 SP_8

  ds_read_b128 v[72:75], v4 offset:0
  ds_read_u16 v76, v5 offset:0
  ds_read_b128 v[80:83], v4 offset:1152
  ds_read_u16 v84, v5 offset:1152
  ds_read_b128 v[88:91], v4 offset:2304
  ds_read_u16 v92, v5 offset:2304
  ds_read_b128 v[56:59], v4 offset:3456
  ds_read_u16 v60, v5 offset:3456
  s_waitcnt lgkmcnt(4)

  v_lshlrev_b32 v36, 16, v72
  v_and_b32 v37, 0xffff0000, v72
  v_lshlrev_b32 v38, 16, v73
  v_and_b32 v39, 0xffff0000, v73
  v_lshlrev_b32 v40, 16, v74
  v_and_b32 v41, 0xffff0000, v74
  v_lshlrev_b32 v42, 16, v75
  v_and_b32 v43, 0xffff0000, v75
  v_lshlrev_b32 v44, 16, v76
  v_and_b32 v26, 0xffff, v80
  v_and_b32 v27, 0xffff0000, v80
  v_and_b32 v28, 0xffff, v81
  v_and_b32 v29, 0xffff0000, v81
  v_and_b32 v30, 0xffff, v82
  v_and_b32 v31, 0xffff0000, v82
  v_and_b32 v32, 0xffff, v83
  v_and_b32 v33, 0xffff0000, v83
  v_mov_b32 v34, v84
  s_waitcnt lgkmcnt(2)
  v_and_b32 v46, 0xffff, v88
  v_and_b32 v47, 0xffff0000, v88
  v_and_b32 v48, 0xffff, v89
  v_and_b32 v49, 0xffff0000, v89
  v_and_b32 v50, 0xffff, v90
  v_and_b32 v51, 0xffff0000, v90
  v_and_b32 v52, 0xffff, v91
  v_and_b32 v53, 0xffff0000, v91
  v_mov_b32 v54, v92
  s_cmp_lt_u32 s3, 4
  s_cbranch_scc1 T_B9
  s_mov_b32 s41, 65536

  s_waitcnt vmcnt(0)
T_ZP:
  s_sleep 10
T_ZP1:

  global_load_dwordx4 v[192:195], v211, s[36:37] offset:0 sc1
  global_load_dwordx4 v[196:199], v211, s[36:37] offset:1024 sc1
  global_load_dwordx4 v[200:203], v211, s[36:37] offset:2048 sc1
  global_load_dwordx4 v[204:207], v211, s[36:37] offset:3072 sc1
  s_waitcnt vmcnt(0)
  s_mov_b64 exec, -1
  v_xor_b32 v64, s38, v195
  v_xor_b32 v65, s38, v199
  v_xor_b32 v66, s38, v203
  v_xor_b32 v67, s38, v207
  v_or3_b32 v64, v64, v65, v66
  v_or_b32 v64, v64, v67
  v_cmp_ne_u32 vcc, 0, v64
  s_cbranch_vccz T_ZD
  s_mov_b64 exec, vcc
  s_sub_u32 s41, s41, 1
  s_cbranch_scc0 T_ZP
  s_mov_b64 exec, -1
T_ZD:

  ds_write2_b32 v208, v192, v196 offset0:0 offset1:16
  ds_write2_b32 v209, v193, v197 offset0:0 offset1:16
  ds_write2_b32 v210, v194, v198 offset0:0 offset1:16
  ds_write2_b32 v208, v200, v204 offset0:32 offset1:48
  ds_write2_b32 v209, v201, v205 offset0:32 offset1:48
  ds_write2_b32 v210, v202, v206 offset0:32 offset1:48
T_B9:
  s_waitcnt lgkmcnt(0)
  s_barrier
  ds_read_b128 v[64:67], v6
  ds_read_u16 v68, v7
  s_waitcnt lgkmcnt(0)

  s_cmp_ge_u32 s2, 144
  s_cbranch_scc1 T_NUP
  s_cmp_ge_u32 s3, 4
  s_cbranch_scc1 T_NUP
  v_lshrrev_b32 v9, 2, v2
  s_mul_i32 s40, s3, 144
  v_add_u32 v9, s40, v9
  v_mul_u32_u24 v9, 9216, v9
  v_and_b32 v8, 3, v2
  v_lshl_add_u32 v9, v8, 4, v9
  s_lshl_b32 s40, s46, 6
  v_add_u32 v9, s40, v9
  s_mul_i32 s50, s3, 9216
  s_mov_b32 s40, 147456

  s_add_u32 m0, s50, 45568
  v_mov_b32 v8, v9
  global_load_lds_dwordx4 v8, s[24:25]
  s_add_u32 m0, m0, 1024
  v_add_u32 v8, s40, v8
  global_load_lds_dwordx4 v8, s[24:25]
  s_add_u32 m0, m0, 1024
  v_add_u32 v8, s40, v8
  global_load_lds_dwordx4 v8, s[24:25]
  s_add_u32 m0, m0, 1024
  v_add_u32 v8, s40, v8
  global_load_lds_dwordx4 v8, s[24:25]
  s_add_u32 m0, m0, 1024
  v_add_u32 v8, s40, v8
  global_load_lds_dwordx4 v8, s[24:25]
  s_add_u32 m0, m0, 1024
  v_add_u32 v8, s40, v8
  global_load_lds_dwordx4 v8, s[24:25]
  s_add_u32 m0, m0, 1024
  v_add_u32 v8, s40, v8
  global_load_lds_dwordx4 v8, s[24:25]
  s_add_u32 m0, m0, 1024
  v_add_u32 v8, s40, v8
  global_load_lds_dwordx4 v8, s[24:25]
  s_add_u32 m0, m0, 1024
  v_add_u32 v8, s40, v8
  global_load_lds_dwordx4 v8, s[24:25]
T_NUP:
  s_cmp_ge_u32 s3, 3
  s_cbranch_scc1 T_NT
  s_lshr_b32 s64, s2, 3
  s_mul_i32 s64, s64, 162
  s_mul_i32 s65, s3, 54
  s_add_u32 s64, s64, s65
  s_and_b32 s65, s2, 7
  s_mul_i32 s65, s65, 5184
  s_add_u32 s64, s64, s65
  v_min_u32 v252, 53, v2
  v_add_u32 v252, s64, v252
  v_lshlrev_b32 v252, 7, v252

  global_load_dword v250, v252, s[26:27]
T_NT:
  v_dot2_f32_bf16 v78, v68, v62, v24
  v_dot2_f32_bf16 v70, v64, v62, v16
  v_dot2_f32_bf16 v71, v64, v63, v17
  v_dot2_f32_bf16 v72, v65, v62, v18
  v_dot2_f32_bf16 v73, v65, v63, v19
  v_dot2_f32_bf16 v74, v66, v62, v20
  v_dot2_f32_bf16 v75, v66, v63, v21
  v_dot2_f32_bf16 v76, v67, v62, v22
  v_dot2_f32_bf16 v77, v67, v63, v23
  v_cvt_pk_bf16_f32 v80, v70, v71
  v_cvt_pk_bf16_f32 v81, v72, v73
  v_cvt_pk_bf16_f32 v82, v74, v75
  v_cvt_pk_bf16_f32 v83, v76, v77
  v_cvt_pk_bf16_f32 v84, v78, 0
  v_dot2_f32_bf16 v86, v80, v61, 0
  v_dot2_f32_bf16 v88, v80, v80, 0
  v_dot2_f32_bf16 v86, v81, v61, v86
  v_dot2_f32_bf16 v88, v81, v81, v88
  v_dot2_f32_bf16 v86, v82, v61, v86
  v_dot2_f32_bf16 v88, v82, v82, v88
  v_dot2_f32_bf16 v86, v83, v61, v86
  v_dot2_f32_bf16 v88, v83, v83, v88
  v_dot2_f32_bf16 v86, v84, v61, v86
  v_dot2_f32_bf16 v88, v84, v84, v88
  s_nop 1
  v_add_f32 v86, v86, v86 row_shr:1 row_mask:0xf bank_mask:0xf bound_ctrl:0
  v_add_f32 v88, v88, v88 row_shr:1 row_mask:0xf bank_mask:0xf bound_ctrl:0
  s_nop 0
  v_add_f32 v86, v86, v86 row_shr:2 row_mask:0xf bank_mask:0xf bound_ctrl:0
  v_add_f32 v88, v88, v88 row_shr:2 row_mask:0xf bank_mask:0xf bound_ctrl:0
  s_nop 0
  v_add_f32 v86, v86, v86 row_shr:4 row_mask:0xf bank_mask:0xf bound_ctrl:0
  v_add_f32 v88, v88, v88 row_shr:4 row_mask:0xf bank_mask:0xf bound_ctrl:0
  s_nop 0
  v_add_f32 v86, v86, v86 row_shr:8 row_mask:0xf bank_mask:0xf bound_ctrl:0
  v_add_f32 v88, v88, v88 row_shr:8 row_mask:0xf bank_mask:0xf bound_ctrl:0
  s_nop 0
  v_add_f32 v86, v86, v86 row_bcast:15 row_mask:0xa bank_mask:0xf
  v_add_f32 v88, v88, v88 row_bcast:15 row_mask:0xa bank_mask:0xf
  s_nop 0
  v_add_f32 v86, v86, v86 row_bcast:31 row_mask:0xc bank_mask:0xf
  v_add_f32 v88, v88, v88 row_bcast:31 row_mask:0xc bank_mask:0xf
  s_nop 0
  v_readlane_b32 s66, v86, 63
  v_readlane_b32 s67, v88, 63
  s_nop 0
  v_mul_f32 v86, s66, v15
  v_mul_f32 v87, s67, v15
  v_mul_f32 v88, v86, v86
  v_fma_f32 v87, -v86, v86, v87
  v_mul_f32 v89, 0x41800000, v87
  v_cmp_gt_f32 vcc, v88, v89
  s_cbranch_vccz T_FAST
  v_sub_f32 v89, 0, v86

  v_dot2_f32_bf16 v78, v84, v62, v89
  v_dot2_f32_bf16 v70, v80, v62, v89
  v_dot2_f32_bf16 v71, v80, v63, v89
  v_dot2_f32_bf16 v72, v81, v62, v89
  v_dot2_f32_bf16 v73, v81, v63, v89
  v_dot2_f32_bf16 v74, v82, v62, v89
  v_dot2_f32_bf16 v75, v82, v63, v89
  v_dot2_f32_bf16 v76, v83, v62, v89
  v_dot2_f32_bf16 v77, v83, v63, v89
  v_mul_f32 v88, v78, v78
  v_fmac_f32 v88, v70, v70
  v_fmac_f32 v88, v71, v71
  v_fmac_f32 v88, v72, v72
  v_fmac_f32 v88, v73, v73
  v_fmac_f32 v88, v74, v74
  v_fmac_f32 v88, v75, v75
  v_fmac_f32 v88, v76, v76
  v_fmac_f32 v88, v77, v77
  s_nop 1
  v_add_f32 v88, v88, v88 row_shr:1 row_mask:0xf bank_mask:0xf bound_ctrl:0
  s_nop 1
  v_add_f32 v88, v88, v88 row_shr:2 row_mask:0xf bank_mask:0xf bound_ctrl:0
  s_nop 1
  v_add_f32 v88, v88, v88 row_shr:4 row_mask:0xf bank_mask:0xf bound_ctrl:0
  s_nop 1
  v_add_f32 v88, v88, v88 row_shr:8 row_mask:0xf bank_mask:0xf bound_ctrl:0
  s_nop 1
  v_add_f32 v88, v88, v88 row_bcast:15 row_mask:0xa bank_mask:0xf
  s_nop 1
  v_add_f32 v88, v88, v88 row_bcast:31 row_mask:0xc bank_mask:0xf
  s_nop 1
  v_readlane_b32 s67, v88, 63
  s_nop 1
  v_mul_f32 v87, s67, v15
T_FAST:
  v_cvt_pk_bf16_f32 v87, -v86, v87
  v_lshlrev_b32 v86, 16, v87
  v_and_b32 v87, 0xffff0000, v87
  v_add_f32 v87, 0x3727c5ac, v87
  v_cvt_pk_bf16_f32 v87, v87, v87
  v_lshlrev_b32 v87, 16, v87
  v_sqrt_f32 v87, v87

  v_dot2_f32_bf16 v78, v84, v62, v86
  v_dot2_f32_bf16 v70, v80, v62, v86
  v_dot2_f32_bf16 v71, v80, v63, v86
  v_dot2_f32_bf16 v72, v81, v62, v86
  v_dot2_f32_bf16 v73, v81, v63, v86
  v_dot2_f32_bf16 v74, v82, v62, v86
  v_dot2_f32_bf16 v75, v82, v63, v86
  v_dot2_f32_bf16 v76, v83, v62, v86
  v_dot2_f32_bf16 v77, v83, v63, v86
  v_cvt_pk_bf16_f32 v87, v87, v87
  v_lshlrev_b32 v87, 16, v87
  v_rcp_f32 v87, v87

  v_cvt_pk_bf16_f32 v78, v78, v78
  v_lshlrev_b32 v78, 16, v78
  v_cvt_pk_bf16_f32 v71, v70, v71
  v_cvt_pk_bf16_f32 v73, v72, v73
  v_cvt_pk_bf16_f32 v75, v74, v75
  v_cvt_pk_bf16_f32 v77, v76, v77
  v_lshlrev_b32 v70, 16, v71
  v_and_b32 v71, 0xffff0000, v71
  v_lshlrev_b32 v72, 16, v73
  v_and_b32 v73, 0xffff0000, v73
  v_lshlrev_b32 v74, 16, v75
  v_and_b32 v75, 0xffff0000, v75
  v_lshlrev_b32 v76, 16, v77
  v_and_b32 v77, 0xffff0000, v77
  v_mul_f32 v78, v78, v87
  v_pk_mul_f32 v[70:71], v[70:71], v[86:87] op_sel:[0,1] op_sel_hi:[1,1]
  v_pk_mul_f32 v[72:73], v[72:73], v[86:87] op_sel:[0,1] op_sel_hi:[1,1]
  v_pk_mul_f32 v[74:75], v[74:75], v[86:87] op_sel:[0,1] op_sel_hi:[1,1]
  v_pk_mul_f32 v[76:77], v[76:77], v[86:87] op_sel:[0,1] op_sel_hi:[1,1]
  v_cvt_pk_bf16_f32 v64, v70, v71
  v_cvt_pk_bf16_f32 v65, v72, v73
  v_cvt_pk_bf16_f32 v66, v74, v75
  v_cvt_pk_bf16_f32 v67, v76, v77
  v_cvt_pk_bf16_f32 v68, v78, 0
  v_dot2_f32_bf16 v78, v68, v34, 0
  v_dot2_f32_bf16 v70, v64, v26, 0
  v_dot2_f32_bf16 v71, v64, v27, 0
  v_dot2_f32_bf16 v72, v65, v28, 0
  v_dot2_f32_bf16 v73, v65, v29, 0
  v_dot2_f32_bf16 v74, v66, v30, 0
  v_dot2_f32_bf16 v75, v66, v31, 0
  v_dot2_f32_bf16 v76, v67, v32, 0
  v_dot2_f32_bf16 v77, v67, v33, 0
  v_cvt_pk_bf16_f32 v64, v70, v71
  v_cvt_pk_bf16_f32 v65, v72, v73
  v_cvt_pk_bf16_f32 v66, v74, v75
  v_cvt_pk_bf16_f32 v67, v76, v77
  v_cvt_pk_bf16_f32 v68, v78, 0
  v_dot2_f32_bf16 v78, v68, v62, v44
  v_dot2_f32_bf16 v70, v64, v62, v36
  v_dot2_f32_bf16 v71, v64, v63, v37
  v_dot2_f32_bf16 v72, v65, v62, v38
  v_dot2_f32_bf16 v73, v65, v63, v39
  v_dot2_f32_bf16 v74, v66, v62, v40
  v_dot2_f32_bf16 v75, v66, v63, v41
  v_dot2_f32_bf16 v76, v67, v62, v42
  v_dot2_f32_bf16 v77, v67, v63, v43
  v_cvt_pk_bf16_f32 v96, v70, v71
  v_cvt_pk_bf16_f32 v97, v72, v73
  v_cvt_pk_bf16_f32 v98, v74, v75
  v_cvt_pk_bf16_f32 v99, v76, v77
  v_cvt_pk_bf16_f32 v100, v78, 0
  v_dot2_f32_bf16 v86, v96, v56, 0
  v_dot2_f32_bf16 v86, v97, v57, v86
  v_dot2_f32_bf16 v86, v98, v58, v86
  v_dot2_f32_bf16 v86, v99, v59, v86
  v_dot2_f32_bf16 v86, v100, v60, v86
  s_lshl_b32 s40, s2, 3
  s_add_u32 s40, s40, s3
  s_sub_u32 s40, 0xffff, s40

  v_add_f32 v86, v86, v86 row_shr:1 row_mask:0xf bank_mask:0xf bound_ctrl:0
  s_nop 1
  v_add_f32 v86, v86, v86 row_shr:2 row_mask:0xf bank_mask:0xf bound_ctrl:0
  s_nop 1
  v_add_f32 v86, v86, v86 row_shr:4 row_mask:0xf bank_mask:0xf bound_ctrl:0
  s_nop 1
  v_add_f32 v86, v86, v86 row_shr:8 row_mask:0xf bank_mask:0xf bound_ctrl:0
  s_nop 1
  v_add_f32 v86, v86, v86 row_bcast:15 row_mask:0xa bank_mask:0xf
  s_nop 1
  v_add_f32 v86, v86, v86 row_bcast:31 row_mask:0xc bank_mask:0xf
  s_nop 1
  v_cvt_pk_bf16_f32 v86, v86, v86
  s_lshl_b32 s41, s3, 3
  v_mov_b32 v88, s41
  v_readlane_b32 s47, v86, 63
  v_mov_b32 v87, s38
  s_and_b32 s47, s47, 0xffff0000
  s_ashr_i32 s41, s47, 31
  s_or_b32 s41, s41, 0x80000000
  s_xor_b32 s47, s47, s41
  s_and_b32 s47, s47, 0xffff0000
  s_or_b32 s47, s47, s40
  v_mov_b32 v86, s47
  s_mov_b64 exec, 1
  ds_write_b64 v88, v[86:87] offset:320
  ds_add_u32 v248, v249 offset:248
  s_mov_b64 exec, -1
  v_and_b32 v4, 3, v2
  v_lshlrev_b32 v4, 4, v4
  v_lshrrev_b32 v5, 2, v2
  v_lshlrev_b32 v5, 14, v5
  s_lshl_b32 s41, s2, 6
  s_add_u32 s41, s41, 65536
  v_add3_u32 v5, v5, v4, s41
  s_mov_b32 s41, s3
  s_cmp_lg_u32 s3, 7
  s_cbranch_scc1 T_NK
T_KS:
  ds_read_b32 v89, v248 offset:248
  ds_read_b128 v[108:111], v4 offset:320
  s_waitcnt lgkmcnt(0)
  v_readfirstlane_b32 s94, v89
  s_cmp_ge_u32 s94, 8
  s_cbranch_scc0 T_KS
  s_mov_b32 exec_hi, 0
  s_waitcnt lgkmcnt(0)
  global_store_dwordx4 v5, v[108:111], s[36:37] sc1
  s_mov_b64 exec, -1
T_NK:

  v_dot2_f32_bf16 v78, v100, v54, 0
  v_dot2_f32_bf16 v70, v96, v46, 0
  v_dot2_f32_bf16 v71, v96, v47, 0
  v_dot2_f32_bf16 v72, v97, v48, 0
  v_dot2_f32_bf16 v73, v97, v49, 0
  v_dot2_f32_bf16 v74, v98, v50, 0
  v_dot2_f32_bf16 v75, v98, v51, 0
  v_dot2_f32_bf16 v76, v99, v52, 0
  v_dot2_f32_bf16 v77, v99, v53, 0
  v_lshlrev_b32 v16, 16, v80
  v_and_b32 v17, 0xffff0000, v80
  v_lshlrev_b32 v18, 16, v81
  v_and_b32 v19, 0xffff0000, v81
  v_lshlrev_b32 v20, 16, v82
  v_and_b32 v21, 0xffff0000, v82
  v_lshlrev_b32 v22, 16, v83
  v_and_b32 v23, 0xffff0000, v83
  v_lshlrev_b32 v24, 16, v84
  v_cvt_pk_bf16_f32 v64, v70, v71
  v_cvt_pk_bf16_f32 v65, v72, v73
  v_cvt_pk_bf16_f32 v66, v74, v75
  v_cvt_pk_bf16_f32 v67, v76, v77
  v_cvt_pk_bf16_f32 v68, v78, 0
  v_dot2_f32_bf16 v78, v68, v62, v24
  v_dot2_f32_bf16 v70, v64, v62, v16
  v_dot2_f32_bf16 v71, v64, v63, v17
  v_dot2_f32_bf16 v72, v65, v62, v18
  v_dot2_f32_bf16 v73, v65, v63, v19
  v_dot2_f32_bf16 v74, v66, v62, v20
  v_dot2_f32_bf16 v75, v66, v63, v21
  v_dot2_f32_bf16 v76, v67, v62, v22
  v_dot2_f32_bf16 v77, v67, v63, v23
  s_and_b32 s40, s2, 7
  s_lshl_b32 s40, s40, 14
  s_lshl_b32 s50, s3, 11
  s_add_u32 s40, s40, s50
  s_add_u32 s40, s40, 65536
  v_lshl_add_u32 v6, v2, 4, s40

  v_cvt_pk_bf16_f32 v102, v70, v71
  v_cvt_pk_bf16_f32 v103, v72, v73
  v_cvt_pk_bf16_f32 v104, v74, v75
  v_cvt_pk_bf16_f32 v105, v76, v77
  v_cvt_pk_bf16_f32 v106, v78, 0
  s_cmp_lg_u32 s41, 7
  s_cbranch_scc1 T_NK2

  s_waitcnt vmcnt(0)
  s_mov_b64 exec, 1
  ds_add_u32 v248, v249 offset:256
  s_mov_b64 exec, -1
T_NK2:

  s_cmp_ge_u32 s2, 144
  s_cbranch_scc1 T_NW
  s_cmp_ge_u32 s3, 4
  s_cbranch_scc1 T_W2
  s_waitcnt vmcnt(0)

  s_mov_b64 exec, 1
  ds_add_u32 v248, v249 offset:260
  s_mov_b64 exec, -1
T_W2:
  v_bfe_u32 v7, v2, 2, 2
  v_lshrrev_b32 v8, 4, v2
  v_lshl_add_u32 v7, v8, 3, v7
  v_and_b32 v8, 3, v2
  v_lshlrev_b32 v8, 3, v8
  v_mul_u32_u24 v21, 1152, v7
  v_add_u32 v21, v21, v8
  s_lshl_b32 s40, s3, 5
  s_add_u32 s40, s40, 82432
  v_add_u32 v21, s40, v21
  v_lshl_add_u32 v7, v7, 6, v8
  s_lshr_b32 s40, s3, 1
  s_mul_i32 s50, s40, 5
  s_cmp_eq_u32 s40, 3
  s_cselect_b32 s50, 14, s50
  s_lshl_b32 s51, s50, 11
  s_and_b32 s40, s3, 1
  s_lshl_b32 s40, s40, 5
  s_add_u32 s40, s40, s51
  s_add_u32 s40, s40, 45568
  v_add_u32 v7, s40, v7
  v_add_u32 v8, 73728, v7

SP_9:
  ds_read_b32 v251, v248 offset:260
  s_waitcnt lgkmcnt(0)
  v_readfirstlane_b32 s94, v251
  s_cmp_ge_u32 s94, 4
  s_cbranch_scc0 SP_9

  ds_read_b64_tr_b16 v[136:137], v8 offset:0
  ds_read_b64_tr_b16 v[138:139], v8 offset:256
  ds_read_b64_tr_b16 v[140:141], v7 offset:0
  ds_read_b64_tr_b16 v[142:143], v7 offset:256
  ds_read_b64_tr_b16 v[144:145], v8 offset:2048
  ds_read_b64_tr_b16 v[146:147], v8 offset:2304
  ds_read_b64_tr_b16 v[148:149], v7 offset:2048
  ds_read_b64_tr_b16 v[150:151], v7 offset:2304
  ds_read_b64_tr_b16 v[152:153], v8 offset:4096
  ds_read_b64_tr_b16 v[154:155], v8 offset:4352
  ds_read_b64_tr_b16 v[156:157], v7 offset:4096
  ds_read_b64_tr_b16 v[158:159], v7 offset:4352
  ds_read_b64_tr_b16 v[160:161], v8 offset:6144
  ds_read_b64_tr_b16 v[162:163], v8 offset:6400
  ds_read_b64_tr_b16 v[164:165], v7 offset:6144
  ds_read_b64_tr_b16 v[166:167], v7 offset:6400
  ds_read_b64_tr_b16 v[168:169], v8 offset:8192
  ds_read_b64_tr_b16 v[170:171], v8 offset:8448
  ds_read_b64_tr_b16 v[172:173], v7 offset:8192
  ds_read_b64_tr_b16 v[174:175], v7 offset:8448
  s_cmp_ge_u32 s2, 144
  s_cbranch_scc1 T_NDN
  s_cmp_ge_u32 s3, 4
  s_cbranch_scc1 T_NDN
  s_mul_i32 s40, s46, 36864
  s_mul_i32 s51, s3, 9216
  s_add_u32 s40, s40, s51
  s_add_u32 m0, s51, 82432
  v_lshl_add_u32 v9, v2, 4, s40

  global_load_lds_dwordx4 v9, s[26:27] offset:0
  global_load_lds_dwordx4 v9, s[26:27] offset:1024
  global_load_lds_dwordx4 v9, s[26:27] offset:2048
  s_add_u32 m0, m0, 3072
  v_add_u32 v9, 3072, v9
  global_load_lds_dwordx4 v9, s[26:27] offset:0
  global_load_lds_dwordx4 v9, s[26:27] offset:1024
  global_load_lds_dwordx4 v9, s[26:27] offset:2048
  s_add_u32 m0, m0, 3072
  v_add_u32 v9, 3072, v9
  global_load_lds_dwordx4 v9, s[26:27] offset:0
  global_load_lds_dwordx4 v9, s[26:27] offset:1024
  global_load_lds_dwordx4 v9, s[26:27] offset:2048
T_NDN:
T_NW:
  v_and_b32 v4, 3, v2
  v_lshlrev_b32 v4, 3, v4
  s_lshl_b32 s77, s3, 2
  s_add_u32 s77, s77, 11264
  v_lshlrev_b32 v5, 5, v2
  s_mov_b32 s41, 65536

SP_10:
  ds_read_b32 v251, v248 offset:256
  s_waitcnt lgkmcnt(0)
  v_readfirstlane_b32 s94, v251
  s_cmp_ge_u32 s94, 1
  s_cbranch_scc0 SP_10

  s_cmp_lt_u32 s2, 144
  s_cbranch_scc1 T_KP1
T_KP:
  s_sleep 14
T_KP1:
  global_load_dwordx4 v[108:111], v6, s[36:37] offset:0 sc1
  global_load_dwordx4 v[112:115], v6, s[36:37] offset:1024 sc1
  s_waitcnt vmcnt(0)
  s_mov_b64 exec, -1
  v_xor_b32 v64, s38, v109
  v_xor_b32 v65, s38, v111
  v_xor_b32 v66, s38, v113
  v_xor_b32 v67, s38, v115
  v_or3_b32 v64, v64, v65, v66
  v_or_b32 v64, v64, v67
  v_cmp_ne_u32 vcc, 0, v64
  s_cbranch_vccz T_KD
  s_mov_b64 exec, vcc
  s_sub_u32 s41, s41, 1
  s_cbranch_scc0 T_KP
  s_mov_b64 exec, -1
T_KD:

  v_max_u32 v64, v108, v112
  v_max_u32 v65, v110, v114
  s_nop 0
  v_max_u32 v64, v64, v64 row_shr:4 row_mask:0xf bank_mask:0xf bound_ctrl:0
  v_max_u32 v65, v65, v65 row_shr:4 row_mask:0xf bank_mask:0xf bound_ctrl:0
  s_nop 0
  v_max_u32 v64, v64, v64 row_shr:8 row_mask:0xf bank_mask:0xf bound_ctrl:0
  v_max_u32 v65, v65, v65 row_shr:8 row_mask:0xf bank_mask:0xf bound_ctrl:0
  s_mov_b32 exec_lo, 0xf000f000
  s_mov_b32 exec_hi, 0xf000f000
  ds_max_u32 v4, v64 offset:288
  ds_max_u32 v4, v65 offset:292
  s_mov_b64 exec, -1
  s_waitcnt lgkmcnt(0)
  s_barrier
  ds_read_b128 v[64:67], v248 offset:288
  ds_read_b128 v[68:71], v248 offset:304
  s_waitcnt lgkmcnt(0)
  v_min3_u32 v64, v64, v65, v66
  v_min3_u32 v68, v68, v69, v70
  v_min3_u32 v64, v64, v67, v71
  v_min_u32 v64, v64, v68
  s_mov_b32 s74, 0

  v_cmp_ge_u32 s[66:67], v108, v64
  v_cmp_ge_u32 s[68:69], v110, v64
  v_cmp_ge_u32 s[70:71], v112, v64
  v_cmp_ge_u32 s[72:73], v114, v64
  s_mov_b64 exec, s[66:67]
  s_cbranch_execz CK_11
  v_mov_b32 v68, s74
  v_mbcnt_lo_u32_b32 v68, s66, v68
  v_mbcnt_hi_u32_b32 v68, s67, v68
  s_bcnt1_i32_b64 s75, exec
  v_lshl_add_u32 v68, v68, 5, s77
  s_add_u32 s74, s74, s75
  ds_write_b32 v68, v108
CK_11:

  s_mov_b64 exec, s[68:69]
  s_cbranch_execz CK_12
  v_mov_b32 v68, s74
  v_mbcnt_lo_u32_b32 v68, s68, v68
  v_mbcnt_hi_u32_b32 v68, s69, v68
  s_bcnt1_i32_b64 s75, exec
  v_lshl_add_u32 v68, v68, 5, s77
  s_add_u32 s74, s74, s75
  ds_write_b32 v68, v110
CK_12:

  s_mov_b64 exec, s[70:71]
  s_cbranch_execz CK_13
  v_mov_b32 v68, s74
  v_mbcnt_lo_u32_b32 v68, s70, v68
  v_mbcnt_hi_u32_b32 v68, s71, v68
  s_bcnt1_i32_b64 s75, exec
  v_lshl_add_u32 v68, v68, 5, s77
  s_add_u32 s74, s74, s75
  ds_write_b32 v68, v112
CK_13:

  s_mov_b64 exec, s[72:73]
  s_cbranch_execz CK_14
  v_mov_b32 v68, s74
  v_mbcnt_lo_u32_b32 v68, s72, v68
  v_mbcnt_hi_u32_b32 v68, s73, v68
  s_bcnt1_i32_b64 s75, exec
  v_lshl_add_u32 v68, v68, 5, s77
  s_add_u32 s74, s74, s75
  ds_write_b32 v68, v114
CK_14:

  s_mov_b64 exec, 1
  v_mov_b32 v65, s74
  ds_max_u32 v248, v65 offset:252
  s_mov_b64 exec, -1
  s_mov_b32 s48, 0
  s_mov_b32 s76, 0
  s_waitcnt lgkmcnt(0)
  s_barrier
  ds_read_b32 v72, v248 offset:252
T_OUT:
  ds_read_b128 v[64:67], v5 offset:11264
  ds_read_b128 v[68:71], v5 offset:11280
  v_add_u32 v5, 2048, v5
  s_add_u32 s76, s76, 64
  s_waitcnt lgkmcnt(1)
  v_readfirstlane_b32 s74, v72

  v_cmp_lt_u32 s[66:67], s47, v64
  v_cmp_lt_u32 s[68:69], s47, v65
  v_cmp_lt_u32 s[70:71], s47, v66
  v_cmp_lt_u32 s[72:73], s47, v67
  s_waitcnt lgkmcnt(0)
  v_cmp_lt_u32 s[80:81], s47, v68
  v_cmp_lt_u32 s[82:83], s47, v69
  v_cmp_lt_u32 s[84:85], s47, v70
  v_cmp_lt_u32 s[86:87], s47, v71
  s_bcnt1_i32_b64 s75, s[66:67]
  s_add_u32 s48, s48, s75
  s_bcnt1_i32_b64 s75, s[68:69]
  s_add_u32 s48, s48, s75
  s_bcnt1_i32_b64 s75, s[70:71]
  s_add_u32 s48, s48, s75
  s_bcnt1_i32_b64 s75, s[72:73]
  s_add_u32 s48, s48, s75
  s_bcnt1_i32_b64 s75, s[80:81]
  s_add_u32 s48, s48, s75
  s_bcnt1_i32_b64 s75, s[82:83]
  s_add_u32 s48, s48, s75
  s_bcnt1_i32_b64 s75, s[84:85]
  s_add_u32 s48, s48, s75
  s_bcnt1_i32_b64 s75, s[86:87]
  s_add_u32 s48, s48, s75
  s_min_u32 s74, s74, 256
  s_cmp_lt_u32 s76, s74
  s_cbranch_scc1 T_OUT

  s_lshl_b32 s40, s2, 3
  s_add_u32 s40, s40, s3
  s_mul_i32 s40, s40, 1152
  v_mov_b32 v18, 0
  v_mov_b32 v19, 0
  s_cmp_lt_u32 s48, 8
  s_cbranch_scc0 T_STO
  s_mul_i32 s40, s48, 3200
  s_add_u32 s40, s40, 393216
  v_lshl_add_u32 v4, v2, 4, s40
  v_mov_b32 v64, v99
  v_mov_b32 v65, v83
  v_lshl_or_b32 v66, v84, 16, v100
  v_mov_b32 v67, s38
  v_mov_b32 v99, s38
  v_mov_b32 v83, s38
  v_mov_b32 v68, s47
  v_mov_b32 v69, s38
  v_mov_b32 v70, s47
  v_mov_b32 v71, s38

  global_store_dwordx4 v4, v[96:99], s[36:37] sc1
  global_store_dwordx4 v4, v[64:67], s[36:37] offset:1024 sc1
  global_store_dwordx4 v4, v[80:83], s[36:37] offset:2048 sc1
  s_mov_b64 exec, 0xff
  global_store_dwordx4 v4, v[68:71], s[36:37] offset:3072 sc1
  s_mov_b64 exec, -1
  s_branch T_STD
T_STO:
  v_lshl_add_u32 v18, v2, 4, s40
  v_lshl_add_u32 v19, v2, 1, s40

  global_store_dwordx4 v18, v[102:105], s[32:33]
  global_store_short v19, v106, s[32:33] offset:1024
T_STD:
  s_cmp_ge_u32 s2, 144
  s_cbranch_scc1 T_END
  s_mul_i32 s40, s3, 3200
  s_lshr_b32 s41, s2, 3
  s_and_b32 s41, s41, 0
  s_mul_i32 s41, s41, 25600
  s_add_u32 s40, s40, s41
  s_add_u32 s40, s40, 393216
  v_lshl_add_u32 v4, v2, 4, s40
  v_mov_b32 v22, s40
  s_lshl_b32 s40, s3, 2
  v_mov_b32 v23, s40
  s_mul_i32 s40, s3, 1168
  s_add_u32 s40, s40, 19712
  v_lshl_add_u32 v5, v2, 4, s40
  v_lshl_add_u32 v6, v2, 1, s40
  s_mov_b32 s41, 65536

  v_and_b32 v7, 7, v2
  v_mul_u32_u24 v17, 80, v7
  v_mul_u32_u24 v7, 1168, v7
  v_and_b32 v8, 0x30, v2
  v_add_u32 v17, v17, v8
  s_lshl_b32 s40, s50, 6
  s_add_u32 s40, s40, 19712
  v_add3_u32 v7, v7, v8, s40
  s_lshl_b32 s40, s3, 10
  s_add_u32 s40, s40, 1536
  v_lshl_add_u32 v8, v2, 4, s40
  v_and_b32 v9, 1, v2
  v_lshlrev_b32 v9, 9, v9
  v_bfe_u32 v16, v2, 1, 4
  v_lshl_add_u32 v9, v16, 4, v9
  v_lshrrev_b32 v16, 5, v2
  v_lshl_add_u32 v9, v16, 10, v9
  s_lshr_b32 s40, s3, 2
  s_lshl_b32 s40, s40, 8
  s_and_b32 s51, s3, 3
  s_lshl_b32 s51, s51, 2
  s_add_u32 s40, s40, s51
  s_add_u32 s40, s40, 1536
  v_add_u32 v9, s40, v9
  s_mul_i32 s40, s3, 80
  v_and_b32 v16, -2, v2
  v_add_u32 v16, s40, v16
T_RP:
  s_sleep 5
  global_load_dwordx4 v[64:67], v4, s[36:37] sc1
  global_load_dwordx4 v[68:71], v4, s[36:37] offset:1024 sc1
  global_load_dwordx4 v[72:75], v4, s[36:37] offset:2048 sc1
  global_load_dwordx2 v[80:81], v22, s[36:37] offset:3072 sc1
  s_waitcnt vmcnt(0)
  v_xor_b32 v76, s38, v67
  v_xor_b32 v77, s38, v71
  v_xor_b32 v78, s38, v75
  v_xor_b32 v79, s38, v81
  v_or3_b32 v76, v76, v77, v78
  v_or_b32 v76, v76, v79
  v_cmp_ne_u32 vcc, 0, v76
  s_cbranch_vccz T_RD
  s_sub_u32 s41, s41, 1
  s_cbranch_scc0 T_RP
T_RD:
  v_mov_b32 v67, v68
  v_mov_b32 v75, v69
  ds_write_b128 v5, v[64:67]
  ds_write_b16 v6, v70 offset:1024
  ds_write_b128 v5, v[72:75] offset:9344
  ds_write_b16_d16_hi v6, v70 offset:10368
  ds_write_b32 v23, v80 offset:384
  s_waitcnt lgkmcnt(3)

  s_barrier
  ds_read_b128 v[64:67], v7 offset:0
  ds_read_b128 v[68:71], v7 offset:64
  ds_read_b128 v[72:75], v7 offset:128
  ds_read_b128 v[76:79], v7 offset:192
  ds_read_b128 v[80:83], v7 offset:256
  s_waitcnt lgkmcnt(4)
  v_mfma_f32_16x16x32_bf16 v[84:87], v[64:67], v[136:139], 0
  v_mfma_f32_16x16x32_bf16 v[88:91], v[64:67], v[140:143], 0
  s_waitcnt lgkmcnt(3)
  v_mfma_f32_16x16x32_bf16 v[84:87], v[68:71], v[144:147], v[84:87]
  v_mfma_f32_16x16x32_bf16 v[88:91], v[68:71], v[148:151], v[88:91]
  s_waitcnt lgkmcnt(2)
  v_mfma_f32_16x16x32_bf16 v[84:87], v[72:75], v[152:155], v[84:87]
  v_mfma_f32_16x16x32_bf16 v[88:91], v[72:75], v[156:159], v[88:91]
  s_waitcnt lgkmcnt(1)
  v_mfma_f32_16x16x32_bf16 v[84:87], v[76:79], v[160:163], v[84:87]
  v_mfma_f32_16x16x32_bf16 v[88:91], v[76:79], v[164:167], v[88:91]
  s_cmp_ge_u32 s3, 4
  s_cbranch_scc1 T_G4
  s_waitcnt lgkmcnt(0)
  v_mfma_f32_16x16x32_bf16 v[84:87], v[80:83], v[168:171], v[84:87]
  v_mfma_f32_16x16x32_bf16 v[88:91], v[80:83], v[172:175], v[88:91]
T_G4:
  v_lshrrev_b32 v18, 5, v2
  v_lshlrev_b32 v18, 5, v18
  v_bfe_u32 v19, v2, 3, 2
  v_add_u32 v18, v18, v19
  s_lshl_b32 s40, s3, 2
  v_add_u32 v18, s40, v18
  v_mul_u32_u24 v18, 18432, v18
  s_mov_b32 exec_hi, 0
  ds_write_b128 v8, v[84:87]
  ds_write_b128 v8, v[88:91] offset:512
  s_mov_b64 exec, -1

  ds_read_b64_tr_b16 v[176:177], v21 offset:0
  ds_read_b64_tr_b16 v[178:179], v21 offset:4608
  ds_read_b64_tr_b16 v[180:181], v21 offset:256
  ds_read_b64_tr_b16 v[182:183], v21 offset:4864
  ds_read_b64_tr_b16 v[184:185], v21 offset:512
  ds_read_b64_tr_b16 v[186:187], v21 offset:5120
  ds_read_b64_tr_b16 v[188:189], v21 offset:768
  ds_read_b64_tr_b16 v[190:191], v21 offset:5376
  ds_read_b64_tr_b16 v[192:193], v21 offset:1024
  ds_read_b64_tr_b16 v[194:195], v21 offset:5632
  v_and_b32 v19, 7, v2
  v_lshl_add_u32 v18, v19, 4, v18
  s_lshl_b32 s40, s2, 7
  s_add_u32 s40, s40, 10485760
  v_add_u32 v18, s40, v18
  v_add_u32 v19, 1179648, v18
  v_add_u32 v20, 2359296, v18
  s_waitcnt lgkmcnt(10)
  s_barrier
  ds_read_b32 v64, v9
  ds_read_b32 v65, v9 offset:2048
  ds_read_b32 v66, v9 offset:4096
  ds_read_b32 v67, v9 offset:6144

  s_mov_b32 s52, 0x05030201
  s_mov_b32 s53, 0x06050302
  s_mov_b32 s54, 0x07060503
  v_mov_b32 v71, s38
  v_mov_b32 v75, s38
  v_mov_b32 v79, s38
  s_waitcnt lgkmcnt(2)
  v_add_f32 v64, v64, v65
  s_waitcnt lgkmcnt(0)
  v_add_f32 v66, v66, v67
  v_add_f32 v64, v64, v66
  v_cvt_pk_bf16_f32 v64, v64, v64
  v_lshlrev_b32 v64, 16, v64
  v_mul_f32 v65, 0xbfb8aa3b, v64
  v_exp_f32 v65, v65
  s_nop 0
  v_add_f32 v65, 1.0, v65
  v_rcp_f32 v65, v65
  s_nop 0
  v_mul_f32 v65, v64, v65
  v_cvt_pk_bf16_f32 v65, v65, v65
  v_lshlrev_b32 v65, 16, v65
  s_nop 0
  v_mul_f32 v65, v64, v65 quad_perm:[1,1,3,3] row_mask:0xf bank_mask:0xf
  v_cvt_pk_bf16_f32 v65, v65, v65
  s_mov_b32 exec_lo, 0x55555555
  s_mov_b32 exec_hi, 0x55555555
  ds_write_b16 v16, v65 offset:38400
  s_mov_b64 exec, -1
  s_waitcnt lgkmcnt(0)
  s_barrier
  ds_read_b128 v[64:67], v17 offset:38400
  s_waitcnt lgkmcnt(0)

  v_mfma_f32_16x16x32_bf16 v[80:83], v[64:67], v[176:179], 0
  v_mfma_f32_16x16x32_bf16 v[84:87], v[64:67], v[180:183], 0
  v_mfma_f32_16x16x32_bf16 v[88:91], v[64:67], v[184:187], 0
  v_mfma_f32_16x16x32_bf16 v[92:95], v[64:67], v[188:191], 0
  v_mfma_f32_16x16x32_bf16 v[96:99], v[64:67], v[192:195], 0
  s_mul_i32 s40, s2, 18432
  s_add_u32 s40, s40, 10485760
  v_lshl_add_u32 v4, v0, 4, s40
  v_add_u32 v5, 8192, v4
  v_add_u32 v6, 16384, v4
  s_nop 0

  v_permlane32_swap_b32 v80, v84
  v_permlane32_swap_b32 v81, v85
  v_permlane32_swap_b32 v82, v86
  v_permlane32_swap_b32 v83, v87
  v_perm_b32 v68, v81, v80, s52
  v_perm_b32 v69, v82, v81, s53
  v_perm_b32 v70, v83, v82, s54
  global_store_dwordx4 v18, v[68:71], s[36:37] sc1
  v_permlane32_swap_b32 v88, v92
  v_permlane32_swap_b32 v89, v93
  v_permlane32_swap_b32 v90, v94
  v_permlane32_swap_b32 v91, v95
  v_perm_b32 v72, v89, v88, s52
  v_perm_b32 v73, v90, v89, s53
  v_perm_b32 v74, v91, v90, s54
  global_store_dwordx4 v19, v[72:75], s[36:37] sc1
  s_cmp_ge_u32 s3, 4
  s_cbranch_scc1 T_NS3
  v_perm_b32 v76, v97, v96, s52
  v_perm_b32 v77, v98, v97, s53
  v_perm_b32 v78, v99, v98, s54
  s_mov_b32 exec_hi, 0
  global_store_dwordx4 v20, v[76:79], s[36:37] sc1
  s_mov_b64 exec, -1
T_NS3:

  s_cmp_lg_u32 s3, 7
  s_cbranch_scc1 T_NF
  s_lshr_b32 s40, s2, 2
  s_lshl_b32 s40, s40, 4
  s_and_b32 s41, s2, 1
  s_lshl_b32 s41, s41, 3
  s_add_u32 s40, s40, s41
  v_and_b32 v24, 7, v2
  v_add_u32 v24, s40, v24
  v_lshlrev_b32 v24, 1, v24
  v_bfe_u32 v25, v2, 3, 2
  s_and_b32 s41, s2, 2
  s_lshl_b32 s41, s41, 1
  v_add_u32 v25, s41, v25
  v_lshlrev_b32 v26, 2, v25
  v_mul_u32_u24 v25, 1168, v25
  v_add_u32 v25, v25, v24
  v_add_u32 v27, 158464, v24
  ds_read_b32 v28, v26 offset:384
  ds_read_u16 v29, v25 offset:19712
  ds_read_u16 v30, v25 offset:29056
  ds_read_u16 v31, v27
  s_waitcnt lgkmcnt(0)
  v_and_b32 v32, 0xffff, v28
  v_sub_u32 v32, 0xffff, v32
  v_min_u32 v32, 2047, v32
  v_mul_u32_u24 v32, 1152, v32
  v_add_u32 v32, v32, v24
  v_ashrrev_i32 v33, 31, v28
  v_not_b32 v33, v33
  v_or_b32 v33, 0x80000000, v33
  v_xor_b32 v33, v33, v28
  v_and_b32 v33, 0xffff0000, v33
  v_mul_f32 v33, 0xbfb8aa3b, v33
  v_exp_f32 v33, v33
  v_lshlrev_b32 v29, 16, v29
  v_add_f32 v33, 1.0, v33
  v_rcp_f32 v33, v33
  v_lshlrev_b32 v30, 16, v30
  v_cvt_pk_bf16_f32 v33, v33, v33
  v_lshlrev_b32 v33, 16, v33
  v_lshlrev_b32 v31, 16, v31
  s_cmp_lg_u32 s2, 0
  s_cbranch_scc1 T_NF
  v_mov_b32 v34, 13631488
  v_mov_b32 v35, s38
  s_mov_b64 exec, 1
  global_store_dword v34, v35, s[36:37]
  s_mov_b64 exec, -1
T_NF:
  s_mov_b32 s52, 0x0201000c
  s_mov_b32 s53, 0x0504030c
  s_mov_b32 s54, 0x0403020c
  s_mov_b32 s55, 0x0302010c
  v_mov_b32 v107, s38
  v_mov_b32 v104, 0
  v_mov_b32 v105, 0
  v_mov_b32 v106, 0
  v_bfe_u32 v7, v2, 4, 2
  v_lshlrev_b32 v7, 5, v7
  v_and_b32 v8, 7, v2
  v_lshl_add_u32 v7, v8, 2, v7
  s_lshl_b32 s40, s3, 7
  v_add_u32 v7, s40, v7
  s_mov_b32 s41, 65536
  s_waitcnt vmcnt(0)
T_GP:
  s_sleep 1
  global_load_dwordx4 v[96:99], v4, s[36:37] sc1
  global_load_dwordx4 v[100:103], v5, s[36:37] sc1
  s_cmp_ge_u32 s3, 2
  s_cbranch_scc1 T_G3
  global_load_dwordx4 v[104:107], v6, s[36:37] sc1
T_G3:
  s_waitcnt vmcnt(0)
  s_mov_b64 exec, -1
  v_xor_b32 v64, s38, v99
  v_xor_b32 v65, s38, v103
  v_xor_b32 v66, s38, v107
  v_or3_b32 v64, v64, v65, v66
  v_cmp_ne_u32 vcc, 0, v64
  s_cbranch_vccz T_GD
  s_mov_b64 exec, vcc
  s_sub_u32 s41, s41, 1
  s_cbranch_scc0 T_GP
  s_mov_b64 exec, -1
T_GD:

  v_perm_b32 v64, v96, v96, s52
  v_perm_b32 v65, v97, v96, s53
  v_perm_b32 v66, v98, v97, s54
  v_perm_b32 v67, v98, v98, s55
  v_perm_b32 v68, v100, v100, s52
  v_perm_b32 v69, v101, v100, s53
  v_perm_b32 v70, v102, v101, s54
  v_perm_b32 v71, v102, v102, s55
  v_perm_b32 v72, v104, v104, s52
  v_perm_b32 v73, v105, v104, s53
  v_perm_b32 v74, v106, v105, s54
  v_perm_b32 v75, v106, v106, s55
  v_add_f32 v64, v64, v68
  v_add_f32 v65, v65, v69
  v_add_f32 v66, v66, v70
  v_add_f32 v67, v67, v71
  v_add_f32 v64, v64, v72
  v_add_f32 v65, v65, v73
  v_add_f32 v66, v66, v74
  v_add_f32 v67, v67, v75
  s_nop 1
  v_permlane32_swap_b32 v64, v66
  v_permlane32_swap_b32 v65, v67
  v_add_f32 v64, v64, v66
  v_add_f32 v65, v65, v67
  s_nop 1
  v_permlane16_swap_b32 v64, v65
  v_add_f32 v64, v64, v65
  s_nop 1
  v_add_f32 v64, v64, v64 row_shl:8 row_mask:0xf bank_mask:0x3
  s_mov_b32 exec_lo, 0x00ff00ff
  s_mov_b32 exec_hi, 0x00ff00ff
  ds_write_b32 v7, v64 offset:39040
  s_mov_b64 exec, -1
  v_lshlrev_b32 v8, 2, v2
  s_waitcnt lgkmcnt(0)
  s_barrier
  s_cmp_lg_u32 s3, 7
  s_cbranch_scc1 T_END

  ds_read_b32 v64, v8 offset:39040
  ds_read_b32 v65, v8 offset:39168
  ds_read_b32 v66, v8 offset:39296
  ds_read_b32 v67, v8 offset:39424
  ds_read_b32 v68, v8 offset:39552
  ds_read_b32 v69, v8 offset:39680
  ds_read_b32 v70, v8 offset:39808
  ds_read_b32 v71, v8 offset:39936
  s_waitcnt lgkmcnt(4)
  v_add_f32 v64, v64, v65
  v_add_f32 v66, v66, v67
  s_waitcnt lgkmcnt(0)
  v_add_f32 v68, v68, v69
  v_add_f32 v70, v70, v71
  v_add_f32 v64, v64, v66
  v_add_f32 v68, v68, v70
  v_add_f32 v64, v64, v68
  v_cvt_pk_bf16_f32 v64, v64, v64
  v_lshlrev_b32 v64, 16, v64
  v_mul_f32 v64, v64, v33
  v_cvt_pk_bf16_f32 v64, v64, v64
  v_lshlrev_b32 v64, 16, v64
  v_add_f32 v64, v64, v29
  v_cvt_pk_bf16_f32 v64, v64, v64
  v_lshlrev_b32 v64, 16, v64
  v_mul_f32 v64, v64, v31
  v_cvt_pk_bf16_f32 v64, v64, v64
  v_lshlrev_b32 v64, 16, v64
  v_add_f32 v64, v64, v30
  v_cvt_pk_bf16_f32 v64, v64, v64
  s_mov_b32 exec_hi, 0
  global_store_short v32, v64, s[32:33]

T_END:
M_END:
  s_endpgm
CODE_END:
.section .rodata,"a"
.p2align 6
.amdhsa_kernel ka_kernel
  .amdhsa_next_free_vgpr 256
  .amdhsa_next_free_sgpr 100
  .amdhsa_accum_offset 256
  .amdhsa_group_segment_fixed_size 0
  .amdhsa_kernarg_size 136
  .amdhsa_user_sgpr_count 2
  .amdhsa_user_sgpr_kernarg_segment_ptr 1
  .amdhsa_system_sgpr_workgroup_id_x 1
  .amdhsa_float_denorm_mode_32 3
  .amdhsa_float_denorm_mode_16_64 3
.end_amdhsa_kernel
```

```asm
; @launch kernel=ka_kernel grid=(256,1,1) block=(512,1,1) lds=160768
.amdgcn_target "amdgcn-amd-amdhsa--gfx950"
.text
.globl ka_kernel
.p2align 8
.type ka_kernel,@function
ka_kernel:
  s_cmp_ge_u32 s2, 256
  s_cbranch_scc1 M_END
  s_load_dwordx16 s[4:19], s[0:1], 0
  s_load_dwordx16 s[20:35], s[0:1], 64
  s_load_dwordx2 s[36:37], s[0:1], 128
  v_lshrrev_b32 v1, 6, v0
  v_and_b32 v2, 63, v0

  v_readfirstlane_b32 s3, v1
  s_cmp_lg_u32 s3, 3
  s_cbranch_scc1 M_NCP
  s_getpc_b64 s[74:75]
M_PC:
  s_sub_u32 s74, s74, M_PC - ka_kernel
  s_subb_u32 s75, s75, 0
  s_lshr_b32 s76, s2, 3
  s_mul_i32 s76, s76, 10
  v_min_u32 v25, 9, v2
  v_add_u32 v25, s76, v25
  v_lshlrev_b32 v25, 7, v25
  v_min_u32 v25, CODE_END - ka_kernel - 4, v25
  global_load_dword v250, v25, s[74:75]
M_NCP:

  s_lshl_b32 s40, s2, 3
  s_add_u32 s40, s40, s3
  s_mul_i32 s40, s40, 1152
  v_lshl_add_u32 v3, v2, 4, s40
  v_lshl_add_u32 v4, v2, 1, s40
  v_mov_b32 v20, 0
  v_mov_b32 v21, 0
  v_mov_b32 v22, 0
  v_mov_b32 v23, 0
  v_mov_b32 v248, 0
  v_mov_b32 v249, 1
  v_pk_mov_b32 v[34:35], v[20:21], v[20:21]
  v_pk_mov_b32 v[252:253], v[20:21], v[20:21]
  v_pk_mov_b32 v[240:241], v[20:21], v[20:21]
  v_pk_mov_b32 v[242:243], v[20:21], v[20:21]
  v_pk_mov_b32 v[30:31], v[20:21], v[20:21]
  v_pk_mov_b32 v[210:211], v[20:21], v[20:21]
  v_lshlrev_b32 v24, 4, v2
  s_cmp_eq_u32 s3, 0
  s_cbranch_scc0 M_Z1
  s_mov_b64 exec, 0x3fffffff
  ds_write_b128 v24, v[20:23] offset:55168
  ds_write_b128 v24, v[20:23] offset:59776
  ds_write_b128 v24, v[20:23] offset:64384
M_Z1:
  s_cmp_eq_u32 s3, 3
  s_cbranch_scc0 M_Z0
  s_mov_b64 exec, 0xfffff
  ds_write_b128 v24, v[20:23] offset:192
M_Z0:
  s_mov_b64 exec, -1
  s_lshr_b32 s41, s3, 1
  s_lshl_b32 s42, s2, 1
  s_add_u32 s42, s42, s41
  s_lshr_b32 s45, s2, 2
  s_add_u32 s45, s45, 512
  s_cmp_eq_u32 s41, 2
  s_cselect_b32 s42, s45, s42
  s_and_b32 s43, s3, 1
  s_mul_i32 s44, s2, 2428
  s_lshr_b32 s44, s44, 16
  s_mul_i32 s40, s44, 27
  s_sub_u32 s49, s2, s40
  v_lshrrev_b32 v25, 2, v2
  s_lshl_b32 s40, s44, 6
  v_add_u32 v25, s40, v25
  v_mul_u32_u24 v25, 6912, v25
  v_and_b32 v26, 3, v2
  v_lshl_add_u32 v25, v26, 4, v25
  v_add_u32 v39, s40, v2
  s_lshl_b32 s40, s49, 7
  s_lshl_b32 s50, s43, 6
  s_add_u32 s40, s40, s50
  v_add_u32 v216, s40, v25
  v_lshlrev_b32 v39, 1, v39
  s_lshl_b32 s40, s42, 8
  v_lshl_add_u32 v5, v2, 2, s40
  s_lshl_b32 s40, s42, 1
  v_mov_b32 v6, s40
  s_waitcnt lgkmcnt(0)
  global_load_dwordx4 v[10:13], v3, s[4:5] nt
  global_load_ushort v14, v4, s[4:5] offset:1024 nt
  s_mov_b32 s50, 110592
  v_add_u32 v217, s50, v216
  v_add_u32 v218, s50, v217
  v_add_u32 v219, s50, v218
  v_mov_b32 v7, 19922944

  s_setprio 2
  s_cmp_ge_u32 s3, 6
  s_cbranch_scc1 M_T0MOD
  s_barrier
  global_load_ushort v44, v6, s[14:15]
  global_load_dword v40, v5, s[6:7]
  global_load_dword v41, v5, s[8:9]
  global_load_dword v42, v5, s[10:11]
  global_load_dword v43, v5, s[12:13]
  s_mov_b32 s62, 5

  s_branch M_T0J
M_T0MOD:
  s_setprio 2
  s_barrier

  global_load_dword v47, v7, s[36:37]
  s_mov_b32 s62, 2
  s_cmp_ge_u32 s2, 243
  s_cbranch_scc1 M_T0J
  global_load_ushort v44, v39, s[28:29]

  global_load_dwordx4 v[48:51], v216, s[30:31] nt
  global_load_dwordx4 v[52:55], v217, s[30:31] nt
  global_load_dwordx4 v[56:59], v218, s[30:31] nt
  global_load_dwordx4 v[60:63], v219, s[30:31] nt
  s_mov_b32 s62, 7
M_T0J:

  s_cmp_ge_u32 s3, 6
  s_cbranch_scc1 M_SU6
  v_and_b32 v20, 15, v2
  v_lshrrev_b32 v21, 4, v2
  s_mul_i32 s50, s3, 4352
  s_add_u32 s51, s50, 21120
  s_add_u32 s50, s50, 1536
  s_cmp_ge_u32 s3, 4
  s_cselect_b32 s50, s51, s50
  s_mov_b32 m0, s50
  v_mul_u32_u24 v210, 272, v20
  v_lshl_add_u32 v210, v21, 4, v210
  v_add_u32 v210, s50, v210
  s_mov_b32 s88, -1
  s_mov_b32 s89, 0
  s_mul_i32 s61, s3, 2816
  s_add_u32 s61, s61, 69120
  v_lshrrev_b32 v22, 1, v21
  v_lshlrev_b32 v211, 9, v22
  v_and_b32 v23, 1, v21
  v_lshl_add_u32 v211, v23, 4, v211
  v_lshl_add_u32 v211, v20, 5, v211
  v_add_u32 v211, s61, v211
  v_sub_u32 v23, 4, v22
  v_lshlrev_b32 v23, v23, v20
  v_lshl_add_u32 v23, v21, 8, v23
  v_add_u32 v23, s61, v23
  v_add_u32 v212, 1024, v23
  v_mul_u32_u24 v22, 120, v22
  v_add3_u32 v215, v212, v22, 8
  v_lshlrev_b32 v213, 8, v21
  v_lshl_add_u32 v213, v20, 2, v213
  v_add_u32 v213, s61, v213
  s_mul_i32 s60, s41, 5632
  s_add_u32 s60, s60, 69120
  v_mov_b32 v205, s60
  v_add_u32 v206, -4, v205
  v_add_u32 v207, -8, v205
  v_sub_u32 v22, 63, v2
  s_lshl_b32 s51, s43, 8
  s_sub_u32 s51, s60, s51
  s_add_u32 s51, s51, 2304
  v_lshl_add_u32 v200, v22, 2, s51
  v_add_u32 v201, 4, v200
  s_add_u32 s51, s60, 1536
  v_lshl_add_u32 v202, v22, 3, s51
  v_add_u32 v203, 4, v202
  v_add_u32 v204, 8, v202
  v_lshlrev_b32 v23, 5, v22
  v_lshlrev_b32 v22, 4, v22
  v_add_u32 v22, 512, v22
  v_min_u32 v22, v22, v23
  v_add_u32 v22, s60, v22
  s_cmp_eq_u32 s43, 0
  s_cselect_b64 vcc, -1, 0
  s_mul_i32 s51, s41, 16640
  s_add_u32 s51, s51, 86016
  s_cmp_eq_u32 s41, 2
  s_cselect_b32 s51, 38528, s51
  v_cndmask_b32 v202, v202, v22, vcc
  v_lshlrev_b32 v22, 2, v21
  v_sub_u32 v22, v20, v22
  s_add_u32 s59, s60, 1520
  v_lshl_add_u32 v23, v22, 3, s59
  v_cndmask_b32 v200, v200, v23, vcc
  v_med3_i32 v23, v22, -1, 1
  v_lshlrev_b32 v23, 4, v23
  v_sub_u32 v23, 16, v23
  v_lshrrev_b64 v[24:25], v23, s[88:89]
  v_cndmask_b32 v203, v203, v24, vcc
  v_add_u32 v22, -2, v22
  v_med3_i32 v23, v22, -1, 1
  v_lshlrev_b32 v23, 4, v23
  v_sub_u32 v23, 16, v23
  v_lshrrev_b64 v[24:25], v23, s[88:89]
  v_cndmask_b32 v204, v204, v24, vcc
  v_lshrrev_b32 v22, 1, v2
  v_mul_u32_u24 v22, 4160, v22
  v_and_b32 v23, 1, v2
  v_lshl_add_u32 v22, v23, 4, v22
  v_add_u32 v214, s51, v22
  v_lshl_add_u32 v208, v2, 4, s51
  s_lshl_b32 s51, s41, 2
  v_mov_b32 v209, s51
  s_lshl_b32 s48, s43, 4
  s_sub_u32 s48, 16, s48
  s_mov_b32 s52, 0x3fb8aa3b
  s_mov_b32 s53, 0x32a57060
  s_mov_b32 s54, 0x3f317218
  s_mov_b32 s55, 0x3e22f983
  s_mov_b32 s56, 0x31dc9c88
  s_mov_b32 s58, 0x3fa00000

  s_cmp_lt_u32 s3, 4
  s_cbranch_scc1 M_SUD
  v_and_b32 v20, 15, v2
  v_lshrrev_b32 v21, 4, v2
  s_lshl_b32 s40, s3, 2
  v_and_b32 v22, 3, v20
  v_mul_u32_u24 v22, 4160, v22
  v_lshrrev_b32 v23, 2, v20
  v_lshlrev_b32 v23, 3, v23
  v_lshl_add_u32 v23, v21, 4, v23
  v_sub_u32 v22, v22, v23
  v_add_u32 v22, 86088, v22
  v_lshlrev_b32 v23, 5, v20
  v_lshlrev_b32 v19, 4, v21
  v_sub_u32 v19, v23, v19
  v_add_u32 v19, 55216, v19
  v_lshl_add_u32 v3, v21, 3, v23
  v_add_u32 v3, 55648, v3
  s_lshr_b32 s40, 0x10221100, s40
  s_and_b32 s40, s40, 15
  s_mul_i32 s50, s40, 16640
  s_cmp_eq_u32 s40, 2
  s_cselect_b32 s50, 4294919808, s50
  v_add_u32 v4, s50, v22
  v_add_u32 v5, 16640, v22
  s_mul_i32 s50, s40, 4608
  v_add_u32 v6, s50, v19
  v_add_u32 v7, 4608, v19
  s_mul_i32 s50, s40, 18432
  s_add_u32 s50, s50, 1536
  v_lshl_add_u32 v8, v2, 4, s50
  v_lshlrev_b32 v9, 4, v2
  v_add_u32 v9, 19968, v9
  s_lshl_b32 s40, s40, 2
  v_mov_b32 v1, s40

  s_add_u32 s85, s3, 7
  s_cmp_ge_u32 s3, 6
  s_cselect_b32 s83, s85, s3
  s_add_u32 s84, s3, 3
  s_cmp_lt_u32 s3, 3
  s_cselect_b32 s84, s83, s84
  s_cselect_b32 s82, 0, 1.0
  s_add_u32 s86, s3, -4
  s_cmp_lt_u32 s86, 2
  s_cselect_b32 s85, s85, s83
  s_cselect_b32 s87, 1.0, 0
  s_lshl_b32 s83, s83, 10
  s_lshl_b32 s84, s84, 10
  s_lshl_b32 s85, s85, 10
  v_lshlrev_b32 v26, 4, v2
  v_add_u32 v26, 1536, v26
  v_add_u32 v24, s83, v26
  v_add_u32 v25, s84, v26
  v_add_u32 v26, s85, v26
  s_lshl_b32 s40, s3, 9
  v_add_u32 v27, s40, v3
  s_mul_i32 s40, s3, 1536
  s_add_u32 s40, s40, 69120
  v_and_b32 v28, 15, v2
  v_mul_u32_u24 v28, 96, v28
  v_lshrrev_b32 v29, 5, v2
  v_mul_u32_u24 v29, 48, v29
  v_and_b32 v30, 16, v2
  v_add3_u32 v28, v28, v29, v30
  v_add_u32 v28, s40, v28
  v_lshrrev_b32 v30, 2, v2
  v_mul_u32_u24 v29, 96, v30
  v_and_b32 v31, 3, v2
  v_mul_u32_u24 v16, 12, v31
  v_add3_u32 v29, v29, v16, s40
  v_lshlrev_b32 v30, 15, v30
  v_lshl_add_u32 v30, v31, 4, v30
  s_lshl_b32 s40, s3, 19
  s_lshl_b32 s86, s2, 6
  s_add_u32 s40, s40, s86
  s_add_u32 s40, s40, 6291456
  v_add_u32 v30, s40, v30

  s_branch M_SUP
M_SU6:
  v_lshrrev_b32 v21, 4, v2
  s_lshl_b32 s50, s2, 1
  v_add_u32 v20, s50, v21
  v_mov_b32 v22, s45
  v_cmp_gt_u32 vcc, 2, v21
  v_and_b32 v23, 15, v2
  v_min_u32 v23, 8, v23
  v_cndmask_b32 v20, v22, v20, vcc
  v_lshlrev_b32 v23, 9, v23
  v_lshlrev_b32 v243, 1, v20
  v_lshrrev_b32 v22, 6, v20
  v_mul_u32_u24 v22, 4608, v22
  v_and_b32 v20, 63, v20
  v_lshl_add_u32 v20, v20, 3, v22
  v_add_u32 v20, v20, v23
  v_add_u32 v240, 524288, v20
  v_add_u32 v241, 565760, v20
  v_add_u32 v242, 607232, v20
  s_mul_i32 s40, s49, 9
  s_add_u32 s40, s40, s44
  s_lshl_b32 s40, s40, 9
  s_lshl_b32 s50, s43, 8
  s_add_u32 s40, s40, s50
  s_add_u32 s40, s40, 524288
  v_and_b32 v34, 3, v2
  v_lshlrev_b32 v34, 6, v34
  v_lshrrev_b32 v35, 3, v2
  v_lshl_add_u32 v34, v35, 3, v34
  v_add_u32 v34, s40, v34
  v_add_u32 v35, 124416, v34

M_SUP:
  v_lshrrev_b32 v22, 2, v2
  s_and_b32 s40, s3, 3

  s_lshl_b32 s40, s40, 6
  v_add_u32 v22, s40, v22
  v_and_b32 v23, 3, v2
  v_mul_u32_u24 v222, 2592, v23
  v_lshl_add_u32 v222, v22, 2, v222
  v_add_u32 v222, 27136, v222
  v_lshrrev_b32 v223, 2, v22
  v_lshlrev_b32 v223, 4, v223
  v_lshl_add_u32 v223, v23, 2, v223
  v_add_u32 v223, 37504, v223
  v_lshlrev_b32 v22, 14, v22
  v_lshl_add_u32 v22, v23, 4, v22
  s_lshl_b32 s40, s2, 6
  s_add_u32 s40, s40, 1048576
  v_add_u32 v253, s40, v22

M_SUD:
  s_lshr_b32 s40, s3, 1
  s_mul_i32 s40, s40, 2592
  s_mul_i32 s50, s43, 1280
  s_add_u32 s40, s40, s50
  s_add_u32 s40, s40, 27136
  v_lshl_add_u32 v220, v2, 4, s40
  s_lshl_b32 s40, s3, 1
  s_add_u32 s40, s40, 37504
  v_lshl_add_u32 v221, v2, 4, s40
  v_mov_b32 v15, 0x3ae38e39
  v_mov_b32 v92, 0x3f803f80
  v_mov_b32 v94, 0x3f80
  v_mov_b32 v95, 0x3f800000

  s_cmp_eq_u32 s62, 7
  s_cbranch_scc1 M_W6
  s_cmp_eq_u32 s62, 5
  s_cbranch_scc1 M_W5
  s_waitcnt vmcnt(1)
M_W5:
  s_waitcnt vmcnt(5)
M_W6:
  s_waitcnt vmcnt(6)

  v_dot2_f32_bf16 v96, v10, v92, 0
  v_dot2_f32_bf16 v98, v10, v10, 0
  v_dot2_f32_bf16 v96, v11, v92, v96
  v_dot2_f32_bf16 v98, v11, v11, v98
  v_dot2_f32_bf16 v96, v12, v92, v96
  v_dot2_f32_bf16 v98, v12, v12, v98
  v_dot2_f32_bf16 v96, v13, v92, v96
  v_dot2_f32_bf16 v98, v13, v13, v98
  v_dot2_f32_bf16 v96, v14, v92, v96
  v_dot2_f32_bf16 v98, v14, v14, v98
  s_nop 1
  v_add_f32 v96, v96, v96 row_shr:1 row_mask:0xf bank_mask:0xf bound_ctrl:0
  v_add_f32 v98, v98, v98 row_shr:1 row_mask:0xf bank_mask:0xf bound_ctrl:0
  s_nop 0
  v_add_f32 v96, v96, v96 row_shr:2 row_mask:0xf bank_mask:0xf bound_ctrl:0
  v_add_f32 v98, v98, v98 row_shr:2 row_mask:0xf bank_mask:0xf bound_ctrl:0
  s_nop 0
  v_add_f32 v96, v96, v96 row_shr:4 row_mask:0xf bank_mask:0xf bound_ctrl:0
  v_add_f32 v98, v98, v98 row_shr:4 row_mask:0xf bank_mask:0xf bound_ctrl:0
  s_nop 0
  v_add_f32 v96, v96, v96 row_shr:8 row_mask:0xf bank_mask:0xf bound_ctrl:0
  v_add_f32 v98, v98, v98 row_shr:8 row_mask:0xf bank_mask:0xf bound_ctrl:0
  s_nop 0
  v_add_f32 v96, v96, v96 row_bcast:15 row_mask:0xa bank_mask:0xf
  v_add_f32 v98, v98, v98 row_bcast:15 row_mask:0xa bank_mask:0xf
  s_nop 0
  v_add_f32 v96, v96, v96 row_bcast:31 row_mask:0xc bank_mask:0xf
  v_add_f32 v98, v98, v98 row_bcast:31 row_mask:0xc bank_mask:0xf
  s_nop 0
  v_readlane_b32 s66, v96, 63
  v_readlane_b32 s67, v98, 63
  s_nop 0
  v_mul_f32 v96, s66, v15
  v_mul_f32 v97, s67, v15
  v_mul_f32 v98, v96, v96
  v_fma_f32 v97, -v96, v96, v97
  v_mul_f32 v99, 0x41800000, v97
  v_cmp_gt_f32 vcc, v98, v99
  s_cbranch_vccz M_FAST
  v_sub_f32 v99, 0, v96

  v_dot2_f32_bf16 v88, v14, v94, v99
  v_dot2_f32_bf16 v80, v10, v94, v99
  v_dot2_f32_bf16 v81, v10, v95, v99
  v_dot2_f32_bf16 v82, v11, v94, v99
  v_dot2_f32_bf16 v83, v11, v95, v99
  v_dot2_f32_bf16 v84, v12, v94, v99
  v_dot2_f32_bf16 v85, v12, v95, v99
  v_dot2_f32_bf16 v86, v13, v94, v99
  v_dot2_f32_bf16 v87, v13, v95, v99
  v_mul_f32 v98, v88, v88
  v_fmac_f32 v98, v80, v80
  v_fmac_f32 v98, v81, v81
  v_fmac_f32 v98, v82, v82
  v_fmac_f32 v98, v83, v83
  v_fmac_f32 v98, v84, v84
  v_fmac_f32 v98, v85, v85
  v_fmac_f32 v98, v86, v86
  v_fmac_f32 v98, v87, v87
  s_nop 1
  v_add_f32 v98, v98, v98 row_shr:1 row_mask:0xf bank_mask:0xf bound_ctrl:0
  s_nop 1
  v_add_f32 v98, v98, v98 row_shr:2 row_mask:0xf bank_mask:0xf bound_ctrl:0
  s_nop 1
  v_add_f32 v98, v98, v98 row_shr:4 row_mask:0xf bank_mask:0xf bound_ctrl:0
  s_nop 1
  v_add_f32 v98, v98, v98 row_shr:8 row_mask:0xf bank_mask:0xf bound_ctrl:0
  s_nop 1
  v_add_f32 v98, v98, v98 row_bcast:15 row_mask:0xa bank_mask:0xf
  s_nop 1
  v_add_f32 v98, v98, v98 row_bcast:31 row_mask:0xc bank_mask:0xf
  s_nop 1
  v_readlane_b32 s67, v98, 63
  s_nop 1
  v_mul_f32 v97, s67, v15
M_FAST:
  v_cvt_pk_bf16_f32 v97, -v96, v97
  v_lshlrev_b32 v96, 16, v97
  v_and_b32 v97, 0xffff0000, v97
  v_add_f32 v97, 0x3727c5ac, v97
  v_cvt_pk_bf16_f32 v97, v97, v97
  v_lshlrev_b32 v97, 16, v97
  v_sqrt_f32 v97, v97

  v_dot2_f32_bf16 v88, v14, v94, v96
  v_dot2_f32_bf16 v80, v10, v94, v96
  v_dot2_f32_bf16 v81, v10, v95, v96
  v_dot2_f32_bf16 v82, v11, v94, v96
  v_dot2_f32_bf16 v83, v11, v95, v96
  v_dot2_f32_bf16 v84, v12, v94, v96
  v_dot2_f32_bf16 v85, v12, v95, v96
  v_dot2_f32_bf16 v86, v13, v94, v96
  v_dot2_f32_bf16 v87, v13, v95, v96
  v_cvt_pk_bf16_f32 v97, v97, v97
  v_lshlrev_b32 v97, 16, v97
  v_rcp_f32 v97, v97

  v_cvt_pk_bf16_f32 v88, v88, v88
  v_lshlrev_b32 v88, 16, v88
  v_cvt_pk_bf16_f32 v81, v80, v81
  v_cvt_pk_bf16_f32 v83, v82, v83
  v_cvt_pk_bf16_f32 v85, v84, v85
  v_cvt_pk_bf16_f32 v87, v86, v87
  v_lshlrev_b32 v80, 16, v81
  v_and_b32 v81, 0xffff0000, v81
  v_lshlrev_b32 v82, 16, v83
  v_and_b32 v83, 0xffff0000, v83
  v_lshlrev_b32 v84, 16, v85
  v_and_b32 v85, 0xffff0000, v85
  v_lshlrev_b32 v86, 16, v87
  v_and_b32 v87, 0xffff0000, v87
  v_mul_f32 v88, v88, v97
  v_pk_mul_f32 v[80:81], v[80:81], v[96:97] op_sel:[0,1] op_sel_hi:[1,1]
  v_pk_mul_f32 v[82:83], v[82:83], v[96:97] op_sel:[0,1] op_sel_hi:[1,1]
  v_pk_mul_f32 v[84:85], v[84:85], v[96:97] op_sel:[0,1] op_sel_hi:[1,1]
  v_pk_mul_f32 v[86:87], v[86:87], v[96:97] op_sel:[0,1] op_sel_hi:[1,1]
  v_cvt_pk_bf16_f32 v96, v80, v81
  v_cvt_pk_bf16_f32 v97, v82, v83
  v_cvt_pk_bf16_f32 v98, v84, v85
  v_cvt_pk_bf16_f32 v99, v86, v87
  v_cvt_pk_bf16_f32 v100, v88, 0
  ds_write_b128 v220, v[96:99]
  ds_write_b16 v221, v100
  s_cmp_lt_u32 s3, 6
  s_cbranch_scc1 M_NTAG
  s_cmp_eq_u32 s62, 7
  s_cbranch_scc1 M_TG5
  s_waitcnt vmcnt(0)
M_TG5:
  s_waitcnt vmcnt(5)
  s_mov_b32 s40, 0x9E3779B1
  v_mul_lo_u32 v33, v47, s40
  v_add_u32 v33, 0x7F4A7C15, v33
  ds_write_b32 v248, v33 offset:196
M_NTAG:

  s_mov_b64 exec, 1
  ds_add_u32 v248, v249 offset:192
  s_mov_b64 exec, -1
  s_cmp_lt_u32 s3, 4
  s_cbranch_scc1 M_KG
  s_cmp_lt_u32 s3, 6
  s_cbranch_scc1 M_PACK
  s_cmp_ge_u32 s2, 243
  s_cbranch_scc1 M_PACK
  s_mov_b32 s40, 0xbfb8aa3b
  s_waitcnt vmcnt(4)
  v_lshlrev_b32 v44, 16, v44
  v_mul_f32 v45, s40, v44
  v_exp_f32 v45, v45
  v_lshrrev_b32 v46, 2, v2
  v_add_f32 v45, 1.0, v45
  v_rcp_f32 v45, v45
  v_lshlrev_b32 v46, 2, v46
  v_mul_f32 v44, v44, v45
  v_cvt_pk_bf16_f32 v44, v44, 0

  ds_bpermute_b32 v108, v46, v44 offset:0
  ds_bpermute_b32 v109, v46, v44 offset:64
  ds_bpermute_b32 v110, v46, v44 offset:128
  ds_bpermute_b32 v111, v46, v44 offset:192
  s_waitcnt lgkmcnt(0)

  v_lshlrev_b32 v104, 16, v108
  v_lshlrev_b32 v105, 16, v109
  v_lshlrev_b32 v106, 16, v110
  v_lshlrev_b32 v107, 16, v111
  v_mov_b32 v112, 0
  v_mov_b32 v113, 0
  v_mov_b32 v114, 0
  v_mov_b32 v115, 0
  v_mov_b32 v116, 0
  v_mov_b32 v117, 0
  v_mov_b32 v118, 0
  v_mov_b32 v119, 0
  s_waitcnt vmcnt(3)
  v_dot2c_f32_bf16 v112, v48, v108
  v_dot2c_f32_bf16 v113, v48, v104
  v_dot2c_f32_bf16 v114, v49, v108
  v_dot2c_f32_bf16 v115, v49, v104
  v_dot2c_f32_bf16 v116, v50, v108
  v_dot2c_f32_bf16 v117, v50, v104
  v_dot2c_f32_bf16 v118, v51, v108
  v_dot2c_f32_bf16 v119, v51, v104
  s_waitcnt vmcnt(2)
  v_dot2c_f32_bf16 v112, v52, v109
  v_dot2c_f32_bf16 v113, v52, v105
  v_dot2c_f32_bf16 v114, v53, v109
  v_dot2c_f32_bf16 v115, v53, v105
  v_dot2c_f32_bf16 v116, v54, v109
  v_dot2c_f32_bf16 v117, v54, v105
  v_dot2c_f32_bf16 v118, v55, v109
  v_dot2c_f32_bf16 v119, v55, v105
  s_waitcnt vmcnt(1)
  v_dot2c_f32_bf16 v112, v56, v110
  v_dot2c_f32_bf16 v113, v56, v106
  v_dot2c_f32_bf16 v114, v57, v110
  v_dot2c_f32_bf16 v115, v57, v106
  v_dot2c_f32_bf16 v116, v58, v110
  v_dot2c_f32_bf16 v117, v58, v106
  v_dot2c_f32_bf16 v118, v59, v110
  v_dot2c_f32_bf16 v119, v59, v106
  s_waitcnt vmcnt(0)
  v_dot2c_f32_bf16 v112, v60, v111
  v_dot2c_f32_bf16 v113, v60, v107
  v_dot2c_f32_bf16 v114, v61, v111
  v_dot2c_f32_bf16 v115, v61, v107
  v_dot2c_f32_bf16 v116, v62, v111
  v_dot2c_f32_bf16 v117, v62, v107
  v_dot2c_f32_bf16 v118, v63, v111
  v_dot2c_f32_bf16 v119, v63, v107
  s_nop 2
  v_permlane32_swap_b32 v112, v116
  v_permlane32_swap_b32 v113, v117
  v_permlane32_swap_b32 v114, v118
  v_permlane32_swap_b32 v115, v119
  v_add_f32 v112, v112, v116
  v_add_f32 v113, v113, v117
  v_add_f32 v114, v114, v118
  v_add_f32 v115, v115, v119
  s_nop 0
  v_permlane16_swap_b32 v112, v114
  v_permlane16_swap_b32 v113, v115
  v_add_f32 v112, v112, v114
  v_add_f32 v113, v113, v115
  s_nop 1
  v_add_f32 v32, v112, v112 row_ror:8 row_mask:0xf bank_mask:0x3
  v_add_f32 v32, v113, v113 row_ror:8 row_mask:0xf bank_mask:0xc
  s_nop 1
  v_add_f32 v32, v32, v32 row_shl:4 row_mask:0xf bank_mask:0x5
  s_mov_b32 exec_lo, 0x0f0f0f0f
  s_mov_b32 exec_hi, 0x0f0f0f0f
  global_store_dwordx2 v34, v[32:33], s[36:37] sc1
  s_mov_b64 exec, -1
M_PACK:
  v_add_u32 v21, 64, v222
  v_add_u32 v22, 128, v222
  v_add_u32 v23, 192, v222
  s_mov_b32 s41, 262144
M_SPL:
  ds_read_b64 v[96:97], v248 offset:192

  ds_read2st64_b32 v[80:81], v222 offset0:0 offset1:5
  ds_read_b32 v82, v223 offset:0
  ds_read2st64_b32 v[84:85], v21 offset0:0 offset1:5
  ds_read_b32 v86, v223 offset:64
  ds_read2st64_b32 v[88:89], v22 offset0:0 offset1:5
  ds_read_b32 v90, v223 offset:128
  ds_read2st64_b32 v[92:93], v23 offset0:0 offset1:5
  ds_read_b32 v94, v223 offset:192
  s_waitcnt lgkmcnt(8)
  v_readfirstlane_b32 s94, v96
  v_readfirstlane_b32 s38, v97
  s_cmp_ge_u32 s94, 8
  s_cbranch_scc0 M_SPL

  v_mov_b32 v83, v97
  s_waitcnt lgkmcnt(6)
  global_store_dwordx4 v253, v[80:83], s[36:37] sc1
  v_add_u32 v253, s41, v253
  v_mov_b32 v87, v97
  s_waitcnt lgkmcnt(4)
  global_store_dwordx4 v253, v[84:87], s[36:37] sc1
  v_add_u32 v253, s41, v253
  v_mov_b32 v91, v97
  s_waitcnt lgkmcnt(2)
  global_store_dwordx4 v253, v[88:91], s[36:37] sc1
  v_add_u32 v253, s41, v253
  v_mov_b32 v95, v97
  s_waitcnt lgkmcnt(0)
  global_store_dwordx4 v253, v[92:95], s[36:37] sc1
  s_setprio 0
  s_cmp_ge_u32 s3, 6
  s_cbranch_scc1 M_MOD
  s_waitcnt vmcnt(4)

  s_mov_b64 exec, 1
  ds_add_u32 v248, v249 offset:240
  s_mov_b64 exec, -1
  s_branch KG_W1
M_KG:
  s_setprio 0
  s_waitcnt vmcnt(0)
KG_W1:
  s_cmp_lg_u32 s3, 5
  s_cbranch_scc1 M_NB5
  s_getpc_b64 s[74:75]
BXB5:
  s_add_u32 s74, s74, BOXT - BXB5
  s_addc_u32 s75, s75, 0
  v_lshlrev_b32 v192, 4, v2
  global_load_dwordx4 v[196:199], v192, s[74:75] offset:1024
  global_load_dwordx4 v[192:195], v192, s[74:75]

M_NB5:
  v_lshlrev_b32 v44, 16, v44
  v_lshlrev_b32 v40, s48, v40
  v_lshlrev_b32 v41, s48, v41
  v_mul_f32 v45, s52, v44
  v_fma_f32 v46, v44, s52, -v45
  v_fma_f32 v46, v44, s53, v46
  v_exp_f32 v45, v45
  v_mul_f32 v46, s54, v46
  v_fma_f32 v45, v45, v46, v45
  v_cvt_pk_bf16_f32 v45, v45, v45
  v_lshlrev_b32 v44, 16, v45
  v_and_b32 v40, 0xffff0000, v40
  v_and_b32 v41, 0xffff0000, v41
  v_mul_f32 v45, s52, v40
  v_fma_f32 v46, v40, s52, -v45
  v_fma_f32 v46, v40, s53, v46
  v_exp_f32 v45, v45
  v_mul_f32 v46, s54, v46
  v_fma_f32 v45, v45, v46, v45
  v_cvt_pk_bf16_f32 v45, v45, v45
  v_lshlrev_b32 v40, 16, v45
  v_mul_f32 v40, v40, v44
  v_mul_f32 v45, v41, v44
  v_mul_f32 v40, s52, v40
  v_sub_f32 v40, 0, v40
  v_mul_f32 v41, s55, v45
  v_fma_f32 v47, v45, s55, -v41
  v_fma_f32 v47, v45, s56, v47
  v_and_b32 v48, 0x7fff7fff, v42
  v_and_b32 v46, 0x7fff7fff, v43
  v_pk_max_u16 v48, v48, v46
  v_lshlrev_b32 v46, 16, v48
  v_max_u32 v48, v48, v46

  v_mov_b32 v56, 0x3c00
  ds_write_addtid_b32 v56 offset:0
  v_mul_f32 v64, 0x41000000, v40
  v_mul_f32 v65, 0x41000000, v41
  v_exp_f32 v64, v64
  v_fract_f32 v65, v65
  v_fmamk_f32 v65, v47, 0x41000000, v65
  v_cos_f32 v62, v65
  v_sin_f32 v63, v65
  s_nop 0
  v_pk_mul_f32 v[62:63], v[62:63], v[64:65] op_sel_hi:[1,0]
  v_cvt_pk_f16_f32 v57, v62, v63
  v_pk_mul_f32 v[64:65], v[62:63], v[62:63] op_sel_hi:[1,0]
  v_pk_fma_f32 v[64:65], v[62:63], v[62:63], v[64:65] op_sel:[1,1,0] op_sel_hi:[0,1,1] neg_lo:[1,0,0]
  v_cvt_pk_f16_f32 v58, v64, v65
  v_max_u32 v48, v48, v48 row_shr:1 row_mask:0xf bank_mask:0xf bound_ctrl:0
  v_pk_mul_f32 v[66:67], v[62:63], v[64:65] op_sel_hi:[1,0]
  v_pk_fma_f32 v[66:67], v[62:63], v[64:65], v[66:67] op_sel:[1,1,0] op_sel_hi:[0,1,1] neg_lo:[1,0,0]
  v_cvt_pk_f16_f32 v59, v66, v67
  ds_write_addtid_b32 v57 offset:272
  ds_write_addtid_b32 v58 offset:544
  v_max_u32 v48, v48, v48 row_shr:2 row_mask:0xf bank_mask:0xf bound_ctrl:0
  v_pk_mul_f32 v[68:69], v[64:65], v[64:65] op_sel_hi:[1,0]
  v_pk_fma_f32 v[68:69], v[64:65], v[64:65], v[68:69] op_sel:[1,1,0] op_sel_hi:[0,1,1] neg_lo:[1,0,0]
  v_cvt_pk_f16_f32 v60, v68, v69
  v_max_u32 v48, v48, v48 row_shr:4 row_mask:0xf bank_mask:0xf bound_ctrl:0
  v_pk_mul_f32 v[70:71], v[68:69], v[62:63] op_sel_hi:[1,0]
  v_pk_fma_f32 v[70:71], v[68:69], v[62:63], v[70:71] op_sel:[1,1,0] op_sel_hi:[0,1,1] neg_lo:[1,0,0]
  v_cvt_pk_f16_f32 v61, v70, v71
  ds_write_addtid_b32 v59 offset:816
  ds_write_addtid_b32 v60 offset:1088
  v_max_u32 v48, v48, v48 row_shr:8 row_mask:0xf bank_mask:0xf bound_ctrl:0
  v_pk_mul_f32 v[72:73], v[68:69], v[64:65] op_sel_hi:[1,0]
  v_pk_fma_f32 v[72:73], v[68:69], v[64:65], v[72:73] op_sel:[1,1,0] op_sel_hi:[0,1,1] neg_lo:[1,0,0]
  v_cvt_pk_f16_f32 v56, v72, v73
  v_max_u32 v48, v48, v48 row_bcast:15 row_mask:0xa bank_mask:0xf
  v_pk_mul_f32 v[74:75], v[68:69], v[66:67] op_sel_hi:[1,0]
  v_pk_fma_f32 v[74:75], v[68:69], v[66:67], v[74:75] op_sel:[1,1,0] op_sel_hi:[0,1,1] neg_lo:[1,0,0]
  v_cvt_pk_f16_f32 v57, v74, v75
  ds_write_addtid_b32 v61 offset:1360
  ds_write_addtid_b32 v56 offset:1632
  v_max_u32 v48, v48, v48 row_bcast:31 row_mask:0xc bank_mask:0xf
  v_pk_mul_f32 v[76:77], v[68:69], v[68:69] op_sel_hi:[1,0]
  v_pk_fma_f32 v[76:77], v[68:69], v[68:69], v[76:77] op_sel:[1,1,0] op_sel_hi:[0,1,1] neg_lo:[1,0,0]
  v_cvt_pk_f16_f32 v58, v76, v77
  v_readlane_b32 s57, v48, 63
  v_pk_mul_f32 v[78:79], v[76:77], v[62:63] op_sel_hi:[1,0]
  v_pk_fma_f32 v[78:79], v[76:77], v[62:63], v[78:79] op_sel:[1,1,0] op_sel_hi:[0,1,1] neg_lo:[1,0,0]
  v_cvt_pk_f16_f32 v59, v78, v79
  ds_write_addtid_b32 v57 offset:1904
  ds_write_addtid_b32 v58 offset:2176
  v_pk_mul_f32 v[78:79], v[76:77], v[64:65] op_sel_hi:[1,0]
  v_pk_fma_f32 v[78:79], v[76:77], v[64:65], v[78:79] op_sel:[1,1,0] op_sel_hi:[0,1,1] neg_lo:[1,0,0]
  v_cvt_pk_f16_f32 v60, v78, v79
  v_pk_mul_f32 v[78:79], v[76:77], v[66:67] op_sel_hi:[1,0]
  v_pk_fma_f32 v[78:79], v[76:77], v[66:67], v[78:79] op_sel:[1,1,0] op_sel_hi:[0,1,1] neg_lo:[1,0,0]
  v_cvt_pk_f16_f32 v61, v78, v79
  ds_write_addtid_b32 v59 offset:2448
  ds_write_addtid_b32 v60 offset:2720
  v_pk_mul_f32 v[78:79], v[76:77], v[68:69] op_sel_hi:[1,0]
  v_pk_fma_f32 v[78:79], v[76:77], v[68:69], v[78:79] op_sel:[1,1,0] op_sel_hi:[0,1,1] neg_lo:[1,0,0]
  v_cvt_pk_f16_f32 v56, v78, v79
  v_pk_mul_f32 v[78:79], v[76:77], v[70:71] op_sel_hi:[1,0]
  v_pk_fma_f32 v[78:79], v[76:77], v[70:71], v[78:79] op_sel:[1,1,0] op_sel_hi:[0,1,1] neg_lo:[1,0,0]
  v_cvt_pk_f16_f32 v57, v78, v79
  ds_write_addtid_b32 v61 offset:2992
  ds_write_addtid_b32 v56 offset:3264
  v_pk_mul_f32 v[78:79], v[76:77], v[72:73] op_sel_hi:[1,0]
  v_pk_fma_f32 v[78:79], v[76:77], v[72:73], v[78:79] op_sel:[1,1,0] op_sel_hi:[0,1,1] neg_lo:[1,0,0]
  v_cvt_pk_f16_f32 v58, v78, v79
  v_pk_mul_f32 v[78:79], v[76:77], v[74:75] op_sel_hi:[1,0]
  v_pk_fma_f32 v[78:79], v[76:77], v[74:75], v[78:79] op_sel:[1,1,0] op_sel_hi:[0,1,1] neg_lo:[1,0,0]
  v_cvt_pk_f16_f32 v59, v78, v79
  ds_write_addtid_b32 v57 offset:3536
  ds_write_addtid_b32 v58 offset:3808
  ds_write_addtid_b32 v59 offset:4080
  ds_read_b128 v[64:67], v210 offset:0
  ds_read_b128 v[68:71], v210 offset:64
  ds_read_b128 v[72:75], v210 offset:128
  ds_read_b128 v[76:79], v210 offset:192
  v_mul_f32 v80, 1.0, v40
  v_mul_f32 v81, 1.0, v41
  v_exp_f32 v80, v80
  v_fract_f32 v81, v81
  v_fmamk_f32 v81, v47, 0x3f800000, v81
  v_cos_f32 v62, v81
  v_sin_f32 v63, v81
  s_nop 0
  v_pk_mul_f32 v[62:63], v[62:63], v[80:81] op_sel_hi:[1,0]
  s_and_b32 s57, s57, 0xffff0000
  v_frexp_exp_i32_f32 v48, s57
  v_lshlrev_b32 v42, s48, v42
  v_lshlrev_b32 v43, s48, v43
  v_sub_u32 v48, 6, v48
  v_and_b32 v42, 0xffff0000, v42
  v_and_b32 v43, 0xffff0000, v43
  v_ldexp_f32 v45, s58, v48
  v_mul_f32 v44, 0x3f4ccccd, v44
  v_mul_f32 v42, v42, v45
  v_mul_f32 v43, v43, v45
  v_sub_u32 v48, 1, v48
  v_ldexp_f32 v44, v44, v48

  ds_write_b32 v209, v44 offset:80
  v_pk_mul_f32 v[80:81], v[62:63], v[62:63] op_sel_hi:[1,0]
  v_pk_fma_f32 v[80:81], v[62:63], v[62:63], v[80:81] op_sel:[1,1,0] op_sel_hi:[0,1,1] neg_lo:[1,0,0]
  v_pk_mul_f32 v[82:83], v[80:81], v[80:81] op_sel_hi:[1,0]
  v_pk_fma_f32 v[82:83], v[80:81], v[80:81], v[82:83] op_sel:[1,1,0] op_sel_hi:[0,1,1] neg_lo:[1,0,0]
  v_mul_f32 v86, 0x43000000, v40
  v_mul_f32 v87, 0x43000000, v41
  v_exp_f32 v86, v86
  v_fract_f32 v87, v87
  v_fmamk_f32 v87, v47, 0x43000000, v87
  v_cos_f32 v84, v87
  v_sin_f32 v85, v87
  s_nop 0
  v_pk_mul_f32 v[84:85], v[84:85], v[86:87] op_sel_hi:[1,0]
  v_cvt_pk_f16_f32 v60, v42, -v43
  v_pk_mul_f32 v[86:87], v[42:43], v[62:63] op_sel_hi:[1,0]
  v_pk_fma_f32 v[86:87], v[42:43], v[62:63], v[86:87] op_sel:[1,1,0] op_sel_hi:[0,1,1] neg_lo:[1,0,0]
  v_cvt_pk_f16_f32 v61, v86, -v87
  v_pk_mul_f32 v[116:117], v[42:43], v[80:81] op_sel_hi:[1,0]
  v_pk_fma_f32 v[116:117], v[42:43], v[80:81], v[116:117] op_sel:[1,1,0] op_sel_hi:[0,1,1] neg_lo:[1,0,0]
  v_cvt_pk_f16_f32 v56, v116, -v117
  ds_write_addtid_b32 v60 offset:0
  ds_write_addtid_b32 v61 offset:272
  v_pk_mul_f32 v[118:119], v[86:87], v[80:81] op_sel_hi:[1,0]
  v_pk_fma_f32 v[118:119], v[86:87], v[80:81], v[118:119] op_sel:[1,1,0] op_sel_hi:[0,1,1] neg_lo:[1,0,0]
  v_cvt_pk_f16_f32 v57, v118, -v119
  v_pk_mul_f32 v[120:121], v[42:43], v[82:83] op_sel_hi:[1,0]
  v_pk_fma_f32 v[120:121], v[42:43], v[82:83], v[120:121] op_sel:[1,1,0] op_sel_hi:[0,1,1] neg_lo:[1,0,0]
  v_cvt_pk_f16_f32 v58, v120, -v121
  ds_write_addtid_b32 v56 offset:544
  ds_write_addtid_b32 v57 offset:816
  v_pk_mul_f32 v[122:123], v[86:87], v[82:83] op_sel_hi:[1,0]
  v_pk_fma_f32 v[122:123], v[86:87], v[82:83], v[122:123] op_sel:[1,1,0] op_sel_hi:[0,1,1] neg_lo:[1,0,0]
  v_cvt_pk_f16_f32 v59, v122, -v123
  v_pk_mul_f32 v[124:125], v[116:117], v[82:83] op_sel_hi:[1,0]
  v_pk_fma_f32 v[124:125], v[116:117], v[82:83], v[124:125] op_sel:[1,1,0] op_sel_hi:[0,1,1] neg_lo:[1,0,0]
  v_cvt_pk_f16_f32 v60, v124, -v125
  ds_write_addtid_b32 v58 offset:1088
  ds_write_addtid_b32 v59 offset:1360
  v_pk_mul_f32 v[126:127], v[118:119], v[82:83] op_sel_hi:[1,0]
  v_pk_fma_f32 v[126:127], v[118:119], v[82:83], v[126:127] op_sel:[1,1,0] op_sel_hi:[0,1,1] neg_lo:[1,0,0]
  v_cvt_pk_f16_f32 v61, v126, -v127
  v_pk_mul_f32 v[62:63], v[42:43], v[84:85] op_sel_hi:[1,0]
  v_pk_fma_f32 v[62:63], v[42:43], v[84:85], v[62:63] op_sel:[1,1,0] op_sel_hi:[0,1,1] neg_lo:[1,0,0]
  v_cvt_pk_f16_f32 v56, v62, -v63
  ds_write_addtid_b32 v60 offset:1632
  ds_write_addtid_b32 v61 offset:1904
  v_pk_mul_f32 v[80:81], v[86:87], v[84:85] op_sel_hi:[1,0]
  v_pk_fma_f32 v[80:81], v[86:87], v[84:85], v[80:81] op_sel:[1,1,0] op_sel_hi:[0,1,1] neg_lo:[1,0,0]
  v_cvt_pk_f16_f32 v57, v80, -v81
  v_pk_mul_f32 v[80:81], v[116:117], v[84:85] op_sel_hi:[1,0]
  v_pk_fma_f32 v[80:81], v[116:117], v[84:85], v[80:81] op_sel:[1,1,0] op_sel_hi:[0,1,1] neg_lo:[1,0,0]
  v_cvt_pk_f16_f32 v58, v80, -v81
  ds_write_addtid_b32 v56 offset:2176
  ds_write_addtid_b32 v57 offset:2448
  v_pk_mul_f32 v[82:83], v[118:119], v[84:85] op_sel_hi:[1,0]
  v_pk_fma_f32 v[82:83], v[118:119], v[84:85], v[82:83] op_sel:[1,1,0] op_sel_hi:[0,1,1] neg_lo:[1,0,0]
  v_cvt_pk_f16_f32 v59, v82, -v83
  v_pk_mul_f32 v[82:83], v[120:121], v[84:85] op_sel_hi:[1,0]
  v_pk_fma_f32 v[82:83], v[120:121], v[84:85], v[82:83] op_sel:[1,1,0] op_sel_hi:[0,1,1] neg_lo:[1,0,0]
  v_cvt_pk_f16_f32 v60, v82, -v83
  ds_write_addtid_b32 v58 offset:2720
  ds_write_addtid_b32 v59 offset:2992
  v_pk_mul_f32 v[86:87], v[122:123], v[84:85] op_sel_hi:[1,0]
  v_pk_fma_f32 v[86:87], v[122:123], v[84:85], v[86:87] op_sel:[1,1,0] op_sel_hi:[0,1,1] neg_lo:[1,0,0]
  v_cvt_pk_f16_f32 v61, v86, -v87
  v_pk_mul_f32 v[86:87], v[124:125], v[84:85] op_sel_hi:[1,0]
  v_pk_fma_f32 v[86:87], v[124:125], v[84:85], v[86:87] op_sel:[1,1,0] op_sel_hi:[0,1,1] neg_lo:[1,0,0]
  v_cvt_pk_f16_f32 v56, v86, -v87
  ds_write_addtid_b32 v60 offset:3264
  ds_write_addtid_b32 v61 offset:3536
  v_pk_mul_f32 v[118:119], v[126:127], v[84:85] op_sel_hi:[1,0]
  v_pk_fma_f32 v[118:119], v[126:127], v[84:85], v[118:119] op_sel:[1,1,0] op_sel_hi:[0,1,1] neg_lo:[1,0,0]
  v_cvt_pk_f16_f32 v57, v118, -v119
  v_pk_mul_f32 v[118:119], v[84:85], v[84:85] op_sel_hi:[1,0]
  v_pk_fma_f32 v[118:119], v[84:85], v[84:85], v[118:119] op_sel:[1,1,0] op_sel_hi:[0,1,1] neg_lo:[1,0,0]
  ds_write_addtid_b32 v56 offset:3808
  ds_write_addtid_b32 v57 offset:4080
  ds_read_b128 v[100:103], v210 offset:0
  ds_read_b128 v[104:107], v210 offset:64
  ds_read_b128 v[108:111], v210 offset:128
  ds_read_b128 v[112:115], v210 offset:192
  v_pk_mul_f32 v[84:85], v[118:119], v[118:119] op_sel_hi:[1,0]
  v_pk_fma_f32 v[84:85], v[118:119], v[118:119], v[84:85] op_sel:[1,1,0] op_sel_hi:[0,1,1] neg_lo:[1,0,0]
  v_pk_mul_f32 v[122:123], v[42:43], v[118:119] op_sel_hi:[1,0]
  v_pk_fma_f32 v[122:123], v[42:43], v[118:119], v[122:123] op_sel:[1,1,0] op_sel_hi:[0,1,1] neg_lo:[1,0,0]
  v_cvt_pk_f16_f32 v58, v122, -v123
  v_pk_mul_f32 v[126:127], v[116:117], v[118:119] op_sel_hi:[1,0]
  v_pk_fma_f32 v[126:127], v[116:117], v[118:119], v[126:127] op_sel:[1,1,0] op_sel_hi:[0,1,1] neg_lo:[1,0,0]
  v_cvt_pk_f16_f32 v59, v126, -v127
  v_pk_mul_f32 v[116:117], v[120:121], v[118:119] op_sel_hi:[1,0]
  v_pk_fma_f32 v[116:117], v[120:121], v[118:119], v[116:117] op_sel:[1,1,0] op_sel_hi:[0,1,1] neg_lo:[1,0,0]
  v_cvt_pk_f16_f32 v60, v116, -v117
  ds_write_addtid_b32 v58 offset:0
  ds_write_addtid_b32 v59 offset:272
  v_pk_mul_f32 v[126:127], v[124:125], v[118:119] op_sel_hi:[1,0]
  v_pk_fma_f32 v[126:127], v[124:125], v[118:119], v[126:127] op_sel:[1,1,0] op_sel_hi:[0,1,1] neg_lo:[1,0,0]
  s_waitcnt lgkmcnt(5)
  v_mfma_f32_16x16x32_f16 v[88:91], v[100:103], v[64:67], 0
  v_cvt_pk_f16_f32 v61, v126, -v127
  v_pk_mul_f32 v[124:125], v[62:63], v[118:119] op_sel_hi:[1,0]
  v_pk_fma_f32 v[124:125], v[62:63], v[118:119], v[124:125] op_sel:[1,1,0] op_sel_hi:[0,1,1] neg_lo:[1,0,0]
  s_waitcnt lgkmcnt(4)
  v_mfma_f32_16x16x32_f16 v[88:91], v[104:107], v[68:71], v[88:91]
  v_cvt_pk_f16_f32 v56, v124, -v125
  ds_write_addtid_b32 v60 offset:544
  ds_write_addtid_b32 v61 offset:816
  v_pk_mul_f32 v[126:127], v[80:81], v[118:119] op_sel_hi:[1,0]
  v_pk_fma_f32 v[126:127], v[80:81], v[118:119], v[126:127] op_sel:[1,1,0] op_sel_hi:[0,1,1] neg_lo:[1,0,0]
  s_waitcnt lgkmcnt(5)
  v_mfma_f32_16x16x32_f16 v[88:91], v[108:111], v[72:75], v[88:91]
  v_cvt_pk_f16_f32 v57, v126, -v127
  v_pk_mul_f32 v[80:81], v[82:83], v[118:119] op_sel_hi:[1,0]
  v_pk_fma_f32 v[80:81], v[82:83], v[118:119], v[80:81] op_sel:[1,1,0] op_sel_hi:[0,1,1] neg_lo:[1,0,0]
  s_waitcnt lgkmcnt(4)
  v_mfma_f32_16x16x32_f16 v[88:91], v[112:115], v[76:79], v[88:91]
  v_cvt_pk_f16_f32 v58, v80, -v81
  ds_write_addtid_b32 v56 offset:1088
  ds_write_addtid_b32 v57 offset:1360
  v_pk_mul_f32 v[126:127], v[86:87], v[118:119] op_sel_hi:[1,0]
  v_pk_fma_f32 v[126:127], v[86:87], v[118:119], v[126:127] op_sel:[1,1,0] op_sel_hi:[0,1,1] neg_lo:[1,0,0]
  v_cvt_pk_f16_f32 v59, v126, -v127
  v_pk_mul_f32 v[86:87], v[42:43], v[84:85] op_sel_hi:[1,0]
  v_pk_fma_f32 v[86:87], v[42:43], v[84:85], v[86:87] op_sel:[1,1,0] op_sel_hi:[0,1,1] neg_lo:[1,0,0]
  v_cvt_pk_f16_f32 v60, v86, -v87
  ds_write_addtid_b32 v58 offset:1632
  ds_write_addtid_b32 v59 offset:1904
  v_pk_mul_f32 v[118:119], v[120:121], v[84:85] op_sel_hi:[1,0]
  v_pk_fma_f32 v[118:119], v[120:121], v[84:85], v[118:119] op_sel:[1,1,0] op_sel_hi:[0,1,1] neg_lo:[1,0,0]
  v_cvt_pk_f16_f32 v61, v118, -v119
  v_pk_mul_f32 v[118:119], v[62:63], v[84:85] op_sel_hi:[1,0]
  v_pk_fma_f32 v[118:119], v[62:63], v[84:85], v[118:119] op_sel:[1,1,0] op_sel_hi:[0,1,1] neg_lo:[1,0,0]
  ds_write_b128 v211, v[88:91]
  v_cvt_pk_f16_f32 v56, v118, -v119
  ds_write_addtid_b32 v60 offset:2176
  ds_write_addtid_b32 v61 offset:2448
  v_pk_mul_f32 v[120:121], v[82:83], v[84:85] op_sel_hi:[1,0]
  v_pk_fma_f32 v[120:121], v[82:83], v[84:85], v[120:121] op_sel:[1,1,0] op_sel_hi:[0,1,1] neg_lo:[1,0,0]
  v_cvt_pk_f16_f32 v57, v120, -v121
  v_pk_mul_f32 v[82:83], v[122:123], v[84:85] op_sel_hi:[1,0]
  v_pk_fma_f32 v[82:83], v[122:123], v[84:85], v[82:83] op_sel:[1,1,0] op_sel_hi:[0,1,1] neg_lo:[1,0,0]
  v_cvt_pk_f16_f32 v58, v82, -v83
  ds_write_addtid_b32 v56 offset:2720
  ds_write_addtid_b32 v57 offset:2992
  v_pk_mul_f32 v[120:121], v[116:117], v[84:85] op_sel_hi:[1,0]
  v_pk_fma_f32 v[120:121], v[116:117], v[84:85], v[120:121] op_sel:[1,1,0] op_sel_hi:[0,1,1] neg_lo:[1,0,0]
  v_cvt_pk_f16_f32 v59, v120, -v121
  v_pk_mul_f32 v[116:117], v[124:125], v[84:85] op_sel_hi:[1,0]
  v_pk_fma_f32 v[116:117], v[124:125], v[84:85], v[116:117] op_sel:[1,1,0] op_sel_hi:[0,1,1] neg_lo:[1,0,0]
  v_cvt_pk_f16_f32 v60, v116, -v117
  ds_write_addtid_b32 v58 offset:3264
  ds_write_addtid_b32 v59 offset:3536
  v_pk_mul_f32 v[120:121], v[80:81], v[84:85] op_sel_hi:[1,0]
  v_pk_fma_f32 v[120:121], v[80:81], v[84:85], v[120:121] op_sel:[1,1,0] op_sel_hi:[0,1,1] neg_lo:[1,0,0]
  v_cvt_pk_f16_f32 v61, v120, -v121
  ds_write_addtid_b32 v60 offset:3808
  ds_write_addtid_b32 v61 offset:4080
  ds_read_b128 v[100:103], v210 offset:0
  ds_read_b128 v[104:107], v210 offset:64
  ds_read_b128 v[108:111], v210 offset:128
  ds_read_b128 v[112:115], v210 offset:192
  v_mul_f32 v84, 0x44800000, v40
  v_mul_f32 v85, 0x44800000, v41
  v_exp_f32 v84, v84
  v_fract_f32 v85, v85
  v_fmamk_f32 v85, v47, 0x44800000, v85
  v_cos_f32 v80, v85
  v_sin_f32 v81, v85
  s_nop 0
  v_pk_mul_f32 v[80:81], v[80:81], v[84:85] op_sel_hi:[1,0]
  v_pk_mul_f32 v[84:85], v[42:43], v[80:81] op_sel_hi:[1,0]
  v_pk_fma_f32 v[84:85], v[42:43], v[80:81], v[84:85] op_sel:[1,1,0] op_sel_hi:[0,1,1] neg_lo:[1,0,0]
  v_cvt_pk_f16_f32 v56, v84, -v85
  v_pk_mul_f32 v[84:85], v[62:63], v[80:81] op_sel_hi:[1,0]
  v_pk_fma_f32 v[84:85], v[62:63], v[80:81], v[84:85] op_sel:[1,1,0] op_sel_hi:[0,1,1] neg_lo:[1,0,0]
  v_cvt_pk_f16_f32 v57, v84, -v85
  v_pk_mul_f32 v[84:85], v[122:123], v[80:81] op_sel_hi:[1,0]
  v_pk_fma_f32 v[84:85], v[122:123], v[80:81], v[84:85] op_sel:[1,1,0] op_sel_hi:[0,1,1] neg_lo:[1,0,0]
  v_cvt_pk_f16_f32 v58, v84, -v85
  ds_write_addtid_b32 v56 offset:0
  ds_write_addtid_b32 v57 offset:272
  v_pk_mul_f32 v[84:85], v[124:125], v[80:81] op_sel_hi:[1,0]
  v_pk_fma_f32 v[84:85], v[124:125], v[80:81], v[84:85] op_sel:[1,1,0] op_sel_hi:[0,1,1] neg_lo:[1,0,0]
  s_waitcnt lgkmcnt(5)
  v_mfma_f32_16x16x32_f16 v[92:95], v[100:103], v[64:67], 0
  v_cvt_pk_f16_f32 v59, v84, -v85
  v_pk_mul_f32 v[84:85], v[86:87], v[80:81] op_sel_hi:[1,0]
  v_pk_fma_f32 v[84:85], v[86:87], v[80:81], v[84:85] op_sel:[1,1,0] op_sel_hi:[0,1,1] neg_lo:[1,0,0]
  s_waitcnt lgkmcnt(4)
  v_mfma_f32_16x16x32_f16 v[92:95], v[104:107], v[68:71], v[92:95]
  v_cvt_pk_f16_f32 v60, v84, -v85
  ds_write_addtid_b32 v58 offset:544
  ds_write_addtid_b32 v59 offset:816
  v_pk_mul_f32 v[84:85], v[118:119], v[80:81] op_sel_hi:[1,0]
  v_pk_fma_f32 v[84:85], v[118:119], v[80:81], v[84:85] op_sel:[1,1,0] op_sel_hi:[0,1,1] neg_lo:[1,0,0]
  s_waitcnt lgkmcnt(5)
  v_mfma_f32_16x16x32_f16 v[92:95], v[108:111], v[72:75], v[92:95]
  v_cvt_pk_f16_f32 v61, v84, -v85
  v_pk_mul_f32 v[84:85], v[82:83], v[80:81] op_sel_hi:[1,0]
  v_pk_fma_f32 v[84:85], v[82:83], v[80:81], v[84:85] op_sel:[1,1,0] op_sel_hi:[0,1,1] neg_lo:[1,0,0]
  s_waitcnt lgkmcnt(4)
  v_mfma_f32_16x16x32_f16 v[92:95], v[112:115], v[76:79], v[92:95]
  v_cvt_pk_f16_f32 v56, v84, -v85
  ds_write_addtid_b32 v60 offset:1088
  ds_write_addtid_b32 v61 offset:1360
  v_pk_mul_f32 v[84:85], v[116:117], v[80:81] op_sel_hi:[1,0]
  v_pk_fma_f32 v[84:85], v[116:117], v[80:81], v[84:85] op_sel:[1,1,0] op_sel_hi:[0,1,1] neg_lo:[1,0,0]
  v_cvt_pk_f16_f32 v57, v84, -v85
  v_pk_mul_f32 v[84:85], v[80:81], v[80:81] op_sel_hi:[1,0]
  v_pk_fma_f32 v[84:85], v[80:81], v[80:81], v[84:85] op_sel:[1,1,0] op_sel_hi:[0,1,1] neg_lo:[1,0,0]
  v_pk_mul_f32 v[120:121], v[42:43], v[84:85] op_sel_hi:[1,0]
  v_pk_fma_f32 v[120:121], v[42:43], v[84:85], v[120:121] op_sel:[1,1,0] op_sel_hi:[0,1,1] neg_lo:[1,0,0]
  v_cvt_pk_f16_f32 v58, v120, -v121
  ds_write_addtid_b32 v56 offset:1632
  ds_write_addtid_b32 v57 offset:1904
  ds_write_addtid_b32 v58 offset:2176
  ds_read_b128 v[100:103], v210 offset:0
  ds_read_b128 v[104:107], v210 offset:64
  ds_read_b128 v[108:111], v210 offset:128
  ds_read_b128 v[112:115], v210 offset:192
  ds_write_b64 v212, v[92:93]
  ds_write_b64 v215, v[94:95]
  s_waitcnt lgkmcnt(5)
  v_mfma_f32_16x16x32_f16 v[96:99], v[100:103], v[64:67], 0
  s_waitcnt lgkmcnt(4)
  v_mfma_f32_16x16x32_f16 v[96:99], v[104:107], v[68:71], v[96:99]
  s_waitcnt lgkmcnt(3)
  v_mfma_f32_16x16x32_f16 v[96:99], v[108:111], v[72:75], v[96:99]
  s_waitcnt lgkmcnt(2)
  v_mfma_f32_16x16x32_f16 v[96:99], v[112:115], v[76:79], v[96:99]
  s_mov_b32 exec_hi, 0xffff
  s_nop 6
  ds_write_b32 v213, v96 offset:2048
  s_mov_b32 exec_hi, 0
  ds_write_b32 v213, v97 offset:2112
  ds_write_b32 v213, v98 offset:2176
  ds_write_b32 v213, v99 offset:2240

  s_mov_b64 exec, 1
  ds_add_u32 v209, v249 offset:208
  s_mov_b64 exec, -1
  s_cmp_lt_u32 s3, 4
  s_cbranch_scc1 CU_1
  s_setprio 1
CU_1:
  s_cmp_ge_u32 s3, 4
  s_cbranch_scc1 M_SUE
  v_and_b32 v20, 15, v2
  v_lshrrev_b32 v21, 4, v2
  s_lshl_b32 s40, s3, 2
  v_and_b32 v22, 3, v20
  v_mul_u32_u24 v22, 4160, v22
  v_lshrrev_b32 v23, 2, v20
  v_lshlrev_b32 v23, 3, v23
  v_lshl_add_u32 v23, v21, 4, v23
  v_sub_u32 v22, v22, v23
  v_add_u32 v22, 86088, v22
  v_lshlrev_b32 v23, 5, v20
  v_lshlrev_b32 v19, 4, v21
  v_sub_u32 v19, v23, v19
  v_add_u32 v19, 55216, v19
  v_lshl_add_u32 v3, v21, 3, v23
  v_add_u32 v3, 55648, v3
  s_lshr_b32 s40, 0x10221100, s40
  s_and_b32 s40, s40, 15
  s_mul_i32 s50, s40, 16640
  s_cmp_eq_u32 s40, 2
  s_cselect_b32 s50, 4294919808, s50
  v_add_u32 v4, s50, v22
  v_add_u32 v5, 16640, v22
  s_mul_i32 s50, s40, 4608
  v_add_u32 v6, s50, v19
  v_add_u32 v7, 4608, v19
  s_mul_i32 s50, s40, 18432
  s_add_u32 s50, s50, 1536
  v_lshl_add_u32 v8, v2, 4, s50
  v_lshlrev_b32 v9, 4, v2
  v_add_u32 v9, 19968, v9
  s_lshl_b32 s40, s40, 2
  v_mov_b32 v1, s40

  s_lshl_b32 s40, s3, 2
  s_lshr_b32 s63, 0xc8004040, s40
  s_and_b32 s63, s63, 15
  s_lshl_b32 s50, s63, 10
  s_lshl_b32 s51, s2, 14
  s_add_u32 s50, s50, s51
  s_add_u32 s50, s50, 1048576
  v_lshl_add_u32 v252, v2, 4, s50

  s_add_u32 s85, s3, 7
  s_cmp_ge_u32 s3, 6
  s_cselect_b32 s83, s85, s3
  s_add_u32 s84, s3, 3
  s_cmp_lt_u32 s3, 3
  s_cselect_b32 s84, s83, s84
  s_cselect_b32 s82, 0, 1.0
  s_add_u32 s86, s3, -4
  s_cmp_lt_u32 s86, 2
  s_cselect_b32 s85, s85, s83
  s_cselect_b32 s87, 1.0, 0
  s_lshl_b32 s83, s83, 10
  s_lshl_b32 s84, s84, 10
  s_lshl_b32 s85, s85, 10
  v_lshlrev_b32 v26, 4, v2
  v_add_u32 v26, 1536, v26
  v_add_u32 v24, s83, v26
  v_add_u32 v25, s84, v26
  v_add_u32 v26, s85, v26
  s_lshl_b32 s40, s3, 9
  v_add_u32 v27, s40, v3
  s_mul_i32 s40, s3, 1536
  s_add_u32 s40, s40, 69120
  v_and_b32 v28, 15, v2
  v_mul_u32_u24 v28, 96, v28
  v_lshrrev_b32 v29, 5, v2
  v_mul_u32_u24 v29, 48, v29
  v_and_b32 v30, 16, v2
  v_add3_u32 v28, v28, v29, v30
  v_add_u32 v28, s40, v28
  v_lshrrev_b32 v30, 2, v2
  v_mul_u32_u24 v29, 96, v30
  v_and_b32 v31, 3, v2
  v_mul_u32_u24 v16, 12, v31
  v_add3_u32 v29, v29, v16, s40
  v_lshlrev_b32 v30, 15, v30
  v_lshl_add_u32 v30, v31, 4, v30
  s_lshl_b32 s40, s3, 19
  s_lshl_b32 s86, s2, 6
  s_add_u32 s40, s40, s86
  s_add_u32 s40, s40, 6291456
  v_add_u32 v30, s40, v30

M_SUE:
SP_3:
  ds_read_b32 v251, v209 offset:208
  s_waitcnt lgkmcnt(0)
  v_readfirstlane_b32 s94, v251
  s_cmp_ge_u32 s94, 2
  s_cbranch_scc0 SP_3

  s_cmp_eq_u32 s43, 0
  s_cbranch_scc0 M_EXB

  ds_read_b128 v[64:67], v202 offset:0
  ds_read_b128 v[72:75], v202 offset:2816
  ds_read_b128 v[68:71], v202 offset:16
  ds_read_b128 v[76:79], v202 offset:2832
  ds_read_b64 v[128:129], v200 offset:512
  ds_read_b64 v[136:137], v200 offset:3328
  ds_read_b64 v[130:131], v200 offset:520
  ds_read_b64 v[138:139], v200 offset:3336
  ds_read_b64 v[132:133], v200 offset:528
  ds_read_b64 v[140:141], v200 offset:3344
  ds_read_b64 v[134:135], v200 offset:536
  ds_read_b64 v[142:143], v200 offset:3352
  s_waitcnt lgkmcnt(8)
  v_add_f32 v64, v64, v72
  v_add_f32 v65, v65, v73
  v_add_f32 v66, v66, v74
  v_add_f32 v67, v67, v75
  v_add_f32 v68, v68, v76
  v_add_f32 v69, v69, v77
  v_add_f32 v70, v70, v78
  v_add_f32 v71, v71, v79
  v_cvt_pk_f16_f32 v100, v71, v70
  v_cvt_pk_f16_f32 v101, v69, v68
  v_cvt_pk_f16_f32 v102, v67, v66
  v_cvt_pk_f16_f32 v103, v65, v64
  v_mov_b32 v104, 0
  v_mov_b32 v105, 0
  s_mov_b32 exec_hi, 0
  v_cvt_pk_f16_f32 v100, v68, v67
  v_cvt_pk_f16_f32 v101, v66, v66
  v_cvt_pk_f16_f32 v102, v66, v65
  v_cvt_pk_f16_f32 v103, v64, v64
  s_mov_b64 exec, -1

  ds_read_b64 v[144:145], v200 offset:640
  ds_read_b64 v[152:153], v200 offset:3456
  ds_read_b64 v[146:147], v200 offset:648
  ds_read_b64 v[154:155], v200 offset:3464
  ds_read_b64 v[148:149], v200 offset:656
  ds_read_b64 v[156:157], v200 offset:3472
  ds_read_b64 v[150:151], v200 offset:664
  ds_read_b64 v[158:159], v200 offset:3480
  ds_write_b128 v208, v[100:103] offset:15552
  v_mov_b32 v104, v100 wave_shl:1 row_mask:0xf bank_mask:0xf
  v_mov_b32 v105, v101 wave_shl:1 row_mask:0xf bank_mask:0xf
  v_alignbit_b32 v108, v101, v100, 16
  v_alignbit_b32 v109, v102, v101, 16
  v_alignbit_b32 v110, v103, v102, 16
  v_alignbit_b32 v111, v104, v103, 16
  v_mov_b32 v112, v101
  v_mov_b32 v113, v102
  ds_write_b128 v208, v[108:111] offset:11392
  v_mov_b32 v114, v103
  v_mov_b32 v115, v104
  v_mov_b32 v116, v109
  v_mov_b32 v117, v110
  ds_write_b128 v208, v[112:115] offset:7232
  v_mov_b32 v118, v111
  v_alignbit_b32 v119, v105, v104, 16
  ds_write_b128 v208, v[116:119] offset:3072

  ds_read_b64 v[160:161], v200 offset:768
  ds_read_b64 v[168:169], v200 offset:3584
  ds_read_b64 v[162:163], v200 offset:776
  ds_read_b64 v[170:171], v200 offset:3592
  ds_read_b64 v[164:165], v200 offset:784
  ds_read_b64 v[172:173], v200 offset:3600
  ds_read_b64 v[166:167], v200 offset:792
  ds_read_b64 v[174:175], v200 offset:3608
  ds_read_b64 v[176:177], v200 offset:896
  ds_read_b64 v[184:185], v200 offset:3712
  ds_read_b64 v[178:179], v200 offset:904
  ds_read_b64 v[186:187], v200 offset:3720
  ds_read_b64 v[180:181], v200 offset:912
  ds_read_b64 v[188:189], v200 offset:3728
  ds_read_b64 v[182:183], v200 offset:920
  ds_read_b64 v[190:191], v200 offset:3736
  s_waitcnt lgkmcnt(15)
  v_pk_add_f32 v[128:129], v[128:129], v[136:137]
  v_pk_add_f32 v[130:131], v[130:131], v[138:139]
  v_pk_add_f32 v[132:133], v[132:133], v[140:141]
  v_pk_add_f32 v[134:135], v[134:135], v[142:143]
  v_cvt_pk_f16_f32 v112, v134, v132
  v_cvt_pk_f16_f32 v113, v130, v128
  v_cvt_pk_f16_f32 v114, v135, v133
  v_cvt_pk_f16_f32 v115, v131, v129
  v_and_b32 v112, v112, v203
  v_and_b32 v113, v113, v204
  v_and_b32 v114, v114, v203
  v_and_b32 v115, v115, v204
  ds_write_b128 v208, v[112:115] offset:0
  s_waitcnt lgkmcnt(15)
  v_pk_add_f32 v[144:145], v[144:145], v[152:153]
  v_pk_add_f32 v[146:147], v[146:147], v[154:155]
  v_pk_add_f32 v[148:149], v[148:149], v[156:157]
  v_pk_add_f32 v[150:151], v[150:151], v[158:159]
  v_cvt_pk_f16_f32 v116, v150, v148
  v_cvt_pk_f16_f32 v117, v146, v144
  v_cvt_pk_f16_f32 v118, v151, v149
  v_cvt_pk_f16_f32 v119, v147, v145
  ds_write_b128 v208, v[116:119] offset:4160
  s_waitcnt lgkmcnt(10)
  v_pk_add_f32 v[160:161], v[160:161], v[168:169]
  v_pk_add_f32 v[162:163], v[162:163], v[170:171]
  v_pk_add_f32 v[164:165], v[164:165], v[172:173]
  v_pk_add_f32 v[166:167], v[166:167], v[174:175]
  v_cvt_pk_f16_f32 v112, v166, v164
  v_cvt_pk_f16_f32 v113, v162, v160
  v_cvt_pk_f16_f32 v114, v167, v165
  v_cvt_pk_f16_f32 v115, v163, v161
  ds_write_b128 v208, v[112:115] offset:8320
  s_waitcnt lgkmcnt(3)
  v_pk_add_f32 v[176:177], v[176:177], v[184:185]
  v_pk_add_f32 v[178:179], v[178:179], v[186:187]
  v_pk_add_f32 v[180:181], v[180:181], v[188:189]
  v_pk_add_f32 v[182:183], v[182:183], v[190:191]
  v_cvt_pk_f16_f32 v116, v182, v180
  v_cvt_pk_f16_f32 v117, v178, v176
  v_cvt_pk_f16_f32 v118, v183, v181
  v_cvt_pk_f16_f32 v119, v179, v177
  s_mov_b64 exec, 0x8000
  v_and_b32 v118, 0xffff0000, v118
  s_mov_b64 exec, -1
  ds_write_b128 v208, v[116:119] offset:12480
  v_mov_b32 v104, 0
  v_mov_b32 v105, 0
  v_mov_b32 v106, 0
  v_mov_b32 v107, 0
  s_mov_b64 exec, 0xff
  ds_write_b128 v214, v[104:107] offset:4096

  s_branch M_EXD
M_EXB:
  ds_read2st64_b32 v[56:57], v200 offset0:0 offset1:11
  ds_read2st64_b32 v[58:59], v201 offset0:0 offset1:11
  ds_read2st64_b32 v[60:61], v205 offset0:8 offset1:19
  ds_read2st64_b32 v[62:63], v206 offset0:8 offset1:19
  ds_read2st64_b32 v[64:65], v202 offset0:0 offset1:11
  ds_read2st64_b32 v[66:67], v203 offset0:0 offset1:11
  ds_read2st64_b32 v[68:69], v204 offset0:0 offset1:11
  ds_read2st64_b32 v[70:71], v205 offset0:6 offset1:17
  ds_read2st64_b32 v[72:73], v206 offset0:6 offset1:17
  ds_read2st64_b32 v[74:75], v207 offset0:6 offset1:17
  s_waitcnt lgkmcnt(6)
  v_add_f32 v56, v56, v57
  v_add_f32 v58, v58, v59
  v_add_f32 v60, v60, v61
  v_add_f32 v62, v62, v63
  s_mov_b32 exec_hi, 0x7fffffff
  v_mov_b32 v58, 0
  v_mov_b32 v57, 0
  s_mov_b32 exec_hi, 0x3fffffff
  v_mov_b32 v56, 0
  s_mov_b32 exec_lo, 0
  s_mov_b32 exec_hi, 0x80000000
  v_mov_b32 v57, v56
  s_mov_b64 exec, -1
  v_cvt_pk_f16_f32 v80, v58, v58
  v_cvt_pk_f16_f32 v82, v56, v56
  v_cvt_pk_f16_f32 v81, v58, v57
  v_cvt_pk_f16_f32 v84, v60, v60
  v_mov_b32 v83, v82
  v_cvt_pk_f16_f32 v85, v62, v62

  s_mov_b32 exec_lo, 0
  s_mov_b32 exec_hi, 0xf0000000
  ds_write_b128 v208, v[80:83] offset:13504
  v_mov_b32 v84, v80 wave_shl:1 row_mask:0xf bank_mask:0xf
  v_mov_b32 v85, v81 wave_shl:1 row_mask:0xf bank_mask:0xf
  v_alignbit_b32 v88, v81, v80, 16
  v_alignbit_b32 v89, v82, v81, 16
  v_alignbit_b32 v90, v83, v82, 16
  v_alignbit_b32 v91, v84, v83, 16
  v_mov_b32 v92, v81
  v_mov_b32 v93, v82
  ds_write_b128 v208, v[88:91] offset:9344
  v_mov_b32 v94, v83
  v_mov_b32 v95, v84
  v_mov_b32 v96, v89
  v_mov_b32 v97, v90
  ds_write_b128 v208, v[92:95] offset:5184
  v_mov_b32 v98, v91
  v_alignbit_b32 v99, v85, v84, 16
  ds_write_b128 v208, v[96:99] offset:1024

  s_mov_b64 exec, -1
  s_waitcnt lgkmcnt(4)
  v_add_f32 v64, v64, v65
  v_add_f32 v66, v66, v67
  v_add_f32 v68, v68, v69
  v_add_f32 v70, v70, v71
  v_add_f32 v72, v72, v73
  v_add_f32 v74, v74, v75
  v_cvt_pk_f16_f32 v100, v68, v68
  v_cvt_pk_f16_f32 v101, v66, v66
  v_cvt_pk_f16_f32 v102, v66, v64
  v_cvt_pk_f16_f32 v103, v64, v64
  v_cvt_pk_f16_f32 v104, v70, v72
  v_cvt_pk_f16_f32 v105, v74, v74

  ds_write_b128 v208, v[100:103] offset:14528
  v_mov_b32 v104, v100 wave_shl:1 row_mask:0xf bank_mask:0xf
  v_mov_b32 v105, v101 wave_shl:1 row_mask:0xf bank_mask:0xf
  v_alignbit_b32 v108, v101, v100, 16
  v_alignbit_b32 v109, v102, v101, 16
  v_alignbit_b32 v110, v103, v102, 16
  v_alignbit_b32 v111, v104, v103, 16
  v_mov_b32 v112, v101
  v_mov_b32 v113, v102
  ds_write_b128 v208, v[108:111] offset:10368
  v_mov_b32 v114, v103
  v_mov_b32 v115, v104
  v_mov_b32 v116, v109
  v_mov_b32 v117, v110
  ds_write_b128 v208, v[112:115] offset:6208
  v_mov_b32 v118, v111
  v_alignbit_b32 v119, v105, v104, 16
  ds_write_b128 v208, v[116:119] offset:2048

M_EXD:
  s_mov_b64 exec, 1
  ds_add_u32 v209, v249 offset:224
  s_mov_b64 exec, -1
  s_sub_u32 s40, s3, 0
  s_cmp_ge_u32 s40, 2
  s_cbranch_scc1 NI_4
  global_load_dwordx4 v[224:227], v252, s[36:37] offset:0 sc1
  global_load_dwordx4 v[228:231], v252, s[36:37] offset:1024 sc1
  global_load_dwordx4 v[232:235], v252, s[36:37] offset:2048 sc1
  global_load_dwordx4 v[236:239], v252, s[36:37] offset:3072 sc1
NI_4:
  s_mov_b32 s73, 0
  s_branch M_CSET
M_MOD:
  s_cmp_ge_u32 s2, 243
  s_cbranch_scc1 M_MODX

  global_load_dwordx4 v[64:67], v216, s[30:31] offset:3456 nt
  global_load_dwordx4 v[68:71], v217, s[30:31] offset:3456 nt
  global_load_dwordx4 v[72:75], v218, s[30:31] offset:3456 nt
  global_load_dwordx4 v[76:79], v219, s[30:31] offset:3456 nt
M_MODX:
  s_getpc_b64 s[74:75]
BXB6:
  s_add_u32 s74, s74, BOXT - BXB6
  s_addc_u32 s75, s75, 0
  v_lshlrev_b32 v192, 4, v2
  global_load_dwordx4 v[196:199], v192, s[74:75] offset:1024
  global_load_dwordx4 v[192:195], v192, s[74:75]

  v_and_b32 v20, 15, v2
  v_lshrrev_b32 v21, 4, v2
  s_lshl_b32 s40, s3, 2
  v_and_b32 v22, 3, v20
  v_mul_u32_u24 v22, 4160, v22
  v_lshrrev_b32 v23, 2, v20
  v_lshlrev_b32 v23, 3, v23
  v_lshl_add_u32 v23, v21, 4, v23
  v_sub_u32 v22, v22, v23
  v_add_u32 v22, 86088, v22
  v_lshlrev_b32 v23, 5, v20
  v_lshlrev_b32 v19, 4, v21
  v_sub_u32 v19, v23, v19
  v_add_u32 v19, 55216, v19
  v_lshl_add_u32 v3, v21, 3, v23
  v_add_u32 v3, 55648, v3
  s_lshr_b32 s40, 0x10221100, s40
  s_and_b32 s40, s40, 15
  s_mul_i32 s50, s40, 16640
  s_cmp_eq_u32 s40, 2
  s_cselect_b32 s50, 4294919808, s50
  v_add_u32 v4, s50, v22
  v_add_u32 v5, 16640, v22
  s_mul_i32 s50, s40, 4608
  v_add_u32 v6, s50, v19
  v_add_u32 v7, 4608, v19
  s_mul_i32 s50, s40, 18432
  s_add_u32 s50, s50, 1536
  v_lshl_add_u32 v8, v2, 4, s50
  v_lshlrev_b32 v9, 4, v2
  v_add_u32 v9, 19968, v9
  s_lshl_b32 s40, s40, 2
  v_mov_b32 v1, s40

  s_lshl_b32 s40, s3, 2
  s_lshr_b32 s63, 0xc8004040, s40
  s_and_b32 s63, s63, 15
  s_lshl_b32 s50, s63, 10
  s_lshl_b32 s51, s2, 14
  s_add_u32 s50, s50, s51
  s_add_u32 s50, s50, 1048576
  v_lshl_add_u32 v252, v2, 4, s50

  s_add_u32 s85, s3, 7
  s_cmp_ge_u32 s3, 6
  s_cselect_b32 s83, s85, s3
  s_add_u32 s84, s3, 3
  s_cmp_lt_u32 s3, 3
  s_cselect_b32 s84, s83, s84
  s_cselect_b32 s82, 0, 1.0
  s_add_u32 s86, s3, -4
  s_cmp_lt_u32 s86, 2
  s_cselect_b32 s85, s85, s83
  s_cselect_b32 s87, 1.0, 0
  s_lshl_b32 s83, s83, 10
  s_lshl_b32 s84, s84, 10
  s_lshl_b32 s85, s85, 10
  v_lshlrev_b32 v26, 4, v2
  v_add_u32 v26, 1536, v26
  v_add_u32 v24, s83, v26
  v_add_u32 v25, s84, v26
  v_add_u32 v26, s85, v26
  s_lshl_b32 s40, s3, 9
  v_add_u32 v27, s40, v3
  s_mul_i32 s40, s3, 1536
  s_add_u32 s40, s40, 69120
  v_and_b32 v28, 15, v2
  v_mul_u32_u24 v28, 96, v28
  v_lshrrev_b32 v29, 5, v2
  v_mul_u32_u24 v29, 48, v29
  v_and_b32 v30, 16, v2
  v_add3_u32 v28, v28, v29, v30
  v_add_u32 v28, s40, v28
  v_lshrrev_b32 v30, 2, v2
  v_mul_u32_u24 v29, 96, v30
  v_and_b32 v31, 3, v2
  v_mul_u32_u24 v16, 12, v31
  v_add3_u32 v29, v29, v16, s40
  v_lshlrev_b32 v30, 15, v30
  v_lshl_add_u32 v30, v31, 4, v30
  s_lshl_b32 s40, s3, 19
  s_lshl_b32 s86, s2, 6
  s_add_u32 s40, s40, s86
  s_add_u32 s40, s40, 6291456
  v_add_u32 v30, s40, v30

  s_setprio 0
  s_cmp_lg_u32 s3, 6
  s_cbranch_scc1 M_W7X

SP_5:
  ds_read_b32 v251, v248 offset:208
  s_waitcnt lgkmcnt(0)
  v_readfirstlane_b32 s94, v251
  s_cmp_ge_u32 s94, 1
  s_cbranch_scc0 SP_5

  global_load_ushort v243, v243, s[16:17]
  global_load_dwordx2 v[120:121], v240, s[36:37] sc1
  global_load_dwordx2 v[122:123], v241, s[36:37] sc1
  global_load_dwordx2 v[124:125], v242, s[36:37] sc1
  s_mov_b32 s41, 65536
M_MP:
  s_waitcnt vmcnt(0)
  v_xor_b32 v16, s38, v121
  v_xor_b32 v17, s38, v123
  v_xor_b32 v18, s38, v125
  v_or3_b32 v16, v16, v17, v18
  v_cmp_ne_u32 vcc, 0, v16
  s_cbranch_vccz M_MPD

  global_load_dwordx2 v[120:121], v240, s[36:37] sc1
  global_load_dwordx2 v[122:123], v241, s[36:37] sc1
  global_load_dwordx2 v[124:125], v242, s[36:37] sc1
  s_waitcnt vmcnt(0)
  s_sub_u32 s41, s41, 1
  s_cbranch_scc0 M_MP
M_MPD:
  s_setprio 1
  s_mov_b32 exec_lo, 0xfe00fe00
  s_mov_b32 exec_hi, 0xfe00fe00
  v_mov_b32 v120, 0
  v_mov_b32 v122, 0
  v_mov_b32 v124, 0
  s_mov_b64 exec, -1

  v_add_f32 v120, v120, v120 row_shr:1 row_mask:0xf bank_mask:0xf bound_ctrl:0
  v_add_f32 v122, v122, v122 row_shr:1 row_mask:0xf bank_mask:0xf bound_ctrl:0
  v_add_f32 v124, v124, v124 row_shr:1 row_mask:0xf bank_mask:0xf bound_ctrl:0
  v_add_f32 v120, v120, v120 row_shr:2 row_mask:0xf bank_mask:0xf bound_ctrl:0
  v_add_f32 v122, v122, v122 row_shr:2 row_mask:0xf bank_mask:0xf bound_ctrl:0
  v_add_f32 v124, v124, v124 row_shr:2 row_mask:0xf bank_mask:0xf bound_ctrl:0
  v_add_f32 v120, v120, v120 row_shr:4 row_mask:0xf bank_mask:0xf bound_ctrl:0
  v_add_f32 v122, v122, v122 row_shr:4 row_mask:0xf bank_mask:0xf bound_ctrl:0
  v_add_f32 v124, v124, v124 row_shr:4 row_mask:0xf bank_mask:0xf bound_ctrl:0
  v_add_f32 v120, v120, v120 row_shr:8 row_mask:0xf bank_mask:0xf bound_ctrl:0
  v_add_f32 v122, v122, v122 row_shr:8 row_mask:0xf bank_mask:0xf bound_ctrl:0
  v_add_f32 v124, v124, v124 row_shr:8 row_mask:0xf bank_mask:0xf bound_ctrl:0
  v_cvt_pk_bf16_f32 v17, v120, v122
  v_cvt_pk_bf16_f32 v18, v124, v124
  v_lshlrev_b32 v16, 16, v17
  v_and_b32 v17, 0xffff0000, v17
  v_add_f32 v17, 1.0, v17
  v_cvt_pk_bf16_f32 v17, v17, v17
  v_and_b32 v17, 0xffff0000, v17
  v_mul_f32 v19, 0x42800000, v17
  v_add_f32 v19, abs(v19), abs(v16)
  v_frexp_exp_i32_f32 v19, v19
  v_sub_u32 v19, 11, v19
  v_ldexp_f32 v17, v17, v19
  v_ldexp_f32 v16, v16, v19
  v_sub_u32 v19, 0, v19
  v_lshlrev_b32 v243, 16, v243
  v_lshlrev_b32 v18, 16, v18
  v_ldexp_f32 v243, v243, v19
  v_lshrrev_b32 v20, 2, v2
  v_and_b32 v20, 12, v20
  s_mov_b32 exec_lo, 0x80008000
  s_mov_b32 exec_hi, 0x00008000
  ds_write_b32 v20, v17 offset:0
  ds_write_b32 v20, v16 offset:16
  ds_write_b32 v248, v33 offset:276
  ds_write_b32 v20, v243 offset:32
  ds_write_b32 v20, v18 offset:48
  ds_write_b32 v20, v19 offset:64
  s_mov_b64 exec, -1

  s_mov_b64 exec, 1
  ds_add_u32 v248, v249 offset:272
  s_mov_b64 exec, -1
  s_setprio 0
  s_branch M_NI2
M_W7X:
  s_cmp_ge_u32 s2, 243
  s_cbranch_scc1 M_NI2
  v_mov_b32 v112, 0
  v_mov_b32 v113, 0
  v_mov_b32 v114, 0
  v_mov_b32 v115, 0
  v_mov_b32 v116, 0
  v_mov_b32 v117, 0
  v_mov_b32 v118, 0
  v_mov_b32 v119, 0
  s_waitcnt vmcnt(3)
  v_dot2c_f32_bf16 v112, v64, v108
  v_dot2c_f32_bf16 v113, v64, v104
  v_dot2c_f32_bf16 v114, v65, v108
  v_dot2c_f32_bf16 v115, v65, v104
  v_dot2c_f32_bf16 v116, v66, v108
  v_dot2c_f32_bf16 v117, v66, v104
  v_dot2c_f32_bf16 v118, v67, v108
  v_dot2c_f32_bf16 v119, v67, v104
  s_waitcnt vmcnt(2)
  v_dot2c_f32_bf16 v112, v68, v109
  v_dot2c_f32_bf16 v113, v68, v105
  v_dot2c_f32_bf16 v114, v69, v109
  v_dot2c_f32_bf16 v115, v69, v105
  v_dot2c_f32_bf16 v116, v70, v109
  v_dot2c_f32_bf16 v117, v70, v105
  v_dot2c_f32_bf16 v118, v71, v109
  v_dot2c_f32_bf16 v119, v71, v105
  s_waitcnt vmcnt(1)
  v_dot2c_f32_bf16 v112, v72, v110
  v_dot2c_f32_bf16 v113, v72, v106
  v_dot2c_f32_bf16 v114, v73, v110
  v_dot2c_f32_bf16 v115, v73, v106
  v_dot2c_f32_bf16 v116, v74, v110
  v_dot2c_f32_bf16 v117, v74, v106
  v_dot2c_f32_bf16 v118, v75, v110
  v_dot2c_f32_bf16 v119, v75, v106
  s_waitcnt vmcnt(0)
  v_dot2c_f32_bf16 v112, v76, v111
  v_dot2c_f32_bf16 v113, v76, v107
  v_dot2c_f32_bf16 v114, v77, v111
  v_dot2c_f32_bf16 v115, v77, v107
  v_dot2c_f32_bf16 v116, v78, v111
  v_dot2c_f32_bf16 v117, v78, v107
  v_dot2c_f32_bf16 v118, v79, v111
  v_dot2c_f32_bf16 v119, v79, v107
  s_nop 2
  v_permlane32_swap_b32 v112, v116
  v_permlane32_swap_b32 v113, v117
  v_permlane32_swap_b32 v114, v118
  v_permlane32_swap_b32 v115, v119
  v_add_f32 v112, v112, v116
  v_add_f32 v113, v113, v117
  v_add_f32 v114, v114, v118
  v_add_f32 v115, v115, v119
  s_nop 0
  v_permlane16_swap_b32 v112, v114
  v_permlane16_swap_b32 v113, v115
  v_add_f32 v112, v112, v114
  v_add_f32 v113, v113, v115
  s_nop 1
  v_add_f32 v32, v112, v112 row_ror:8 row_mask:0xf bank_mask:0x3
  v_add_f32 v32, v113, v113 row_ror:8 row_mask:0xf bank_mask:0xc
  s_nop 1
  v_add_f32 v32, v32, v32 row_shl:4 row_mask:0xf bank_mask:0x5
  s_mov_b32 exec_lo, 0x0f0f0f0f
  s_mov_b32 exec_hi, 0x0f0f0f0f
  global_store_dwordx2 v35, v[32:33], s[36:37] sc1
  s_mov_b64 exec, -1
M_NI2:
SP_6:
  ds_read_b32 v251, v248 offset:224
  s_waitcnt lgkmcnt(0)
  v_readfirstlane_b32 s94, v251
  s_cmp_ge_u32 s94, 1
  s_cbranch_scc0 SP_6

  global_load_dwordx4 v[224:227], v252, s[36:37] offset:0 sc1
  global_load_dwordx4 v[228:231], v252, s[36:37] offset:1024 sc1
  global_load_dwordx4 v[232:235], v252, s[36:37] offset:2048 sc1
  global_load_dwordx4 v[236:239], v252, s[36:37] offset:3072 sc1
  s_mov_b32 s73, 0
  s_cmp_lg_u32 s3, 6
  s_cbranch_scc1 M_CSET
  s_cmp_ge_u32 s2, 243
  s_cbranch_scc1 M_CSET
  v_mov_b32 v112, 0
  v_mov_b32 v113, 0
  v_mov_b32 v114, 0
  v_mov_b32 v115, 0
  v_mov_b32 v116, 0
  v_mov_b32 v117, 0
  v_mov_b32 v118, 0
  v_mov_b32 v119, 0
  s_waitcnt vmcnt(7)
  v_dot2c_f32_bf16 v112, v64, v108
  v_dot2c_f32_bf16 v113, v64, v104
  v_dot2c_f32_bf16 v114, v65, v108
  v_dot2c_f32_bf16 v115, v65, v104
  v_dot2c_f32_bf16 v116, v66, v108
  v_dot2c_f32_bf16 v117, v66, v104
  v_dot2c_f32_bf16 v118, v67, v108
  v_dot2c_f32_bf16 v119, v67, v104
  s_waitcnt vmcnt(6)
  v_dot2c_f32_bf16 v112, v68, v109
  v_dot2c_f32_bf16 v113, v68, v105
  v_dot2c_f32_bf16 v114, v69, v109
  v_dot2c_f32_bf16 v115, v69, v105
  v_dot2c_f32_bf16 v116, v70, v109
  v_dot2c_f32_bf16 v117, v70, v105
  v_dot2c_f32_bf16 v118, v71, v109
  v_dot2c_f32_bf16 v119, v71, v105
  s_waitcnt vmcnt(5)
  v_dot2c_f32_bf16 v112, v72, v110
  v_dot2c_f32_bf16 v113, v72, v106
  v_dot2c_f32_bf16 v114, v73, v110
  v_dot2c_f32_bf16 v115, v73, v106
  v_dot2c_f32_bf16 v116, v74, v110
  v_dot2c_f32_bf16 v117, v74, v106
  v_dot2c_f32_bf16 v118, v75, v110
  v_dot2c_f32_bf16 v119, v75, v106
  s_waitcnt vmcnt(4)
  v_dot2c_f32_bf16 v112, v76, v111
  v_dot2c_f32_bf16 v113, v76, v107
  v_dot2c_f32_bf16 v114, v77, v111
  v_dot2c_f32_bf16 v115, v77, v107
  v_dot2c_f32_bf16 v116, v78, v111
  v_dot2c_f32_bf16 v117, v78, v107
  v_dot2c_f32_bf16 v118, v79, v111
  v_dot2c_f32_bf16 v119, v79, v107
  s_nop 2
  v_permlane32_swap_b32 v112, v116
  v_permlane32_swap_b32 v113, v117
  v_permlane32_swap_b32 v114, v118
  v_permlane32_swap_b32 v115, v119
  v_add_f32 v112, v112, v116
  v_add_f32 v113, v113, v117
  v_add_f32 v114, v114, v118
  v_add_f32 v115, v115, v119
  s_nop 0
  v_permlane16_swap_b32 v112, v114
  v_permlane16_swap_b32 v113, v115
  v_add_f32 v112, v112, v114
  v_add_f32 v113, v113, v115
  s_nop 1
  v_add_f32 v32, v112, v112 row_ror:8 row_mask:0xf bank_mask:0x3
  v_add_f32 v32, v113, v113 row_ror:8 row_mask:0xf bank_mask:0xc
  s_nop 1
  v_add_f32 v32, v32, v32 row_shl:4 row_mask:0xf bank_mask:0x5
  s_mov_b32 exec_lo, 0x0f0f0f0f
  s_mov_b32 exec_hi, 0x0f0f0f0f
  global_store_dwordx2 v35, v[32:33], s[36:37] sc1
  s_mov_b64 exec, -1
  s_mov_b32 s73, 1
M_CSET:
  s_lshl_b32 s40, s3, 2
  s_lshr_b32 s40, 0x22731010, s40
  s_and_b32 s62, s40, 15
  s_and_b32 s40, s2, 3
  s_cmp_ge_u32 s62, 3
  s_cselect_b32 s40, s40, 0
  s_add_u32 s62, s62, s40

  s_cmp_ge_u32 s3, 6
  s_cbranch_scc1 M_TGS
M_PL0:
SP_7:
  ds_read_b32 v251, v1 offset:224
  s_waitcnt lgkmcnt(0)
  v_readfirstlane_b32 s94, v251
  s_cmp_ge_u32 s94, 2
  s_cbranch_scc0 SP_7

  s_cmp_eq_u32 s62, 0
  s_cbranch_scc1 M_PLA
  s_cmp_eq_u32 s62, 1
  s_cbranch_scc1 M_PLB
  s_cmp_eq_u32 s62, 2
  s_cbranch_scc1 M_PLD
  s_cmp_eq_u32 s62, 3
  s_cbranch_scc1 M_PLP0
  s_cmp_eq_u32 s62, 4
  s_cbranch_scc1 M_PLP1
  s_cmp_eq_u32 s62, 5
  s_cbranch_scc1 M_PLP2
  s_cmp_eq_u32 s62, 6
  s_cbranch_scc1 M_PLP3
  s_cmp_eq_u32 s62, 7
  s_cbranch_scc1 M_PLQ0
  s_cmp_eq_u32 s62, 8
  s_cbranch_scc1 M_PLQ1
  s_cmp_eq_u32 s62, 9
  s_cbranch_scc1 M_PLQ2
  s_branch M_PLQ3
M_PLA:
  ds_read_b64 v[92:93], v4 offset:3584
  ds_read_b64 v[94:95], v4 offset:3592
  ds_read_b64 v[124:125], v4 offset:3072
  ds_read_b64 v[126:127], v4 offset:3080
  ds_read_b64 v[156:157], v4 offset:2560
  ds_read_b64 v[158:159], v4 offset:2568
  ds_read_b64 v[188:189], v4 offset:2048
  ds_read_b64 v[190:191], v4 offset:2056
  ds_read_b64 v[88:89], v4 offset:3648
  ds_read_b64 v[90:91], v4 offset:3656
  ds_read_b64 v[120:121], v4 offset:3136
  ds_read_b64 v[122:123], v4 offset:3144
  ds_read_b64 v[152:153], v4 offset:2624
  ds_read_b64 v[154:155], v4 offset:2632
  ds_read_b64 v[184:185], v4 offset:2112
  ds_read_b64 v[186:187], v4 offset:2120
  ds_read_b64 v[84:85], v4 offset:3712
  ds_read_b64 v[86:87], v4 offset:3720
  ds_read_b64 v[116:117], v4 offset:3200
  ds_read_b64 v[118:119], v4 offset:3208
  ds_read_b64 v[148:149], v4 offset:2688
  ds_read_b64 v[150:151], v4 offset:2696
  ds_read_b64 v[180:181], v4 offset:2176
  ds_read_b64 v[182:183], v4 offset:2184
  ds_read_b64 v[80:81], v4 offset:3776
  ds_read_b64 v[82:83], v4 offset:3784
  ds_read_b64 v[112:113], v4 offset:3264
  ds_read_b64 v[114:115], v4 offset:3272
  ds_read_b64 v[144:145], v4 offset:2752
  ds_read_b64 v[146:147], v4 offset:2760
  ds_read_b64 v[176:177], v4 offset:2240
  ds_read_b64 v[178:179], v4 offset:2248
  ds_read_b64 v[76:77], v4 offset:3840
  ds_read_b64 v[78:79], v4 offset:3848
  ds_read_b64 v[108:109], v4 offset:3328
  ds_read_b64 v[110:111], v4 offset:3336
  ds_read_b64 v[140:141], v4 offset:2816
  ds_read_b64 v[142:143], v4 offset:2824
  ds_read_b64 v[172:173], v4 offset:2304
  ds_read_b64 v[174:175], v4 offset:2312
  ds_read_b64 v[72:73], v4 offset:3904
  ds_read_b64 v[74:75], v4 offset:3912
  ds_read_b64 v[104:105], v4 offset:3392
  ds_read_b64 v[106:107], v4 offset:3400
  ds_read_b64 v[136:137], v4 offset:2880
  ds_read_b64 v[138:139], v4 offset:2888
  ds_read_b64 v[168:169], v4 offset:2368
  ds_read_b64 v[170:171], v4 offset:2376
  ds_read_b64 v[68:69], v4 offset:3968
  ds_read_b64 v[70:71], v4 offset:3976
  ds_read_b64 v[100:101], v4 offset:3456
  ds_read_b64 v[102:103], v4 offset:3464
  ds_read_b64 v[132:133], v4 offset:2944
  ds_read_b64 v[134:135], v4 offset:2952
  ds_read_b64 v[164:165], v4 offset:2432
  ds_read_b64 v[166:167], v4 offset:2440
  ds_read_b64 v[64:65], v4 offset:4032
  ds_read_b64 v[66:67], v4 offset:4040
  ds_read_b64 v[96:97], v4 offset:3520
  ds_read_b64 v[98:99], v4 offset:3528
  ds_read_b64 v[128:129], v4 offset:3008
  ds_read_b64 v[130:131], v4 offset:3016
  ds_read_b64 v[160:161], v4 offset:2496
  ds_read_b64 v[162:163], v4 offset:2504
  s_branch M_STG
M_PLB:
  ds_read_b64 v[92:93], v4 offset:3584
  ds_read_b64 v[94:95], v4 offset:3592
  ds_read_b64 v[124:125], v4 offset:3072
  ds_read_b64 v[126:127], v4 offset:3080
  ds_read_b64 v[156:157], v4 offset:2560
  ds_read_b64 v[158:159], v4 offset:2568
  ds_read_b64 v[188:189], v4 offset:2048
  ds_read_b64 v[190:191], v4 offset:2056
  ds_read_b64 v[88:89], v4 offset:3648
  ds_read_b64 v[90:91], v4 offset:3656
  ds_read_b64 v[120:121], v4 offset:3136
  ds_read_b64 v[122:123], v4 offset:3144
  ds_read_b64 v[152:153], v4 offset:2624
  ds_read_b64 v[154:155], v4 offset:2632
  ds_read_b64 v[184:185], v4 offset:2112
  ds_read_b64 v[186:187], v4 offset:2120
  ds_read_b64 v[84:85], v4 offset:3712
  ds_read_b64 v[86:87], v4 offset:3720
  ds_read_b64 v[116:117], v4 offset:3200
  ds_read_b64 v[118:119], v4 offset:3208
  ds_read_b64 v[148:149], v4 offset:2688
  ds_read_b64 v[150:151], v4 offset:2696
  ds_read_b64 v[180:181], v4 offset:2176
  ds_read_b64 v[182:183], v4 offset:2184
  ds_read_b64 v[80:81], v4 offset:3776
  ds_read_b64 v[82:83], v4 offset:3784
  ds_read_b64 v[112:113], v4 offset:3264
  ds_read_b64 v[114:115], v4 offset:3272
  ds_read_b64 v[144:145], v4 offset:2752
  ds_read_b64 v[146:147], v4 offset:2760
  ds_read_b64 v[176:177], v4 offset:2240
  ds_read_b64 v[178:179], v4 offset:2248
  ds_read_b64 v[76:77], v4 offset:3840
  ds_read_b64 v[78:79], v4 offset:3848
  ds_read_b64 v[108:109], v4 offset:3328
  ds_read_b64 v[110:111], v4 offset:3336
  ds_read_b64 v[140:141], v4 offset:2816
  ds_read_b64 v[142:143], v4 offset:2824
  ds_read_b64 v[172:173], v4 offset:2304
  ds_read_b64 v[174:175], v4 offset:2312
  ds_read_b64 v[72:73], v4 offset:3904
  ds_read_b64 v[74:75], v4 offset:3912
  ds_read_b64 v[104:105], v4 offset:3392
  ds_read_b64 v[106:107], v4 offset:3400
  ds_read_b64 v[136:137], v4 offset:2880
  ds_read_b64 v[138:139], v4 offset:2888
  ds_read_b64 v[168:169], v4 offset:2368
  ds_read_b64 v[170:171], v4 offset:2376
  ds_read_b64 v[68:69], v4 offset:3968
  ds_read_b64 v[70:71], v4 offset:3976
  ds_read_b64 v[100:101], v4 offset:3456
  ds_read_b64 v[102:103], v4 offset:3464
  ds_read_b64 v[132:133], v4 offset:2944
  ds_read_b64 v[134:135], v4 offset:2952
  ds_read_b64 v[164:165], v4 offset:2432
  ds_read_b64 v[166:167], v4 offset:2440
  ds_read_b64 v[64:65], v4 offset:4032
  ds_read_b64 v[66:67], v4 offset:4040
  ds_read_b64 v[96:97], v4 offset:3520
  ds_read_b64 v[98:99], v4 offset:3528
  ds_read_b64 v[128:129], v4 offset:3008
  ds_read_b64 v[130:131], v4 offset:3016
  ds_read_b64 v[160:161], v4 offset:2496
  ds_read_b64 v[162:163], v4 offset:2504
  s_branch M_STG
M_PLD:
  ds_read_b64 v[92:93], v4 offset:3584
  ds_read_b64 v[94:95], v4 offset:3592
  ds_read_b64 v[124:125], v4 offset:3072
  ds_read_b64 v[126:127], v4 offset:3080
  ds_read_b64 v[88:89], v4 offset:3648
  ds_read_b64 v[90:91], v4 offset:3656
  ds_read_b64 v[120:121], v4 offset:3136
  ds_read_b64 v[122:123], v4 offset:3144
  ds_read_b64 v[84:85], v4 offset:3712
  ds_read_b64 v[86:87], v4 offset:3720
  ds_read_b64 v[116:117], v4 offset:3200
  ds_read_b64 v[118:119], v4 offset:3208
  ds_read_b64 v[80:81], v4 offset:3776
  ds_read_b64 v[82:83], v4 offset:3784
  ds_read_b64 v[112:113], v4 offset:3264
  ds_read_b64 v[114:115], v4 offset:3272
  ds_read_b64 v[76:77], v4 offset:3840
  ds_read_b64 v[78:79], v4 offset:3848
  ds_read_b64 v[108:109], v4 offset:3328
  ds_read_b64 v[110:111], v4 offset:3336
  ds_read_b64 v[72:73], v4 offset:3904
  ds_read_b64 v[74:75], v4 offset:3912
  ds_read_b64 v[104:105], v4 offset:3392
  ds_read_b64 v[106:107], v4 offset:3400
  ds_read_b64 v[68:69], v4 offset:3968
  ds_read_b64 v[70:71], v4 offset:3976
  ds_read_b64 v[100:101], v4 offset:3456
  ds_read_b64 v[102:103], v4 offset:3464
  ds_read_b64 v[64:65], v4 offset:4032
  ds_read_b64 v[66:67], v4 offset:4040
  ds_read_b64 v[96:97], v4 offset:3520
  ds_read_b64 v[98:99], v4 offset:3528
  v_readfirstlane_b32 s40, v4
  s_sub_u32 s40, s40, 72
  v_lshl_add_u32 v220, v2, 4, s40
  ds_read_b64 v[216:217], v4 offset:1984
  ds_read_b64 v[218:219], v4 offset:1992
  ds_read_b128 v[200:203], v220 offset:0
  ds_read_b128 v[204:207], v220 offset:4160
  ds_read_b128 v[208:211], v220 offset:8320
  ds_read_b128 v[212:215], v220 offset:12480
  s_branch M_STG
M_PLP0:
  ds_read_b64 v[92:93], v4 offset:3584
  ds_read_b64 v[94:95], v4 offset:3592
  ds_read_b64 v[124:125], v4 offset:3072
  ds_read_b64 v[126:127], v4 offset:3080
  ds_read_b64 v[156:157], v4 offset:2560
  ds_read_b64 v[158:159], v4 offset:2568
  ds_read_b64 v[188:189], v4 offset:2048
  ds_read_b64 v[190:191], v4 offset:2056
  ds_read_b64 v[88:89], v4 offset:3648
  ds_read_b64 v[90:91], v4 offset:3656
  ds_read_b64 v[120:121], v4 offset:3136
  ds_read_b64 v[122:123], v4 offset:3144
  ds_read_b64 v[152:153], v4 offset:2624
  ds_read_b64 v[154:155], v4 offset:2632
  ds_read_b64 v[184:185], v4 offset:2112
  ds_read_b64 v[186:187], v4 offset:2120
  ds_read_b64 v[84:85], v4 offset:3712
  ds_read_b64 v[86:87], v4 offset:3720
  ds_read_b64 v[116:117], v4 offset:3200
  ds_read_b64 v[118:119], v4 offset:3208
  ds_read_b64 v[148:149], v4 offset:2688
  ds_read_b64 v[150:151], v4 offset:2696
  ds_read_b64 v[180:181], v4 offset:2176
  ds_read_b64 v[182:183], v4 offset:2184
  s_branch M_STG
M_PLP1:
  ds_read_b64 v[92:93], v4 offset:3584
  ds_read_b64 v[94:95], v4 offset:3592
  ds_read_b64 v[124:125], v4 offset:3072
  ds_read_b64 v[126:127], v4 offset:3080
  ds_read_b64 v[156:157], v4 offset:2560
  ds_read_b64 v[158:159], v4 offset:2568
  ds_read_b64 v[188:189], v4 offset:2048
  ds_read_b64 v[190:191], v4 offset:2056
  ds_read_b64 v[88:89], v4 offset:3648
  ds_read_b64 v[90:91], v4 offset:3656
  ds_read_b64 v[120:121], v4 offset:3136
  ds_read_b64 v[122:123], v4 offset:3144
  ds_read_b64 v[152:153], v4 offset:2624
  ds_read_b64 v[154:155], v4 offset:2632
  ds_read_b64 v[184:185], v4 offset:2112
  ds_read_b64 v[186:187], v4 offset:2120
  ds_read_b64 v[84:85], v4 offset:3712
  ds_read_b64 v[86:87], v4 offset:3720
  ds_read_b64 v[116:117], v4 offset:3200
  ds_read_b64 v[118:119], v4 offset:3208
  ds_read_b64 v[148:149], v4 offset:2688
  ds_read_b64 v[150:151], v4 offset:2696
  ds_read_b64 v[180:181], v4 offset:2176
  ds_read_b64 v[182:183], v4 offset:2184
  s_branch M_STG
M_PLP2:
  ds_read_b64 v[92:93], v4 offset:3584
  ds_read_b64 v[94:95], v4 offset:3592
  ds_read_b64 v[124:125], v4 offset:3072
  ds_read_b64 v[126:127], v4 offset:3080
  ds_read_b64 v[156:157], v4 offset:2560
  ds_read_b64 v[158:159], v4 offset:2568
  ds_read_b64 v[188:189], v4 offset:2048
  ds_read_b64 v[190:191], v4 offset:2056
  ds_read_b64 v[88:89], v4 offset:3648
  ds_read_b64 v[90:91], v4 offset:3656
  ds_read_b64 v[120:121], v4 offset:3136
  ds_read_b64 v[122:123], v4 offset:3144
  ds_read_b64 v[152:153], v4 offset:2624
  ds_read_b64 v[154:155], v4 offset:2632
  ds_read_b64 v[184:185], v4 offset:2112
  ds_read_b64 v[186:187], v4 offset:2120
  ds_read_b64 v[84:85], v4 offset:3712
  ds_read_b64 v[86:87], v4 offset:3720
  ds_read_b64 v[116:117], v4 offset:3200
  ds_read_b64 v[118:119], v4 offset:3208
  ds_read_b64 v[148:149], v4 offset:2688
  ds_read_b64 v[150:151], v4 offset:2696
  ds_read_b64 v[180:181], v4 offset:2176
  ds_read_b64 v[182:183], v4 offset:2184
  s_branch M_STG
M_PLP3:
  ds_read_b64 v[92:93], v4 offset:3584
  ds_read_b64 v[94:95], v4 offset:3592
  ds_read_b64 v[124:125], v4 offset:3072
  ds_read_b64 v[126:127], v4 offset:3080
  ds_read_b64 v[156:157], v4 offset:2560
  ds_read_b64 v[158:159], v4 offset:2568
  ds_read_b64 v[188:189], v4 offset:2048
  ds_read_b64 v[190:191], v4 offset:2056
  ds_read_b64 v[88:89], v4 offset:3648
  ds_read_b64 v[90:91], v4 offset:3656
  ds_read_b64 v[120:121], v4 offset:3136
  ds_read_b64 v[122:123], v4 offset:3144
  ds_read_b64 v[152:153], v4 offset:2624
  ds_read_b64 v[154:155], v4 offset:2632
  ds_read_b64 v[184:185], v4 offset:2112
  ds_read_b64 v[186:187], v4 offset:2120
  ds_read_b64 v[84:85], v4 offset:3712
  ds_read_b64 v[86:87], v4 offset:3720
  ds_read_b64 v[116:117], v4 offset:3200
  ds_read_b64 v[118:119], v4 offset:3208
  ds_read_b64 v[148:149], v4 offset:2688
  ds_read_b64 v[150:151], v4 offset:2696
  ds_read_b64 v[180:181], v4 offset:2176
  ds_read_b64 v[182:183], v4 offset:2184
  s_branch M_STG
M_PLQ0:
  ds_read_b64 v[92:93], v4 offset:3584
  ds_read_b64 v[94:95], v4 offset:3592
  ds_read_b64 v[88:89], v4 offset:3648
  ds_read_b64 v[90:91], v4 offset:3656
  ds_read_b64 v[84:85], v4 offset:3712
  ds_read_b64 v[86:87], v4 offset:3720
  v_readfirstlane_b32 s40, v4
  s_sub_u32 s40, s40, 72
  v_lshl_add_u32 v220, v2, 4, s40
  ds_read_b64 v[216:217], v4 offset:1984
  ds_read_b64 v[218:219], v4 offset:1992
  ds_read_b128 v[200:203], v220 offset:0
  ds_read_b128 v[204:207], v220 offset:4160
  ds_read_b128 v[208:211], v220 offset:8320
  ds_read_b128 v[212:215], v220 offset:12480
  s_branch M_STG
M_PLQ1:
  ds_read_b64 v[92:93], v4 offset:3584
  ds_read_b64 v[94:95], v4 offset:3592
  ds_read_b64 v[124:125], v4 offset:3072
  ds_read_b64 v[126:127], v4 offset:3080
  ds_read_b64 v[88:89], v4 offset:3648
  ds_read_b64 v[90:91], v4 offset:3656
  ds_read_b64 v[120:121], v4 offset:3136
  ds_read_b64 v[122:123], v4 offset:3144
  ds_read_b64 v[84:85], v4 offset:3712
  ds_read_b64 v[86:87], v4 offset:3720
  ds_read_b64 v[116:117], v4 offset:3200
  ds_read_b64 v[118:119], v4 offset:3208
  v_readfirstlane_b32 s40, v4
  s_sub_u32 s40, s40, 72
  v_lshl_add_u32 v220, v2, 4, s40
  ds_read_b64 v[216:217], v4 offset:1984
  ds_read_b64 v[218:219], v4 offset:1992
  ds_read_b128 v[200:203], v220 offset:0
  ds_read_b128 v[204:207], v220 offset:4160
  ds_read_b128 v[208:211], v220 offset:8320
  s_branch M_STG
M_PLQ2:
  ds_read_b64 v[92:93], v4 offset:3584
  ds_read_b64 v[94:95], v4 offset:3592
  ds_read_b64 v[124:125], v4 offset:3072
  ds_read_b64 v[126:127], v4 offset:3080
  ds_read_b64 v[156:157], v4 offset:2560
  ds_read_b64 v[158:159], v4 offset:2568
  ds_read_b64 v[88:89], v4 offset:3648
  ds_read_b64 v[90:91], v4 offset:3656
  ds_read_b64 v[120:121], v4 offset:3136
  ds_read_b64 v[122:123], v4 offset:3144
  ds_read_b64 v[152:153], v4 offset:2624
  ds_read_b64 v[154:155], v4 offset:2632
  ds_read_b64 v[84:85], v4 offset:3712
  ds_read_b64 v[86:87], v4 offset:3720
  ds_read_b64 v[116:117], v4 offset:3200
  ds_read_b64 v[118:119], v4 offset:3208
  ds_read_b64 v[148:149], v4 offset:2688
  ds_read_b64 v[150:151], v4 offset:2696
  v_readfirstlane_b32 s40, v4
  s_sub_u32 s40, s40, 72
  v_lshl_add_u32 v220, v2, 4, s40
  ds_read_b64 v[216:217], v4 offset:1984
  ds_read_b64 v[218:219], v4 offset:1992
  ds_read_b128 v[200:203], v220 offset:0
  ds_read_b128 v[204:207], v220 offset:4160
  s_branch M_STG
M_PLQ3:
  ds_read_b64 v[92:93], v4 offset:3584
  ds_read_b64 v[94:95], v4 offset:3592
  ds_read_b64 v[124:125], v4 offset:3072
  ds_read_b64 v[126:127], v4 offset:3080
  ds_read_b64 v[156:157], v4 offset:2560
  ds_read_b64 v[158:159], v4 offset:2568
  ds_read_b64 v[188:189], v4 offset:2048
  ds_read_b64 v[190:191], v4 offset:2056
  ds_read_b64 v[88:89], v4 offset:3648
  ds_read_b64 v[90:91], v4 offset:3656
  ds_read_b64 v[120:121], v4 offset:3136
  ds_read_b64 v[122:123], v4 offset:3144
  ds_read_b64 v[152:153], v4 offset:2624
  ds_read_b64 v[154:155], v4 offset:2632
  ds_read_b64 v[184:185], v4 offset:2112
  ds_read_b64 v[186:187], v4 offset:2120
  ds_read_b64 v[84:85], v4 offset:3712
  ds_read_b64 v[86:87], v4 offset:3720
  ds_read_b64 v[116:117], v4 offset:3200
  ds_read_b64 v[118:119], v4 offset:3208
  ds_read_b64 v[148:149], v4 offset:2688
  ds_read_b64 v[150:151], v4 offset:2696
  ds_read_b64 v[180:181], v4 offset:2176
  ds_read_b64 v[182:183], v4 offset:2184
  v_readfirstlane_b32 s40, v4
  s_sub_u32 s40, s40, 72
  v_lshl_add_u32 v220, v2, 4, s40
  ds_read_b64 v[216:217], v4 offset:1984
  ds_read_b64 v[218:219], v4 offset:1992
  ds_read_b128 v[200:203], v220 offset:0
  s_branch M_STG
M_STG:
  s_cmp_ge_u32 s3, 4
  s_cbranch_scc1 M_HW
  s_cmp_ge_u32 s3, 2
  s_cbranch_scc1 M_U3

M_TGS:
  s_setprio 1
  ds_read_b64 v[16:17], v248 offset:272
  ds_read_b128 v[48:51], v248 offset:0
  ds_read_b128 v[52:55], v248 offset:16
  s_lshl_b32 s40, s63, 8
  s_add_u32 s40, s40, 55648
  s_mov_b32 m0, s40
  s_mov_b32 s41, 65536
  v_mov_b32 v62, 0x3f80
  v_mov_b32 v63, 0x3f800000
  s_waitcnt lgkmcnt(0)
  v_readfirstlane_b32 s94, v16
  v_readfirstlane_b32 s38, v17
  v_readfirstlane_b32 s66, v48
  v_readfirstlane_b32 s69, v50
  v_readfirstlane_b32 s67, v49
  v_readfirstlane_b32 s70, v52
  v_readfirstlane_b32 s71, v53
  v_readfirstlane_b32 s72, v54
  s_lshr_b32 s66, s66, 16
  s_lshr_b32 s68, s69, 16
  s_cmp_ge_u32 s94, 1
  s_cbranch_scc0 M_TGS
  s_waitcnt vmcnt(1)
  s_cmp_eq_u32 s73, 1
  s_cbranch_scc1 M_XP1
M_XP:
  s_waitcnt vmcnt(0)
M_XP1:
  v_xor_b32 v16, s38, v227
  v_xor_b32 v17, s38, v231
  v_xor_b32 v18, s38, v235
  v_xor_b32 v19, s38, v239
  v_or_b32 v18, v18, v19

  v_or3_b32 v16, v16, v17, v18
  v_cmp_ne_u32 vcc, 0, v16
  s_cbranch_vccz M_XD
  s_mov_b64 exec, vcc

  global_load_dwordx4 v[224:227], v252, s[36:37] offset:0 sc1
  global_load_dwordx4 v[228:231], v252, s[36:37] offset:1024 sc1
  global_load_dwordx4 v[232:235], v252, s[36:37] offset:2048 sc1
  global_load_dwordx4 v[236:239], v252, s[36:37] offset:3072 sc1
  s_mov_b64 exec, -1
  s_sub_u32 s41, s41, 1
  s_cbranch_scc0 M_XP
M_XD:

  v_dot2_f32_bf16 v32, v224, s66, 0
  v_dot2_f32_bf16 v33, v225, s66, 0
  v_dot2_f32_bf16 v34, v224, s67, 0
  v_dot2_f32_bf16 v35, v225, s67, 0
  v_dot2_f32_bf16 v36, v226, s68, 0
  v_dot2_f32_bf16 v37, v226, s69, 0
  v_dot2_f32_bf16 v38, v228, s66, 0
  v_dot2_f32_bf16 v39, v229, s66, 0
  v_dot2_f32_bf16 v40, v228, s67, 0
  v_dot2_f32_bf16 v41, v229, s67, 0
  v_dot2_f32_bf16 v42, v230, s68, 0
  v_dot2_f32_bf16 v43, v230, s69, 0
  v_cvt_pk_bf16_f32 v33, v32, v33
  v_cvt_pk_bf16_f32 v35, v34, v35
  v_cvt_pk_bf16_f32 v37, v36, v37
  v_cvt_pk_bf16_f32 v39, v38, v39
  v_cvt_pk_bf16_f32 v41, v40, v41
  v_cvt_pk_bf16_f32 v43, v42, v43
  v_dot2_f32_bf16 v32, v33, v62, s70
  v_dot2_f32_bf16 v33, v33, v63, s70
  v_dot2_f32_bf16 v34, v35, v62, s71
  v_dot2_f32_bf16 v35, v35, v63, s71
  v_dot2_f32_bf16 v36, v37, v62, s72
  v_dot2_f32_bf16 v37, v37, v63, s72
  v_dot2_f32_bf16 v38, v39, v62, s70
  v_dot2_f32_bf16 v39, v39, v63, s70
  v_dot2_f32_bf16 v40, v41, v62, s71
  v_dot2_f32_bf16 v41, v41, v63, s71
  v_dot2_f32_bf16 v42, v43, v62, s72
  v_dot2_f32_bf16 v43, v43, v63, s72
  s_nop 1
  v_cvt_pk_bf16_f32 v33, v32, v33
  v_cvt_pk_bf16_f32 v35, v34, v35
  v_cvt_pk_bf16_f32 v37, v36, v37
  v_cvt_pk_bf16_f32 v39, v38, v39
  v_cvt_pk_bf16_f32 v41, v40, v41
  v_cvt_pk_bf16_f32 v43, v42, v43
  v_lshlrev_b32 v32, 16, v33
  v_and_b32 v33, 0xffff0000, v33
  v_lshlrev_b32 v34, 16, v35
  v_and_b32 v35, 0xffff0000, v35
  v_lshlrev_b32 v36, 16, v37
  v_and_b32 v37, 0xffff0000, v37
  v_lshlrev_b32 v38, 16, v39
  v_and_b32 v39, 0xffff0000, v39
  v_lshlrev_b32 v40, 16, v41
  v_and_b32 v41, 0xffff0000, v41
  v_lshlrev_b32 v42, 16, v43
  v_and_b32 v43, 0xffff0000, v43
  v_cvt_pk_f16_f32 v16, v32, v33
  v_cvt_pk_f16_f32 v17, v34, v35
  v_cvt_pk_f16_f32 v18, v36, v37
  v_cvt_pk_f16_f32 v19, v38, v39
  v_cvt_pk_f16_f32 v20, v40, v41
  v_cvt_pk_f16_f32 v21, v42, v43
  ds_write_addtid_b32 v16 offset:0
  ds_write_addtid_b32 v17 offset:4608
  ds_write_addtid_b32 v18 offset:9216
  ds_write_addtid_b32 v19 offset:256
  ds_write_addtid_b32 v20 offset:4864
  ds_write_addtid_b32 v21 offset:9472
  v_dot2_f32_bf16 v32, v232, s66, 0
  v_dot2_f32_bf16 v33, v233, s66, 0
  v_dot2_f32_bf16 v34, v232, s67, 0
  v_dot2_f32_bf16 v35, v233, s67, 0
  v_dot2_f32_bf16 v36, v234, s68, 0
  v_dot2_f32_bf16 v37, v234, s69, 0
  v_dot2_f32_bf16 v38, v236, s66, 0
  v_dot2_f32_bf16 v39, v237, s66, 0
  v_dot2_f32_bf16 v40, v236, s67, 0
  v_dot2_f32_bf16 v41, v237, s67, 0
  v_dot2_f32_bf16 v42, v238, s68, 0
  v_dot2_f32_bf16 v43, v238, s69, 0
  v_cvt_pk_bf16_f32 v33, v32, v33
  v_cvt_pk_bf16_f32 v35, v34, v35
  v_cvt_pk_bf16_f32 v37, v36, v37
  v_cvt_pk_bf16_f32 v39, v38, v39
  v_cvt_pk_bf16_f32 v41, v40, v41
  v_cvt_pk_bf16_f32 v43, v42, v43
  v_dot2_f32_bf16 v32, v33, v62, s70
  v_dot2_f32_bf16 v33, v33, v63, s70
  v_dot2_f32_bf16 v34, v35, v62, s71
  v_dot2_f32_bf16 v35, v35, v63, s71
  v_dot2_f32_bf16 v36, v37, v62, s72
  v_dot2_f32_bf16 v37, v37, v63, s72
  v_dot2_f32_bf16 v38, v39, v62, s70
  v_dot2_f32_bf16 v39, v39, v63, s70
  v_dot2_f32_bf16 v40, v41, v62, s71
  v_dot2_f32_bf16 v41, v41, v63, s71
  v_dot2_f32_bf16 v42, v43, v62, s72
  v_dot2_f32_bf16 v43, v43, v63, s72
  s_nop 1
  v_cvt_pk_bf16_f32 v33, v32, v33
  v_cvt_pk_bf16_f32 v35, v34, v35
  v_cvt_pk_bf16_f32 v37, v36, v37
  v_cvt_pk_bf16_f32 v39, v38, v39
  v_cvt_pk_bf16_f32 v41, v40, v41
  v_cvt_pk_bf16_f32 v43, v42, v43
  v_lshlrev_b32 v32, 16, v33
  v_and_b32 v33, 0xffff0000, v33
  v_lshlrev_b32 v34, 16, v35
  v_and_b32 v35, 0xffff0000, v35
  v_lshlrev_b32 v36, 16, v37
  v_and_b32 v37, 0xffff0000, v37
  v_lshlrev_b32 v38, 16, v39
  v_and_b32 v39, 0xffff0000, v39
  v_lshlrev_b32 v40, 16, v41
  v_and_b32 v41, 0xffff0000, v41
  v_lshlrev_b32 v42, 16, v43
  v_and_b32 v43, 0xffff0000, v43
  v_cvt_pk_f16_f32 v56, v32, v33
  v_cvt_pk_f16_f32 v57, v34, v35
  v_cvt_pk_f16_f32 v58, v36, v37
  v_cvt_pk_f16_f32 v59, v38, v39
  v_cvt_pk_f16_f32 v60, v40, v41
  v_cvt_pk_f16_f32 v61, v42, v43
  ds_write_addtid_b32 v56 offset:512
  ds_write_addtid_b32 v57 offset:5120
  ds_write_addtid_b32 v58 offset:9728
  ds_write_addtid_b32 v59 offset:768
  ds_write_addtid_b32 v60 offset:5376
  ds_write_addtid_b32 v61 offset:9984
M_U3:
  s_mov_b64 exec, 1
  ds_add_u32 v248, v249 offset:240
  s_mov_b64 exec, -1
  s_setprio 0
  s_cmp_ge_u32 s3, 6
  s_cbranch_scc1 M_PL0
M_HW:
  s_and_b32 s40, s2, 7
  s_mul_i32 s40, s40, 18
  s_lshr_b32 s41, s2, 3
  s_add_u32 s46, s40, s41

  s_cmp_lt_u32 s3, 4
  s_cselect_b32 s47, 144, 0
  s_lshr_b32 s40, 0x8c, s3
  s_bitcmp1_b32 s40, 0
  s_cselect_b32 s78, s24, s22
  s_cselect_b32 s79, s25, s23

  s_cmp_lt_u32 s3, 4
  s_cbranch_scc1 M_NP4
  s_setprio 1
M_NP4:
  s_cmp_eq_u32 s62, 0
  s_cbranch_scc1 M_RUNA
  s_cmp_eq_u32 s62, 1
  s_cbranch_scc1 M_RUNB
  s_cmp_eq_u32 s62, 2
  s_cbranch_scc1 M_RUND
  s_cmp_eq_u32 s62, 3
  s_cbranch_scc1 M_RUNP0
  s_cmp_eq_u32 s62, 4
  s_cbranch_scc1 M_RUNP1
  s_cmp_eq_u32 s62, 5
  s_cbranch_scc1 M_RUNP2
  s_cmp_eq_u32 s62, 6
  s_cbranch_scc1 M_RUNP3
  s_cmp_eq_u32 s62, 7
  s_cbranch_scc1 M_RUNQ0
  s_cmp_eq_u32 s62, 8
  s_cbranch_scc1 M_RUNQ1
  s_cmp_eq_u32 s62, 9
  s_cbranch_scc1 M_RUNQ2
  s_branch M_RUNQ3
M_RUNA:
M_HSA:
  ds_read_b32 v251, v248 offset:240
  ds_read_b32 v15, v248 offset:196
  s_waitcnt lgkmcnt(0)
  v_readfirstlane_b32 s94, v251
  v_readfirstlane_b32 s38, v15
  s_cmp_ge_u32 s94, 8
  s_cbranch_scc0 M_HSA

  ds_read_b128 v[32:35], v6 offset:1536
  ds_read_b128 v[36:39], v6 offset:1600
  ds_read_b128 v[40:43], v6 offset:1664
  s_waitcnt lgkmcnt(2)
  v_mfma_f32_16x16x32_f16 v[224:227], v[92:95], v[32:35], 0
  v_mfma_f32_16x16x32_f16 v[228:231], v[124:127], v[32:35], 0
  ds_read_b128 v[44:47], v6 offset:1728
  v_mfma_f32_16x16x32_f16 v[232:235], v[156:159], v[32:35], 0
  s_lshr_b32 s64, s2, 3
  s_mul_i32 s64, s64, 162
  v_mfma_f32_16x16x32_f16 v[236:239], v[188:191], v[32:35], 0
  s_add_u32 s64, s64, 0
  s_and_b32 s65, s2, 7
  s_waitcnt lgkmcnt(2)
  v_mfma_f32_16x16x32_f16 v[224:227], v[88:91], v[36:39], v[224:227]
  s_mul_i32 s65, s65, 9
  v_min_u32 v252, 53, v2
  v_mfma_f32_16x16x32_f16 v[228:231], v[120:123], v[36:39], v[228:231]
  v_add_u32 v252, s64, v252
  v_mul_u32_u24 v254, 7282, v252
  ds_read_b128 v[48:51], v6 offset:1792
  v_mfma_f32_16x16x32_f16 v[232:235], v[152:155], v[36:39], v[232:235]
  v_lshrrev_b32 v254, 16, v254
  v_mul_u32_u24 v253, 9, v254
  v_mfma_f32_16x16x32_f16 v[236:239], v[184:187], v[36:39], v[236:239]
  v_sub_u32 v253, v252, v253
  v_add_u32 v253, s65, v253
  s_waitcnt lgkmcnt(2)
  v_mfma_f32_16x16x32_f16 v[224:227], v[84:87], v[40:43], v[224:227]
  v_mul_u32_u24 v254, 9216, v254
  v_lshl_add_u32 v254, v253, 7, v254
  v_mfma_f32_16x16x32_f16 v[228:231], v[116:119], v[40:43], v[228:231]
  global_load_dword v250, v254, s[78:79]
  ds_read_b128 v[52:55], v6 offset:1856
  v_mfma_f32_16x16x32_f16 v[232:235], v[148:151], v[40:43], v[232:235]
  v_mfma_f32_16x16x32_f16 v[236:239], v[180:183], v[40:43], v[236:239]
  s_waitcnt lgkmcnt(2)
  v_mfma_f32_16x16x32_f16 v[224:227], v[80:83], v[44:47], v[224:227]
  v_mfma_f32_16x16x32_f16 v[228:231], v[112:115], v[44:47], v[228:231]
  ds_read_b128 v[56:59], v6 offset:1920
  v_mfma_f32_16x16x32_f16 v[232:235], v[144:147], v[44:47], v[232:235]
  v_mfma_f32_16x16x32_f16 v[236:239], v[176:179], v[44:47], v[236:239]
  s_waitcnt lgkmcnt(2)
  v_mfma_f32_16x16x32_f16 v[224:227], v[76:79], v[48:51], v[224:227]
  v_mfma_f32_16x16x32_f16 v[228:231], v[108:111], v[48:51], v[228:231]
  ds_read_b128 v[60:63], v6 offset:1984
  v_mfma_f32_16x16x32_f16 v[232:235], v[140:143], v[48:51], v[232:235]
  v_mfma_f32_16x16x32_f16 v[236:239], v[172:175], v[48:51], v[236:239]
  s_waitcnt lgkmcnt(2)
  v_mfma_f32_16x16x32_f16 v[224:227], v[72:75], v[52:55], v[224:227]
  v_mfma_f32_16x16x32_f16 v[228:231], v[104:107], v[52:55], v[228:231]
  ds_read_b128 v[32:35], v6 offset:2048
  v_mfma_f32_16x16x32_f16 v[232:235], v[136:139], v[52:55], v[232:235]
  v_mfma_f32_16x16x32_f16 v[236:239], v[168:171], v[52:55], v[236:239]
  s_waitcnt lgkmcnt(2)
  v_mfma_f32_16x16x32_f16 v[224:227], v[68:71], v[56:59], v[224:227]
  v_mfma_f32_16x16x32_f16 v[228:231], v[100:103], v[56:59], v[228:231]
  ds_read_b128 v[36:39], v6 offset:2112
  v_mfma_f32_16x16x32_f16 v[232:235], v[132:135], v[56:59], v[232:235]
  v_mfma_f32_16x16x32_f16 v[236:239], v[164:167], v[56:59], v[236:239]
  s_waitcnt lgkmcnt(2)
  v_mfma_f32_16x16x32_f16 v[224:227], v[64:67], v[60:63], v[224:227]
  v_mfma_f32_16x16x32_f16 v[228:231], v[96:99], v[60:63], v[228:231]
  ds_read_b128 v[40:43], v6 offset:2176
  v_mfma_f32_16x16x32_f16 v[232:235], v[128:131], v[60:63], v[232:235]
  v_mfma_f32_16x16x32_f16 v[236:239], v[160:163], v[60:63], v[236:239]
  s_waitcnt lgkmcnt(2)
  v_mfma_f32_16x16x32_f16 v[228:231], v[92:95], v[32:35], v[228:231]
  v_mfma_f32_16x16x32_f16 v[232:235], v[124:127], v[32:35], v[232:235]
  ds_read_b128 v[44:47], v6 offset:2240
  v_mfma_f32_16x16x32_f16 v[236:239], v[156:159], v[32:35], v[236:239]
  v_mfma_f32_16x16x32_f16 v[240:243], v[188:191], v[32:35], 0
  s_waitcnt lgkmcnt(2)
  v_mfma_f32_16x16x32_f16 v[228:231], v[88:91], v[36:39], v[228:231]
  v_mfma_f32_16x16x32_f16 v[232:235], v[120:123], v[36:39], v[232:235]
  ds_write_b128 v8, v[224:227] offset:6144
  ds_read_b128 v[48:51], v6 offset:2304
  v_mfma_f32_16x16x32_f16 v[236:239], v[152:155], v[36:39], v[236:239]
  v_mfma_f32_16x16x32_f16 v[240:243], v[184:187], v[36:39], v[240:243]
  s_waitcnt lgkmcnt(3)
  v_mfma_f32_16x16x32_f16 v[228:231], v[84:87], v[40:43], v[228:231]
  v_mfma_f32_16x16x32_f16 v[232:235], v[116:119], v[40:43], v[232:235]
  ds_read_b128 v[52:55], v6 offset:2368
  v_mfma_f32_16x16x32_f16 v[236:239], v[148:151], v[40:43], v[236:239]
  v_mfma_f32_16x16x32_f16 v[240:243], v[180:183], v[40:43], v[240:243]
  s_waitcnt lgkmcnt(3)
  v_mfma_f32_16x16x32_f16 v[228:231], v[80:83], v[44:47], v[228:231]
  v_mfma_f32_16x16x32_f16 v[232:235], v[112:115], v[44:47], v[232:235]
  ds_read_b128 v[56:59], v6 offset:2432
  v_mfma_f32_16x16x32_f16 v[236:239], v[144:147], v[44:47], v[236:239]
  v_mfma_f32_16x16x32_f16 v[240:243], v[176:179], v[44:47], v[240:243]
  s_waitcnt lgkmcnt(2)
  v_mfma_f32_16x16x32_f16 v[228:231], v[76:79], v[48:51], v[228:231]
  v_mfma_f32_16x16x32_f16 v[232:235], v[108:111], v[48:51], v[232:235]
  ds_read_b128 v[60:63], v6 offset:2496
  v_mfma_f32_16x16x32_f16 v[236:239], v[140:143], v[48:51], v[236:239]
  v_mfma_f32_16x16x32_f16 v[240:243], v[172:175], v[48:51], v[240:243]
  s_waitcnt lgkmcnt(2)
  v_mfma_f32_16x16x32_f16 v[228:231], v[72:75], v[52:55], v[228:231]
  v_mfma_f32_16x16x32_f16 v[232:235], v[104:107], v[52:55], v[232:235]
  ds_read_b128 v[32:35], v6 offset:2560
  v_mfma_f32_16x16x32_f16 v[236:239], v[136:139], v[52:55], v[236:239]
  v_mfma_f32_16x16x32_f16 v[240:243], v[168:171], v[52:55], v[240:243]
  s_waitcnt lgkmcnt(2)
  v_mfma_f32_16x16x32_f16 v[228:231], v[68:71], v[56:59], v[228:231]
  ds_read_b128 v[36:39], v6 offset:2624
  v_mfma_f32_16x16x32_f16 v[232:235], v[100:103], v[56:59], v[232:235]
  v_mfma_f32_16x16x32_f16 v[236:239], v[132:135], v[56:59], v[236:239]
  v_mfma_f32_16x16x32_f16 v[240:243], v[164:167], v[56:59], v[240:243]
  ds_read_b128 v[40:43], v6 offset:2688
  s_waitcnt lgkmcnt(3)
  v_mfma_f32_16x16x32_f16 v[228:231], v[64:67], v[60:63], v[228:231]
  v_mfma_f32_16x16x32_f16 v[232:235], v[96:99], v[60:63], v[232:235]
  v_mfma_f32_16x16x32_f16 v[236:239], v[128:131], v[60:63], v[236:239]
  ds_read_b128 v[44:47], v6 offset:2752
  v_mfma_f32_16x16x32_f16 v[240:243], v[160:163], v[60:63], v[240:243]
  s_waitcnt lgkmcnt(3)
  v_mfma_f32_16x16x32_f16 v[232:235], v[92:95], v[32:35], v[232:235]
  v_mfma_f32_16x16x32_f16 v[236:239], v[124:127], v[32:35], v[236:239]
  ds_read_b128 v[48:51], v6 offset:2816
  v_mfma_f32_16x16x32_f16 v[240:243], v[156:159], v[32:35], v[240:243]
  s_waitcnt lgkmcnt(3)
  v_mfma_f32_16x16x32_f16 v[232:235], v[88:91], v[36:39], v[232:235]
  v_mfma_f32_16x16x32_f16 v[236:239], v[120:123], v[36:39], v[236:239]
  ds_read_b128 v[52:55], v6 offset:2880
  v_mfma_f32_16x16x32_f16 v[240:243], v[152:155], v[36:39], v[240:243]
  ds_write_b128 v8, v[228:231] offset:7168
  s_waitcnt lgkmcnt(4)
  v_mfma_f32_16x16x32_f16 v[232:235], v[84:87], v[40:43], v[232:235]
  v_mfma_f32_16x16x32_f16 v[236:239], v[116:119], v[40:43], v[236:239]
  ds_read_b128 v[56:59], v6 offset:2944
  v_mfma_f32_16x16x32_f16 v[240:243], v[148:151], v[40:43], v[240:243]
  s_waitcnt lgkmcnt(4)
  v_mfma_f32_16x16x32_f16 v[232:235], v[80:83], v[44:47], v[232:235]
  v_mfma_f32_16x16x32_f16 v[236:239], v[112:115], v[44:47], v[236:239]
  ds_read_b128 v[60:63], v6 offset:3008
  v_mfma_f32_16x16x32_f16 v[240:243], v[144:147], v[44:47], v[240:243]
  s_waitcnt lgkmcnt(4)
  v_mfma_f32_16x16x32_f16 v[232:235], v[76:79], v[48:51], v[232:235]
  v_mfma_f32_16x16x32_f16 v[236:239], v[108:111], v[48:51], v[236:239]
  ds_read_b128 v[32:35], v6 offset:3072
  v_mfma_f32_16x16x32_f16 v[240:243], v[140:143], v[48:51], v[240:243]
  ds_read_b128 v[36:39], v6 offset:3136
  s_waitcnt lgkmcnt(5)
  v_mfma_f32_16x16x32_f16 v[232:235], v[72:75], v[52:55], v[232:235]
  ds_read_b128 v[40:43], v6 offset:3200
  v_mfma_f32_16x16x32_f16 v[236:239], v[104:107], v[52:55], v[236:239]
  ds_read_b128 v[44:47], v6 offset:3264
  v_mfma_f32_16x16x32_f16 v[240:243], v[136:139], v[52:55], v[240:243]
  ds_read_b128 v[48:51], v6 offset:3328
  s_waitcnt lgkmcnt(6)
  v_mfma_f32_16x16x32_f16 v[232:235], v[68:71], v[56:59], v[232:235]
  ds_read_b128 v[52:55], v6 offset:3392
  v_mfma_f32_16x16x32_f16 v[236:239], v[100:103], v[56:59], v[236:239]
  v_mfma_f32_16x16x32_f16 v[240:243], v[132:135], v[56:59], v[240:243]
  ds_read_b128 v[56:59], v6 offset:3456
  s_waitcnt lgkmcnt(7)
  v_mfma_f32_16x16x32_f16 v[232:235], v[64:67], v[60:63], v[232:235]
  v_mfma_f32_16x16x32_f16 v[236:239], v[96:99], v[60:63], v[236:239]
  v_mfma_f32_16x16x32_f16 v[240:243], v[128:131], v[60:63], v[240:243]
  ds_read_b128 v[60:63], v6 offset:3520
  s_waitcnt lgkmcnt(7)
  v_mfma_f32_16x16x32_f16 v[236:239], v[92:95], v[32:35], v[236:239]
  s_waitcnt lgkmcnt(6)
  v_mfma_f32_16x16x32_f16 v[236:239], v[88:91], v[36:39], v[236:239]
  s_waitcnt lgkmcnt(5)
  v_mfma_f32_16x16x32_f16 v[236:239], v[84:87], v[40:43], v[236:239]
  s_waitcnt lgkmcnt(4)
  v_mfma_f32_16x16x32_f16 v[236:239], v[80:83], v[44:47], v[236:239]
  s_waitcnt lgkmcnt(3)
  v_mfma_f32_16x16x32_f16 v[236:239], v[76:79], v[48:51], v[236:239]
  s_waitcnt lgkmcnt(2)
  v_mfma_f32_16x16x32_f16 v[236:239], v[72:75], v[52:55], v[236:239]
  s_waitcnt lgkmcnt(1)
  v_mfma_f32_16x16x32_f16 v[236:239], v[68:71], v[56:59], v[236:239]
  ds_write_b128 v8, v[232:235] offset:8192
  s_waitcnt lgkmcnt(1)
  v_mfma_f32_16x16x32_f16 v[236:239], v[64:67], v[60:63], v[236:239]
  s_nop 7
  ds_write_b128 v8, v[240:243] offset:10240
  ds_write_b128 v8, v[236:239] offset:9216
  s_branch M_FIN
M_RUNB:
M_HSB:
  ds_read_b32 v251, v248 offset:240
  ds_read_b32 v15, v248 offset:196
  s_waitcnt lgkmcnt(0)
  v_readfirstlane_b32 s94, v251
  v_readfirstlane_b32 s38, v15
  s_cmp_ge_u32 s94, 8
  s_cbranch_scc0 M_HSB

  ds_read_b128 v[32:35], v6 offset:0
  ds_read_b128 v[36:39], v6 offset:64
  ds_read_b128 v[40:43], v6 offset:128
  s_waitcnt lgkmcnt(2)
  v_mfma_f32_16x16x32_f16 v[224:227], v[92:95], v[32:35], 0
  v_mfma_f32_16x16x32_f16 v[228:231], v[124:127], v[32:35], 0
  ds_read_b128 v[44:47], v6 offset:192
  v_mfma_f32_16x16x32_f16 v[232:235], v[156:159], v[32:35], 0
  s_lshr_b32 s64, s2, 3
  s_mul_i32 s64, s64, 162
  v_mfma_f32_16x16x32_f16 v[236:239], v[188:191], v[32:35], 0
  s_add_u32 s64, s64, 54
  s_and_b32 s65, s2, 7
  s_waitcnt lgkmcnt(2)
  v_mfma_f32_16x16x32_f16 v[224:227], v[88:91], v[36:39], v[224:227]
  s_mul_i32 s65, s65, 9
  v_min_u32 v252, 53, v2
  v_mfma_f32_16x16x32_f16 v[228:231], v[120:123], v[36:39], v[228:231]
  v_add_u32 v252, s64, v252
  v_mul_u32_u24 v254, 7282, v252
  ds_read_b128 v[48:51], v6 offset:256
  v_mfma_f32_16x16x32_f16 v[232:235], v[152:155], v[36:39], v[232:235]
  v_lshrrev_b32 v254, 16, v254
  v_mul_u32_u24 v253, 9, v254
  v_mfma_f32_16x16x32_f16 v[236:239], v[184:187], v[36:39], v[236:239]
  v_sub_u32 v253, v252, v253
  v_add_u32 v253, s65, v253
  s_waitcnt lgkmcnt(2)
  v_mfma_f32_16x16x32_f16 v[224:227], v[84:87], v[40:43], v[224:227]
  v_mul_u32_u24 v254, 9216, v254
  v_lshl_add_u32 v254, v253, 7, v254
  v_mfma_f32_16x16x32_f16 v[228:231], v[116:119], v[40:43], v[228:231]
  global_load_dword v250, v254, s[78:79]
  ds_read_b128 v[52:55], v6 offset:320
  v_mfma_f32_16x16x32_f16 v[232:235], v[148:151], v[40:43], v[232:235]
  v_mfma_f32_16x16x32_f16 v[236:239], v[180:183], v[40:43], v[236:239]
  s_waitcnt lgkmcnt(2)
  v_mfma_f32_16x16x32_f16 v[224:227], v[80:83], v[44:47], v[224:227]
  v_mfma_f32_16x16x32_f16 v[228:231], v[112:115], v[44:47], v[228:231]
  ds_read_b128 v[56:59], v6 offset:384
  v_mfma_f32_16x16x32_f16 v[232:235], v[144:147], v[44:47], v[232:235]
  v_mfma_f32_16x16x32_f16 v[236:239], v[176:179], v[44:47], v[236:239]
  s_waitcnt lgkmcnt(2)
  v_mfma_f32_16x16x32_f16 v[224:227], v[76:79], v[48:51], v[224:227]
  v_mfma_f32_16x16x32_f16 v[228:231], v[108:111], v[48:51], v[228:231]
  ds_read_b128 v[60:63], v6 offset:448
  v_mfma_f32_16x16x32_f16 v[232:235], v[140:143], v[48:51], v[232:235]
  v_mfma_f32_16x16x32_f16 v[236:239], v[172:175], v[48:51], v[236:239]
  s_waitcnt lgkmcnt(2)
  v_mfma_f32_16x16x32_f16 v[224:227], v[72:75], v[52:55], v[224:227]
  v_mfma_f32_16x16x32_f16 v[228:231], v[104:107], v[52:55], v[228:231]
  ds_read_b128 v[32:35], v6 offset:512
  v_mfma_f32_16x16x32_f16 v[232:235], v[136:139], v[52:55], v[232:235]
  v_mfma_f32_16x16x32_f16 v[236:239], v[168:171], v[52:55], v[236:239]
  s_waitcnt lgkmcnt(2)
  v_mfma_f32_16x16x32_f16 v[224:227], v[68:71], v[56:59], v[224:227]
  v_mfma_f32_16x16x32_f16 v[228:231], v[100:103], v[56:59], v[228:231]
  ds_read_b128 v[36:39], v6 offset:576
  v_mfma_f32_16x16x32_f16 v[232:235], v[132:135], v[56:59], v[232:235]
  v_mfma_f32_16x16x32_f16 v[236:239], v[164:167], v[56:59], v[236:239]
  s_waitcnt lgkmcnt(2)
  v_mfma_f32_16x16x32_f16 v[224:227], v[64:67], v[60:63], v[224:227]
  v_mfma_f32_16x16x32_f16 v[228:231], v[96:99], v[60:63], v[228:231]
  ds_read_b128 v[40:43], v6 offset:640
  v_mfma_f32_16x16x32_f16 v[232:235], v[128:131], v[60:63], v[232:235]
  v_mfma_f32_16x16x32_f16 v[236:239], v[160:163], v[60:63], v[236:239]
  s_waitcnt lgkmcnt(2)
  v_mfma_f32_16x16x32_f16 v[228:231], v[92:95], v[32:35], v[228:231]
  v_mfma_f32_16x16x32_f16 v[232:235], v[124:127], v[32:35], v[232:235]
  ds_read_b128 v[44:47], v6 offset:704
  v_mfma_f32_16x16x32_f16 v[236:239], v[156:159], v[32:35], v[236:239]
  v_mfma_f32_16x16x32_f16 v[240:243], v[188:191], v[32:35], 0
  s_waitcnt lgkmcnt(2)
  v_mfma_f32_16x16x32_f16 v[228:231], v[88:91], v[36:39], v[228:231]
  v_mfma_f32_16x16x32_f16 v[232:235], v[120:123], v[36:39], v[232:235]
  ds_write_b128 v8, v[224:227] offset:0
  ds_read_b128 v[48:51], v6 offset:768
  v_mfma_f32_16x16x32_f16 v[236:239], v[152:155], v[36:39], v[236:239]
  v_mfma_f32_16x16x32_f16 v[240:243], v[184:187], v[36:39], v[240:243]
  s_waitcnt lgkmcnt(3)
  v_mfma_f32_16x16x32_f16 v[228:231], v[84:87], v[40:43], v[228:231]
  v_mfma_f32_16x16x32_f16 v[232:235], v[116:119], v[40:43], v[232:235]
  ds_read_b128 v[52:55], v6 offset:832
  v_mfma_f32_16x16x32_f16 v[236:239], v[148:151], v[40:43], v[236:239]
  v_mfma_f32_16x16x32_f16 v[240:243], v[180:183], v[40:43], v[240:243]
  s_waitcnt lgkmcnt(3)
  v_mfma_f32_16x16x32_f16 v[228:231], v[80:83], v[44:47], v[228:231]
  v_mfma_f32_16x16x32_f16 v[232:235], v[112:115], v[44:47], v[232:235]
  ds_read_b128 v[56:59], v6 offset:896
  v_mfma_f32_16x16x32_f16 v[236:239], v[144:147], v[44:47], v[236:239]
  v_mfma_f32_16x16x32_f16 v[240:243], v[176:179], v[44:47], v[240:243]
  s_waitcnt lgkmcnt(2)
  v_mfma_f32_16x16x32_f16 v[228:231], v[76:79], v[48:51], v[228:231]
  v_mfma_f32_16x16x32_f16 v[232:235], v[108:111], v[48:51], v[232:235]
  ds_read_b128 v[60:63], v6 offset:960
  v_mfma_f32_16x16x32_f16 v[236:239], v[140:143], v[48:51], v[236:239]
  v_mfma_f32_16x16x32_f16 v[240:243], v[172:175], v[48:51], v[240:243]
  s_waitcnt lgkmcnt(2)
  v_mfma_f32_16x16x32_f16 v[228:231], v[72:75], v[52:55], v[228:231]
  v_mfma_f32_16x16x32_f16 v[232:235], v[104:107], v[52:55], v[232:235]
  ds_read_b128 v[32:35], v6 offset:1024
  v_mfma_f32_16x16x32_f16 v[236:239], v[136:139], v[52:55], v[236:239]
  v_mfma_f32_16x16x32_f16 v[240:243], v[168:171], v[52:55], v[240:243]
  ds_read_b128 v[36:39], v6 offset:1088
  s_waitcnt lgkmcnt(3)
  v_mfma_f32_16x16x32_f16 v[228:231], v[68:71], v[56:59], v[228:231]
  v_mfma_f32_16x16x32_f16 v[232:235], v[100:103], v[56:59], v[232:235]
  ds_read_b128 v[40:43], v6 offset:1152
  v_mfma_f32_16x16x32_f16 v[236:239], v[132:135], v[56:59], v[236:239]
  v_mfma_f32_16x16x32_f16 v[240:243], v[164:167], v[56:59], v[240:243]
  ds_read_b128 v[44:47], v6 offset:1216
  s_waitcnt lgkmcnt(4)
  v_mfma_f32_16x16x32_f16 v[228:231], v[64:67], v[60:63], v[228:231]
  v_mfma_f32_16x16x32_f16 v[232:235], v[96:99], v[60:63], v[232:235]
  ds_read_b128 v[48:51], v6 offset:1280
  v_mfma_f32_16x16x32_f16 v[236:239], v[128:131], v[60:63], v[236:239]
  v_mfma_f32_16x16x32_f16 v[240:243], v[160:163], v[60:63], v[240:243]
  ds_read_b128 v[52:55], v6 offset:1344
  s_waitcnt lgkmcnt(5)
  v_mfma_f32_16x16x32_f16 v[232:235], v[92:95], v[32:35], v[232:235]
  v_mfma_f32_16x16x32_f16 v[236:239], v[124:127], v[32:35], v[236:239]
  ds_read_b128 v[56:59], v6 offset:1408
  s_waitcnt lgkmcnt(5)
  v_mfma_f32_16x16x32_f16 v[232:235], v[88:91], v[36:39], v[232:235]
  v_mfma_f32_16x16x32_f16 v[236:239], v[120:123], v[36:39], v[236:239]
  ds_read_b128 v[60:63], v6 offset:1472
  s_waitcnt lgkmcnt(5)
  v_mfma_f32_16x16x32_f16 v[232:235], v[84:87], v[40:43], v[232:235]
  v_mfma_f32_16x16x32_f16 v[236:239], v[116:119], v[40:43], v[236:239]
  ds_write_b128 v8, v[228:231] offset:1024
  s_waitcnt lgkmcnt(5)
  v_mfma_f32_16x16x32_f16 v[232:235], v[80:83], v[44:47], v[232:235]
  v_mfma_f32_16x16x32_f16 v[236:239], v[112:115], v[44:47], v[236:239]
  s_waitcnt lgkmcnt(4)
  v_mfma_f32_16x16x32_f16 v[232:235], v[76:79], v[48:51], v[232:235]
  v_mfma_f32_16x16x32_f16 v[236:239], v[108:111], v[48:51], v[236:239]
  s_waitcnt lgkmcnt(3)
  v_mfma_f32_16x16x32_f16 v[232:235], v[72:75], v[52:55], v[232:235]
  v_mfma_f32_16x16x32_f16 v[236:239], v[104:107], v[52:55], v[236:239]
  s_waitcnt lgkmcnt(2)
  v_mfma_f32_16x16x32_f16 v[232:235], v[68:71], v[56:59], v[232:235]
  v_mfma_f32_16x16x32_f16 v[236:239], v[100:103], v[56:59], v[236:239]
  s_waitcnt lgkmcnt(1)
  v_mfma_f32_16x16x32_f16 v[232:235], v[64:67], v[60:63], v[232:235]
  v_mfma_f32_16x16x32_f16 v[236:239], v[96:99], v[60:63], v[236:239]
  v_mfma_f32_16x16x32_f16 v[240:243], v[156:159], v[32:35], v[240:243]
  v_mfma_f32_16x16x32_f16 v[240:243], v[152:155], v[36:39], v[240:243]
  v_mfma_f32_16x16x32_f16 v[240:243], v[148:151], v[40:43], v[240:243]
  v_mfma_f32_16x16x32_f16 v[240:243], v[144:147], v[44:47], v[240:243]
  v_mfma_f32_16x16x32_f16 v[240:243], v[140:143], v[48:51], v[240:243]
  v_mfma_f32_16x16x32_f16 v[240:243], v[136:139], v[52:55], v[240:243]
  v_mfma_f32_16x16x32_f16 v[240:243], v[132:135], v[56:59], v[240:243]
  v_mfma_f32_16x16x32_f16 v[240:243], v[128:131], v[60:63], v[240:243]
  ds_write_b128 v8, v[232:235] offset:2048
  v_mfma_f32_16x16x32_f16 v[244:247], v[188:191], v[32:35], 0
  ds_write_b128 v8, v[236:239] offset:3072
  v_mfma_f32_16x16x32_f16 v[244:247], v[184:187], v[36:39], v[244:247]
  v_mfma_f32_16x16x32_f16 v[244:247], v[180:183], v[40:43], v[244:247]
  v_mfma_f32_16x16x32_f16 v[244:247], v[176:179], v[44:47], v[244:247]
  v_mfma_f32_16x16x32_f16 v[244:247], v[172:175], v[48:51], v[244:247]
  v_mfma_f32_16x16x32_f16 v[244:247], v[168:171], v[52:55], v[244:247]
  v_mfma_f32_16x16x32_f16 v[244:247], v[164:167], v[56:59], v[244:247]
  v_mfma_f32_16x16x32_f16 v[244:247], v[160:163], v[60:63], v[244:247]
  s_nop 7
  ds_write_b128 v8, v[240:243] offset:4096
  ds_write_b128 v8, v[244:247] offset:5120
  s_branch M_FIN
M_RUND:
M_HSD:
  ds_read_b32 v251, v248 offset:240
  ds_read_b32 v15, v248 offset:196
  s_waitcnt lgkmcnt(0)
  v_readfirstlane_b32 s94, v251
  v_readfirstlane_b32 s38, v15
  s_cmp_ge_u32 s94, 8
  s_cbranch_scc0 M_HSD

  ds_read_b128 v[128:131], v6 offset:432
  ds_read_b128 v[132:135], v6 offset:416
  ds_read_b128 v[136:139], v6 offset:944
  ds_read_b128 v[140:143], v6 offset:928
  ds_read_b128 v[144:147], v6 offset:1456
  ds_read_b128 v[148:151], v6 offset:1440
  ds_read_b128 v[152:155], v6 offset:1968
  ds_read_b128 v[156:159], v6 offset:1952
  ds_read_b128 v[160:163], v6 offset:448
  ds_read_b128 v[164:167], v6 offset:960
  ds_read_b128 v[168:171], v6 offset:1472
  ds_read_b128 v[172:175], v6 offset:1984
  s_waitcnt vmcnt(0)
  s_waitcnt lgkmcnt(10)
  v_mfma_f32_16x16x32_f16 v[32:35], v[128:131], v[192:195], 0
  v_mfma_f32_16x16x32_f16 v[36:39], v[132:135], v[196:199], 0
  s_waitcnt lgkmcnt(8)
  v_mfma_f32_16x16x32_f16 v[40:43], v[136:139], v[192:195], 0
  v_mfma_f32_16x16x32_f16 v[44:47], v[140:143], v[196:199], 0
  s_waitcnt lgkmcnt(6)
  v_mfma_f32_16x16x32_f16 v[48:51], v[144:147], v[192:195], 0
  v_mfma_f32_16x16x32_f16 v[52:55], v[148:151], v[196:199], 0
  s_waitcnt lgkmcnt(4)
  v_mfma_f32_16x16x32_f16 v[56:59], v[152:155], v[192:195], 0
  v_mfma_f32_16x16x32_f16 v[60:63], v[156:159], v[196:199], 0
  s_waitcnt lgkmcnt(0)
  v_mfma_f32_16x16x32_f16 v[224:227], v[216:219], v[160:163], 0
  v_mfma_f32_16x16x32_f16 v[228:231], v[216:219], v[164:167], 0
  v_mfma_f32_16x16x32_f16 v[232:235], v[216:219], v[168:171], 0
  v_mfma_f32_16x16x32_f16 v[236:239], v[216:219], v[172:175], 0
  s_nop 0
  v_cvt_pk_f16_f32 v32, v32, v33
  v_cvt_pk_f16_f32 v33, v34, v35
  v_cvt_pk_f16_f32 v34, v36, v37
  v_cvt_pk_f16_f32 v35, v38, v39
  v_cvt_pk_f16_f32 v40, v40, v41
  v_cvt_pk_f16_f32 v41, v42, v43
  v_cvt_pk_f16_f32 v42, v44, v45
  v_cvt_pk_f16_f32 v43, v46, v47
  v_cvt_pk_f16_f32 v48, v48, v49
  v_cvt_pk_f16_f32 v49, v50, v51
  v_cvt_pk_f16_f32 v50, v52, v53
  v_cvt_pk_f16_f32 v51, v54, v55
  s_nop 2
  v_cvt_pk_f16_f32 v56, v56, v57
  v_cvt_pk_f16_f32 v57, v58, v59
  v_cvt_pk_f16_f32 v58, v60, v61
  v_cvt_pk_f16_f32 v59, v62, v63
  s_nop 1
  v_mfma_f32_16x16x32_f16 v[224:227], v[32:35], v[200:203], v[224:227]
  v_mfma_f32_16x16x32_f16 v[228:231], v[32:35], v[204:207], v[228:231]
  v_mfma_f32_16x16x32_f16 v[232:235], v[32:35], v[208:211], v[232:235]
  v_mfma_f32_16x16x32_f16 v[236:239], v[32:35], v[212:215], v[236:239]
  v_mfma_f32_16x16x32_f16 v[228:231], v[40:43], v[200:203], v[228:231]
  v_mfma_f32_16x16x32_f16 v[232:235], v[40:43], v[204:207], v[232:235]
  v_mfma_f32_16x16x32_f16 v[236:239], v[40:43], v[208:211], v[236:239]
  v_mfma_f32_16x16x32_f16 v[232:235], v[48:51], v[200:203], v[232:235]
  v_mfma_f32_16x16x32_f16 v[236:239], v[48:51], v[204:207], v[236:239]
  v_mfma_f32_16x16x32_f16 v[236:239], v[56:59], v[200:203], v[236:239]
  ds_read_b128 v[32:35], v6 offset:3072
  ds_read_b128 v[36:39], v6 offset:3136
  ds_read_b128 v[40:43], v6 offset:3200
  ds_read_b128 v[44:47], v6 offset:3264
  ds_read_b128 v[48:51], v6 offset:3328
  ds_read_b128 v[52:55], v6 offset:3392
  ds_read_b128 v[56:59], v6 offset:3456
  ds_read_b128 v[60:63], v6 offset:3520
  s_waitcnt lgkmcnt(7)
  v_mfma_f32_16x16x32_f16 v[236:239], v[124:127], v[32:35], v[236:239]
  ds_read_b128 v[32:35], v6 offset:3584
  s_waitcnt lgkmcnt(7)
  v_mfma_f32_16x16x32_f16 v[236:239], v[120:123], v[36:39], v[236:239]
  ds_read_b128 v[36:39], v6 offset:3648
  s_waitcnt lgkmcnt(7)
  v_mfma_f32_16x16x32_f16 v[236:239], v[116:119], v[40:43], v[236:239]
  s_cmp_lg_u32 s3, 6
  s_cbranch_scc1 M_NRI
  s_cmp_lt_u32 s2, 229
  s_cbranch_scc1 M_NRI
  s_sub_u32 s40, s2, 202
  s_mul_i32 s40, s40, 4608
  s_add_u32 s40, s40, 524288
  v_lshl_add_u32 v146, v2, 3, s40
  v_add_u32 v147, 4096, v146

  global_load_dwordx2 v[128:129], v146, s[36:37] offset:0 sc1
  global_load_dwordx2 v[130:131], v146, s[36:37] offset:512 sc1
  global_load_dwordx2 v[132:133], v146, s[36:37] offset:1024 sc1
  global_load_dwordx2 v[134:135], v146, s[36:37] offset:1536 sc1
  global_load_dwordx2 v[136:137], v146, s[36:37] offset:2048 sc1
  global_load_dwordx2 v[138:139], v146, s[36:37] offset:2560 sc1
  global_load_dwordx2 v[140:141], v146, s[36:37] offset:3072 sc1
  global_load_dwordx2 v[142:143], v146, s[36:37] offset:3584 sc1
  global_load_dwordx2 v[144:145], v147, s[36:37] sc1
M_NRI:
  s_lshr_b32 s64, s2, 3
  ds_read_b128 v[40:43], v6 offset:3712
  s_waitcnt lgkmcnt(7)
  v_mfma_f32_16x16x32_f16 v[236:239], v[112:115], v[44:47], v[236:239]
  s_mul_i32 s64, s64, 162
  s_add_u32 s64, s64, 108
  ds_read_b128 v[44:47], v6 offset:3776
  s_waitcnt lgkmcnt(7)
  v_mfma_f32_16x16x32_f16 v[236:239], v[108:111], v[48:51], v[236:239]
  s_and_b32 s65, s2, 7
  s_mul_i32 s65, s65, 9
  ds_read_b128 v[48:51], v6 offset:3840
  s_waitcnt lgkmcnt(7)
  v_mfma_f32_16x16x32_f16 v[236:239], v[104:107], v[52:55], v[236:239]
  v_min_u32 v252, 53, v2
  v_add_u32 v252, s64, v252
  ds_read_b128 v[52:55], v6 offset:3904
  s_waitcnt lgkmcnt(7)
  v_mfma_f32_16x16x32_f16 v[236:239], v[100:103], v[56:59], v[236:239]
  v_mul_u32_u24 v254, 7282, v252
  v_lshrrev_b32 v254, 16, v254
  ds_read_b128 v[56:59], v6 offset:3968
  s_waitcnt lgkmcnt(7)
  v_mfma_f32_16x16x32_f16 v[236:239], v[96:99], v[60:63], v[236:239]
  v_mul_u32_u24 v253, 9, v254
  v_sub_u32 v253, v252, v253
  ds_read_b128 v[60:63], v6 offset:4032
  s_waitcnt lgkmcnt(7)
  v_mfma_f32_16x16x32_f16 v[236:239], v[92:95], v[32:35], v[236:239]
  v_add_u32 v253, s65, v253
  v_mul_u32_u24 v254, 9216, v254
  ds_write_b128 v8, v[224:227] offset:11264
  ds_write_b128 v8, v[228:231] offset:12288
  ds_write_b128 v8, v[232:235] offset:13312
  s_waitcnt lgkmcnt(9)
  v_mfma_f32_16x16x32_f16 v[236:239], v[88:91], v[36:39], v[236:239]
  v_lshl_add_u32 v254, v253, 7, v254
  global_load_dword v250, v254, s[78:79]
  s_waitcnt lgkmcnt(8)
  v_mfma_f32_16x16x32_f16 v[236:239], v[84:87], v[40:43], v[236:239]
  s_waitcnt lgkmcnt(7)
  v_mfma_f32_16x16x32_f16 v[236:239], v[80:83], v[44:47], v[236:239]
  s_waitcnt lgkmcnt(6)
  v_mfma_f32_16x16x32_f16 v[236:239], v[76:79], v[48:51], v[236:239]
  s_waitcnt lgkmcnt(5)
  v_mfma_f32_16x16x32_f16 v[236:239], v[72:75], v[52:55], v[236:239]
  s_waitcnt lgkmcnt(4)
  v_mfma_f32_16x16x32_f16 v[236:239], v[68:71], v[56:59], v[236:239]
  s_waitcnt lgkmcnt(3)
  v_mfma_f32_16x16x32_f16 v[236:239], v[64:67], v[60:63], v[236:239]
  s_nop 7
  ds_write_b128 v8, v[236:239] offset:14336
  s_branch M_FIN
M_RUNP0:
M_HSP0:
  ds_read_b32 v251, v248 offset:240
  ds_read_b32 v15, v248 offset:196
  s_waitcnt lgkmcnt(0)
  v_readfirstlane_b32 s94, v251
  v_readfirstlane_b32 s38, v15
  s_cmp_ge_u32 s94, 8
  s_cbranch_scc0 M_HSP0

  v_lshlrev_b32 v8, 4, v2
  v_add_u32 v8, 16896, v8
  ds_read_b128 v[32:35], v6 offset:2048
  ds_read_b128 v[36:39], v6 offset:2112
  ds_read_b128 v[40:43], v6 offset:2176
  ds_read_b128 v[44:47], v6 offset:2240
  ds_read_b64 v[176:177], v4 offset:2240
  ds_read_b64 v[178:179], v4 offset:2248
  ds_read_b128 v[48:51], v6 offset:2304
  ds_read_b64 v[172:173], v4 offset:2304
  ds_read_b64 v[174:175], v4 offset:2312
  ds_read_b128 v[52:55], v6 offset:2368
  ds_read_b64 v[168:169], v4 offset:2368
  ds_read_b64 v[170:171], v4 offset:2376
  ds_read_b128 v[56:59], v6 offset:2432
  ds_read_b64 v[164:165], v4 offset:2432
  ds_read_b64 v[166:167], v4 offset:2440
  ds_read_b128 v[60:63], v6 offset:2496
  ds_read_b64 v[160:161], v4 offset:2496
  ds_read_b64 v[162:163], v4 offset:2504
  s_waitcnt lgkmcnt(15)
  v_mfma_f32_16x16x32_f16 v[224:227], v[188:191], v[32:35], 0
  ds_read_b128 v[32:35], v6 offset:2560
  v_mfma_f32_16x16x32_f16 v[224:227], v[184:187], v[36:39], v[224:227]
  ds_read_b128 v[36:39], v6 offset:2624
  v_mfma_f32_16x16x32_f16 v[224:227], v[180:183], v[40:43], v[224:227]
  ds_read_b128 v[40:43], v6 offset:2688
  s_waitcnt lgkmcnt(15)
  v_mfma_f32_16x16x32_f16 v[224:227], v[176:179], v[44:47], v[224:227]
  ds_read_b128 v[44:47], v6 offset:2752
  ds_read_b64 v[144:145], v4 offset:2752
  ds_read_b64 v[146:147], v4 offset:2760
  s_waitcnt lgkmcnt(15)
  v_mfma_f32_16x16x32_f16 v[224:227], v[172:175], v[48:51], v[224:227]
  ds_read_b128 v[48:51], v6 offset:2816
  ds_read_b64 v[140:141], v4 offset:2816
  ds_read_b64 v[142:143], v4 offset:2824
  s_waitcnt lgkmcnt(15)
  v_mfma_f32_16x16x32_f16 v[224:227], v[168:171], v[52:55], v[224:227]
  ds_read_b128 v[52:55], v6 offset:2880
  ds_read_b64 v[136:137], v4 offset:2880
  ds_read_b64 v[138:139], v4 offset:2888
  s_waitcnt lgkmcnt(15)
  v_mfma_f32_16x16x32_f16 v[224:227], v[164:167], v[56:59], v[224:227]
  ds_read_b128 v[56:59], v6 offset:2944
  ds_read_b64 v[132:133], v4 offset:2944
  ds_read_b64 v[134:135], v4 offset:2952
  s_waitcnt lgkmcnt(15)
  v_mfma_f32_16x16x32_f16 v[224:227], v[160:163], v[60:63], v[224:227]
  ds_read_b128 v[60:63], v6 offset:3008
  ds_read_b64 v[128:129], v4 offset:3008
  ds_read_b64 v[130:131], v4 offset:3016
  s_waitcnt lgkmcnt(15)
  v_mfma_f32_16x16x32_f16 v[224:227], v[156:159], v[32:35], v[224:227]
  ds_read_b128 v[32:35], v6 offset:3072
  v_mfma_f32_16x16x32_f16 v[224:227], v[152:155], v[36:39], v[224:227]
  ds_read_b128 v[36:39], v6 offset:3136
  v_mfma_f32_16x16x32_f16 v[224:227], v[148:151], v[40:43], v[224:227]
  ds_read_b128 v[40:43], v6 offset:3200
  s_waitcnt lgkmcnt(15)
  v_mfma_f32_16x16x32_f16 v[224:227], v[144:147], v[44:47], v[224:227]
  ds_read_b128 v[44:47], v6 offset:3264
  ds_read_b64 v[112:113], v4 offset:3264
  ds_read_b64 v[114:115], v4 offset:3272
  s_waitcnt lgkmcnt(15)
  v_mfma_f32_16x16x32_f16 v[224:227], v[140:143], v[48:51], v[224:227]
  ds_read_b128 v[48:51], v6 offset:3328
  ds_read_b64 v[108:109], v4 offset:3328
  ds_read_b64 v[110:111], v4 offset:3336
  s_waitcnt lgkmcnt(15)
  v_mfma_f32_16x16x32_f16 v[224:227], v[136:139], v[52:55], v[224:227]
  ds_read_b128 v[52:55], v6 offset:3392
  ds_read_b64 v[104:105], v4 offset:3392
  ds_read_b64 v[106:107], v4 offset:3400
  s_waitcnt lgkmcnt(15)
  v_mfma_f32_16x16x32_f16 v[224:227], v[132:135], v[56:59], v[224:227]
  ds_read_b128 v[56:59], v6 offset:3456
  ds_read_b64 v[100:101], v4 offset:3456
  ds_read_b64 v[102:103], v4 offset:3464
  s_waitcnt lgkmcnt(15)
  v_mfma_f32_16x16x32_f16 v[224:227], v[128:131], v[60:63], v[224:227]
  ds_read_b128 v[60:63], v6 offset:3520
  ds_read_b64 v[96:97], v4 offset:3520
  ds_read_b64 v[98:99], v4 offset:3528
  s_waitcnt lgkmcnt(15)
  v_mfma_f32_16x16x32_f16 v[224:227], v[124:127], v[32:35], v[224:227]
  ds_read_b128 v[32:35], v6 offset:3584
  v_mfma_f32_16x16x32_f16 v[224:227], v[120:123], v[36:39], v[224:227]
  ds_read_b128 v[36:39], v6 offset:3648
  v_mfma_f32_16x16x32_f16 v[224:227], v[116:119], v[40:43], v[224:227]
  ds_read_b128 v[40:43], v6 offset:3712
  s_waitcnt lgkmcnt(15)
  v_mfma_f32_16x16x32_f16 v[224:227], v[112:115], v[44:47], v[224:227]
  ds_read_b128 v[44:47], v6 offset:3776
  ds_read_b64 v[80:81], v4 offset:3776
  ds_read_b64 v[82:83], v4 offset:3784
  s_waitcnt lgkmcnt(15)
  v_mfma_f32_16x16x32_f16 v[224:227], v[108:111], v[48:51], v[224:227]
  ds_read_b128 v[48:51], v6 offset:3840
  ds_read_b64 v[76:77], v4 offset:3840
  ds_read_b64 v[78:79], v4 offset:3848
  s_waitcnt lgkmcnt(15)
  v_mfma_f32_16x16x32_f16 v[224:227], v[104:107], v[52:55], v[224:227]
  ds_read_b128 v[52:55], v6 offset:3904
  ds_read_b64 v[72:73], v4 offset:3904
  ds_read_b64 v[74:75], v4 offset:3912
  s_waitcnt lgkmcnt(15)
  v_mfma_f32_16x16x32_f16 v[224:227], v[100:103], v[56:59], v[224:227]
  ds_read_b128 v[56:59], v6 offset:3968
  ds_read_b64 v[68:69], v4 offset:3968
  ds_read_b64 v[70:71], v4 offset:3976
  s_waitcnt lgkmcnt(15)
  v_mfma_f32_16x16x32_f16 v[224:227], v[96:99], v[60:63], v[224:227]
  ds_read_b128 v[60:63], v6 offset:4032
  ds_read_b64 v[64:65], v4 offset:4032
  ds_read_b64 v[66:67], v4 offset:4040
  s_waitcnt lgkmcnt(15)
  v_mfma_f32_16x16x32_f16 v[224:227], v[92:95], v[32:35], v[224:227]
  v_mfma_f32_16x16x32_f16 v[224:227], v[88:91], v[36:39], v[224:227]
  v_mfma_f32_16x16x32_f16 v[224:227], v[84:87], v[40:43], v[224:227]
  s_waitcnt lgkmcnt(12)
  v_mfma_f32_16x16x32_f16 v[224:227], v[80:83], v[44:47], v[224:227]
  s_waitcnt lgkmcnt(9)
  v_mfma_f32_16x16x32_f16 v[224:227], v[76:79], v[48:51], v[224:227]
  s_waitcnt lgkmcnt(6)
  v_mfma_f32_16x16x32_f16 v[224:227], v[72:75], v[52:55], v[224:227]
  s_waitcnt lgkmcnt(3)
  v_mfma_f32_16x16x32_f16 v[224:227], v[68:71], v[56:59], v[224:227]
  s_waitcnt lgkmcnt(0)
  v_mfma_f32_16x16x32_f16 v[224:227], v[64:67], v[60:63], v[224:227]
  s_nop 7
M_CSP0:
  ds_read_b32 v40, v248 offset:236
  ds_read_b128 v[52:55], v8
  s_waitcnt lgkmcnt(0)
  v_readfirstlane_b32 s94, v40
  s_cmp_ge_u32 s94, 1
  s_cbranch_scc0 M_CSP0

  ds_read_b32 v40, v248 offset:40
  ds_read_b32 v41, v248 offset:56
  ds_read_b32 v42, v248 offset:72
  ds_read_b32 v43, v248 offset:88
  ds_read_b64 v[44:45], v3 offset:12800
  v_and_b32 v16, 15, v2
  v_mul_u32_u24 v16, 96, v16
  v_lshrrev_b32 v17, 5, v2
  v_mul_u32_u24 v17, 48, v17
  v_bfe_u32 v18, v2, 4, 1
  v_lshl_add_u32 v17, v18, 3, v17
  v_add_u32 v16, v16, v17
  v_add_u32 v16, 69152, v16

  v_add_f32 v224, v224, v52
  v_add_f32 v225, v225, v53
  v_add_f32 v226, v226, v54
  v_add_f32 v227, v227, v55
  s_waitcnt lgkmcnt(0)
  v_ldexp_f32 v43, v43, v42
  v_mul_f32 v224, v43, v224
  v_mul_f32 v225, v43, v225
  v_mul_f32 v226, v43, v226
  v_mul_f32 v227, v43, v227
  v_fma_mix_f32 v48, v44, v40, 0 op_sel:[0,0,0] op_sel_hi:[1,0,0]
  v_fma_mix_f32 v49, v44, v40, 0 op_sel:[1,0,0] op_sel_hi:[1,0,0]
  v_fma_mix_f32 v50, v45, v40, 0 op_sel:[0,0,0] op_sel_hi:[1,0,0]
  v_fma_mix_f32 v51, v45, v40, 0 op_sel:[1,0,0] op_sel_hi:[1,0,0]
  v_cvt_pk_bf16_f32 v225, v224, v225
  v_cvt_pk_bf16_f32 v227, v226, v227
  v_cvt_pk_bf16_f32 v49, v48, v49
  v_cvt_pk_bf16_f32 v51, v50, v51
  v_lshlrev_b32 v224, 16, v225
  v_and_b32 v225, 0xffff0000, v225
  v_lshlrev_b32 v226, 16, v227
  v_and_b32 v227, 0xffff0000, v227
  v_lshlrev_b32 v48, 16, v49
  v_and_b32 v49, 0xffff0000, v49
  v_lshlrev_b32 v50, 16, v51
  v_and_b32 v51, 0xffff0000, v51
  v_add_f32 v224, v224, v48
  v_add_f32 v225, v225, v49
  v_add_f32 v226, v226, v50
  v_add_f32 v227, v227, v51
  v_cvt_pk_bf16_f32 v225, v224, v225
  v_cvt_pk_bf16_f32 v227, v226, v227
  v_lshlrev_b32 v224, 16, v225
  v_and_b32 v225, 0xffff0000, v225
  v_lshlrev_b32 v226, 16, v227
  v_and_b32 v227, 0xffff0000, v227
  v_mul_f32 v224, v41, v224
  v_mul_f32 v225, v41, v225
  v_mul_f32 v226, v41, v226
  v_mul_f32 v227, v41, v227
  v_cvt_pk_bf16_f32 v48, v224, v225
  v_cvt_pk_bf16_f32 v49, v226, v227
  ds_write_b64 v16, v[48:49] offset:10752
  s_branch M_FIN
M_RUNP1:
M_HSP1:
  ds_read_b32 v251, v248 offset:240
  ds_read_b32 v15, v248 offset:196
  s_waitcnt lgkmcnt(0)
  v_readfirstlane_b32 s94, v251
  v_readfirstlane_b32 s38, v15
  s_cmp_ge_u32 s94, 8
  s_cbranch_scc0 M_HSP1

  v_lshlrev_b32 v8, 4, v2
  v_add_u32 v8, 16896, v8
  ds_read_b128 v[32:35], v6 offset:1536
  ds_read_b128 v[36:39], v6 offset:1600
  ds_read_b128 v[40:43], v6 offset:1664
  ds_read_b128 v[44:47], v6 offset:1728
  ds_read_b64 v[176:177], v4 offset:2240
  ds_read_b64 v[178:179], v4 offset:2248
  ds_read_b128 v[48:51], v6 offset:1792
  ds_read_b64 v[172:173], v4 offset:2304
  ds_read_b64 v[174:175], v4 offset:2312
  ds_read_b128 v[52:55], v6 offset:1856
  ds_read_b64 v[168:169], v4 offset:2368
  ds_read_b64 v[170:171], v4 offset:2376
  ds_read_b128 v[56:59], v6 offset:1920
  ds_read_b64 v[164:165], v4 offset:2432
  ds_read_b64 v[166:167], v4 offset:2440
  ds_read_b128 v[60:63], v6 offset:1984
  ds_read_b64 v[160:161], v4 offset:2496
  ds_read_b64 v[162:163], v4 offset:2504
  s_waitcnt lgkmcnt(15)
  v_mfma_f32_16x16x32_f16 v[224:227], v[188:191], v[32:35], 0
  ds_read_b128 v[32:35], v6 offset:2048
  v_mfma_f32_16x16x32_f16 v[224:227], v[184:187], v[36:39], v[224:227]
  ds_read_b128 v[36:39], v6 offset:2112
  v_mfma_f32_16x16x32_f16 v[224:227], v[180:183], v[40:43], v[224:227]
  ds_read_b128 v[40:43], v6 offset:2176
  s_waitcnt lgkmcnt(15)
  v_mfma_f32_16x16x32_f16 v[224:227], v[176:179], v[44:47], v[224:227]
  ds_read_b128 v[44:47], v6 offset:2240
  ds_read_b64 v[144:145], v4 offset:2752
  ds_read_b64 v[146:147], v4 offset:2760
  s_waitcnt lgkmcnt(15)
  v_mfma_f32_16x16x32_f16 v[224:227], v[172:175], v[48:51], v[224:227]
  ds_read_b128 v[48:51], v6 offset:2304
  ds_read_b64 v[140:141], v4 offset:2816
  ds_read_b64 v[142:143], v4 offset:2824
  s_waitcnt lgkmcnt(15)
  v_mfma_f32_16x16x32_f16 v[224:227], v[168:171], v[52:55], v[224:227]
  ds_read_b128 v[52:55], v6 offset:2368
  ds_read_b64 v[136:137], v4 offset:2880
  ds_read_b64 v[138:139], v4 offset:2888
  s_waitcnt lgkmcnt(15)
  v_mfma_f32_16x16x32_f16 v[224:227], v[164:167], v[56:59], v[224:227]
  ds_read_b128 v[56:59], v6 offset:2432
  ds_read_b64 v[132:133], v4 offset:2944
  ds_read_b64 v[134:135], v4 offset:2952
  s_waitcnt lgkmcnt(15)
  v_mfma_f32_16x16x32_f16 v[224:227], v[160:163], v[60:63], v[224:227]
  ds_read_b128 v[60:63], v6 offset:2496
  ds_read_b64 v[128:129], v4 offset:3008
  ds_read_b64 v[130:131], v4 offset:3016
  s_waitcnt lgkmcnt(15)
  v_mfma_f32_16x16x32_f16 v[224:227], v[156:159], v[32:35], v[224:227]
  ds_read_b128 v[32:35], v6 offset:2560
  v_mfma_f32_16x16x32_f16 v[224:227], v[152:155], v[36:39], v[224:227]
  ds_read_b128 v[36:39], v6 offset:2624
  v_mfma_f32_16x16x32_f16 v[224:227], v[148:151], v[40:43], v[224:227]
  ds_read_b128 v[40:43], v6 offset:2688
  s_waitcnt lgkmcnt(15)
  v_mfma_f32_16x16x32_f16 v[224:227], v[144:147], v[44:47], v[224:227]
  ds_read_b128 v[44:47], v6 offset:2752
  ds_read_b64 v[112:113], v4 offset:3264
  ds_read_b64 v[114:115], v4 offset:3272
  s_waitcnt lgkmcnt(15)
  v_mfma_f32_16x16x32_f16 v[224:227], v[140:143], v[48:51], v[224:227]
  ds_read_b128 v[48:51], v6 offset:2816
  ds_read_b64 v[108:109], v4 offset:3328
  ds_read_b64 v[110:111], v4 offset:3336
  s_waitcnt lgkmcnt(15)
  v_mfma_f32_16x16x32_f16 v[224:227], v[136:139], v[52:55], v[224:227]
  ds_read_b128 v[52:55], v6 offset:2880
  ds_read_b64 v[104:105], v4 offset:3392
  ds_read_b64 v[106:107], v4 offset:3400
  s_waitcnt lgkmcnt(15)
  v_mfma_f32_16x16x32_f16 v[224:227], v[132:135], v[56:59], v[224:227]
  ds_read_b128 v[56:59], v6 offset:2944
  ds_read_b64 v[100:101], v4 offset:3456
  ds_read_b64 v[102:103], v4 offset:3464
  s_waitcnt lgkmcnt(15)
  v_mfma_f32_16x16x32_f16 v[224:227], v[128:131], v[60:63], v[224:227]
  ds_read_b128 v[60:63], v6 offset:3008
  ds_read_b64 v[96:97], v4 offset:3520
  ds_read_b64 v[98:99], v4 offset:3528
  s_waitcnt lgkmcnt(15)
  v_mfma_f32_16x16x32_f16 v[224:227], v[124:127], v[32:35], v[224:227]
  ds_read_b128 v[32:35], v6 offset:3072
  v_mfma_f32_16x16x32_f16 v[224:227], v[120:123], v[36:39], v[224:227]
  ds_read_b128 v[36:39], v6 offset:3136
  v_mfma_f32_16x16x32_f16 v[224:227], v[116:119], v[40:43], v[224:227]
  ds_read_b128 v[40:43], v6 offset:3200
  s_waitcnt lgkmcnt(15)
  v_mfma_f32_16x16x32_f16 v[224:227], v[112:115], v[44:47], v[224:227]
  ds_read_b128 v[44:47], v6 offset:3264
  ds_read_b64 v[80:81], v4 offset:3776
  ds_read_b64 v[82:83], v4 offset:3784
  s_waitcnt lgkmcnt(15)
  v_mfma_f32_16x16x32_f16 v[224:227], v[108:111], v[48:51], v[224:227]
  ds_read_b128 v[48:51], v6 offset:3328
  ds_read_b64 v[76:77], v4 offset:3840
  ds_read_b64 v[78:79], v4 offset:3848
  s_waitcnt lgkmcnt(15)
  v_mfma_f32_16x16x32_f16 v[224:227], v[104:107], v[52:55], v[224:227]
  ds_read_b128 v[52:55], v6 offset:3392
  ds_read_b64 v[72:73], v4 offset:3904
  ds_read_b64 v[74:75], v4 offset:3912
  s_waitcnt lgkmcnt(15)
  v_mfma_f32_16x16x32_f16 v[224:227], v[100:103], v[56:59], v[224:227]
  ds_read_b128 v[56:59], v6 offset:3456
  ds_read_b64 v[68:69], v4 offset:3968
  ds_read_b64 v[70:71], v4 offset:3976
  s_waitcnt lgkmcnt(15)
  v_mfma_f32_16x16x32_f16 v[224:227], v[96:99], v[60:63], v[224:227]
  ds_read_b128 v[60:63], v6 offset:3520
  ds_read_b64 v[64:65], v4 offset:4032
  ds_read_b64 v[66:67], v4 offset:4040
  s_waitcnt lgkmcnt(15)
  v_mfma_f32_16x16x32_f16 v[224:227], v[92:95], v[32:35], v[224:227]
  v_mfma_f32_16x16x32_f16 v[224:227], v[88:91], v[36:39], v[224:227]
  v_mfma_f32_16x16x32_f16 v[224:227], v[84:87], v[40:43], v[224:227]
  s_waitcnt lgkmcnt(12)
  v_mfma_f32_16x16x32_f16 v[224:227], v[80:83], v[44:47], v[224:227]
  s_waitcnt lgkmcnt(9)
  v_mfma_f32_16x16x32_f16 v[224:227], v[76:79], v[48:51], v[224:227]
  s_waitcnt lgkmcnt(6)
  v_mfma_f32_16x16x32_f16 v[224:227], v[72:75], v[52:55], v[224:227]
  s_waitcnt lgkmcnt(3)
  v_mfma_f32_16x16x32_f16 v[224:227], v[68:71], v[56:59], v[224:227]
  s_waitcnt lgkmcnt(0)
  v_mfma_f32_16x16x32_f16 v[224:227], v[64:67], v[60:63], v[224:227]
  s_nop 7
M_CSP1:
  ds_read_b32 v40, v248 offset:236
  ds_read_b128 v[52:55], v8
  s_waitcnt lgkmcnt(0)
  v_readfirstlane_b32 s94, v40
  s_cmp_ge_u32 s94, 1
  s_cbranch_scc0 M_CSP1

  ds_read_b32 v40, v248 offset:40
  ds_read_b32 v41, v248 offset:56
  ds_read_b32 v42, v248 offset:72
  ds_read_b32 v43, v248 offset:88
  ds_read_b64 v[44:45], v3 offset:12288
  v_and_b32 v16, 15, v2
  v_mul_u32_u24 v16, 96, v16
  v_lshrrev_b32 v17, 5, v2
  v_mul_u32_u24 v17, 48, v17
  v_bfe_u32 v18, v2, 4, 1
  v_lshl_add_u32 v17, v18, 3, v17
  v_add_u32 v16, v16, v17
  v_add_u32 v16, 69152, v16

  v_add_f32 v224, v224, v52
  v_add_f32 v225, v225, v53
  v_add_f32 v226, v226, v54
  v_add_f32 v227, v227, v55
  s_waitcnt lgkmcnt(0)
  v_ldexp_f32 v43, v43, v42
  v_mul_f32 v224, v43, v224
  v_mul_f32 v225, v43, v225
  v_mul_f32 v226, v43, v226
  v_mul_f32 v227, v43, v227
  v_fma_mix_f32 v48, v44, v40, 0 op_sel:[0,0,0] op_sel_hi:[1,0,0]
  v_fma_mix_f32 v49, v44, v40, 0 op_sel:[1,0,0] op_sel_hi:[1,0,0]
  v_fma_mix_f32 v50, v45, v40, 0 op_sel:[0,0,0] op_sel_hi:[1,0,0]
  v_fma_mix_f32 v51, v45, v40, 0 op_sel:[1,0,0] op_sel_hi:[1,0,0]
  v_cvt_pk_bf16_f32 v225, v224, v225
  v_cvt_pk_bf16_f32 v227, v226, v227
  v_cvt_pk_bf16_f32 v49, v48, v49
  v_cvt_pk_bf16_f32 v51, v50, v51
  v_lshlrev_b32 v224, 16, v225
  v_and_b32 v225, 0xffff0000, v225
  v_lshlrev_b32 v226, 16, v227
  v_and_b32 v227, 0xffff0000, v227
  v_lshlrev_b32 v48, 16, v49
  v_and_b32 v49, 0xffff0000, v49
  v_lshlrev_b32 v50, 16, v51
  v_and_b32 v51, 0xffff0000, v51
  v_add_f32 v224, v224, v48
  v_add_f32 v225, v225, v49
  v_add_f32 v226, v226, v50
  v_add_f32 v227, v227, v51
  v_cvt_pk_bf16_f32 v225, v224, v225
  v_cvt_pk_bf16_f32 v227, v226, v227
  v_lshlrev_b32 v224, 16, v225
  v_and_b32 v225, 0xffff0000, v225
  v_lshlrev_b32 v226, 16, v227
  v_and_b32 v227, 0xffff0000, v227
  v_mul_f32 v224, v41, v224
  v_mul_f32 v225, v41, v225
  v_mul_f32 v226, v41, v226
  v_mul_f32 v227, v41, v227
  v_cvt_pk_bf16_f32 v48, v224, v225
  v_cvt_pk_bf16_f32 v49, v226, v227
  ds_write_b64 v16, v[48:49] offset:9216
  s_branch M_FIN
M_RUNP2:
M_HSP2:
  ds_read_b32 v251, v248 offset:240
  ds_read_b32 v15, v248 offset:196
  s_waitcnt lgkmcnt(0)
  v_readfirstlane_b32 s94, v251
  v_readfirstlane_b32 s38, v15
  s_cmp_ge_u32 s94, 8
  s_cbranch_scc0 M_HSP2

  v_lshlrev_b32 v8, 4, v2
  v_add_u32 v8, 16896, v8
  ds_read_b128 v[32:35], v6 offset:1024
  ds_read_b128 v[36:39], v6 offset:1088
  ds_read_b128 v[40:43], v6 offset:1152
  ds_read_b128 v[44:47], v6 offset:1216
  ds_read_b64 v[176:177], v4 offset:2240
  ds_read_b64 v[178:179], v4 offset:2248
  ds_read_b128 v[48:51], v6 offset:1280
  ds_read_b64 v[172:173], v4 offset:2304
  ds_read_b64 v[174:175], v4 offset:2312
  ds_read_b128 v[52:55], v6 offset:1344
  ds_read_b64 v[168:169], v4 offset:2368
  ds_read_b64 v[170:171], v4 offset:2376
  ds_read_b128 v[56:59], v6 offset:1408
  ds_read_b64 v[164:165], v4 offset:2432
  ds_read_b64 v[166:167], v4 offset:2440
  ds_read_b128 v[60:63], v6 offset:1472
  ds_read_b64 v[160:161], v4 offset:2496
  ds_read_b64 v[162:163], v4 offset:2504
  s_waitcnt lgkmcnt(15)
  v_mfma_f32_16x16x32_f16 v[224:227], v[188:191], v[32:35], 0
  ds_read_b128 v[32:35], v6 offset:1536
  v_mfma_f32_16x16x32_f16 v[224:227], v[184:187], v[36:39], v[224:227]
  ds_read_b128 v[36:39], v6 offset:1600
  v_mfma_f32_16x16x32_f16 v[224:227], v[180:183], v[40:43], v[224:227]
  ds_read_b128 v[40:43], v6 offset:1664
  s_waitcnt lgkmcnt(15)
  v_mfma_f32_16x16x32_f16 v[224:227], v[176:179], v[44:47], v[224:227]
  ds_read_b128 v[44:47], v6 offset:1728
  ds_read_b64 v[144:145], v4 offset:2752
  ds_read_b64 v[146:147], v4 offset:2760
  s_waitcnt lgkmcnt(15)
  v_mfma_f32_16x16x32_f16 v[224:227], v[172:175], v[48:51], v[224:227]
  ds_read_b128 v[48:51], v6 offset:1792
  ds_read_b64 v[140:141], v4 offset:2816
  ds_read_b64 v[142:143], v4 offset:2824
  s_waitcnt lgkmcnt(15)
  v_mfma_f32_16x16x32_f16 v[224:227], v[168:171], v[52:55], v[224:227]
  ds_read_b128 v[52:55], v6 offset:1856
  ds_read_b64 v[136:137], v4 offset:2880
  ds_read_b64 v[138:139], v4 offset:2888
  s_waitcnt lgkmcnt(15)
  v_mfma_f32_16x16x32_f16 v[224:227], v[164:167], v[56:59], v[224:227]
  ds_read_b128 v[56:59], v6 offset:1920
  ds_read_b64 v[132:133], v4 offset:2944
  ds_read_b64 v[134:135], v4 offset:2952
  s_waitcnt lgkmcnt(15)
  v_mfma_f32_16x16x32_f16 v[224:227], v[160:163], v[60:63], v[224:227]
  ds_read_b128 v[60:63], v6 offset:1984
  ds_read_b64 v[128:129], v4 offset:3008
  ds_read_b64 v[130:131], v4 offset:3016
  s_waitcnt lgkmcnt(15)
  v_mfma_f32_16x16x32_f16 v[224:227], v[156:159], v[32:35], v[224:227]
  ds_read_b128 v[32:35], v6 offset:2048
  v_mfma_f32_16x16x32_f16 v[224:227], v[152:155], v[36:39], v[224:227]
  ds_read_b128 v[36:39], v6 offset:2112
  v_mfma_f32_16x16x32_f16 v[224:227], v[148:151], v[40:43], v[224:227]
  ds_read_b128 v[40:43], v6 offset:2176
  s_waitcnt lgkmcnt(15)
  v_mfma_f32_16x16x32_f16 v[224:227], v[144:147], v[44:47], v[224:227]
  ds_read_b128 v[44:47], v6 offset:2240
  ds_read_b64 v[112:113], v4 offset:3264
  ds_read_b64 v[114:115], v4 offset:3272
  s_waitcnt lgkmcnt(15)
  v_mfma_f32_16x16x32_f16 v[224:227], v[140:143], v[48:51], v[224:227]
  ds_read_b128 v[48:51], v6 offset:2304
  ds_read_b64 v[108:109], v4 offset:3328
  ds_read_b64 v[110:111], v4 offset:3336
  s_waitcnt lgkmcnt(15)
  v_mfma_f32_16x16x32_f16 v[224:227], v[136:139], v[52:55], v[224:227]
  ds_read_b128 v[52:55], v6 offset:2368
  ds_read_b64 v[104:105], v4 offset:3392
  ds_read_b64 v[106:107], v4 offset:3400
  s_waitcnt lgkmcnt(15)
  v_mfma_f32_16x16x32_f16 v[224:227], v[132:135], v[56:59], v[224:227]
  ds_read_b128 v[56:59], v6 offset:2432
  ds_read_b64 v[100:101], v4 offset:3456
  ds_read_b64 v[102:103], v4 offset:3464
  s_waitcnt lgkmcnt(15)
  v_mfma_f32_16x16x32_f16 v[224:227], v[128:131], v[60:63], v[224:227]
  ds_read_b128 v[60:63], v6 offset:2496
  ds_read_b64 v[96:97], v4 offset:3520
  ds_read_b64 v[98:99], v4 offset:3528
  s_waitcnt lgkmcnt(15)
  v_mfma_f32_16x16x32_f16 v[224:227], v[124:127], v[32:35], v[224:227]
  ds_read_b128 v[32:35], v6 offset:2560
  v_mfma_f32_16x16x32_f16 v[224:227], v[120:123], v[36:39], v[224:227]
  ds_read_b128 v[36:39], v6 offset:2624
  v_mfma_f32_16x16x32_f16 v[224:227], v[116:119], v[40:43], v[224:227]
  ds_read_b128 v[40:43], v6 offset:2688
  s_waitcnt lgkmcnt(15)
  v_mfma_f32_16x16x32_f16 v[224:227], v[112:115], v[44:47], v[224:227]
  ds_read_b128 v[44:47], v6 offset:2752
  ds_read_b64 v[80:81], v4 offset:3776
  ds_read_b64 v[82:83], v4 offset:3784
  s_waitcnt lgkmcnt(15)
  v_mfma_f32_16x16x32_f16 v[224:227], v[108:111], v[48:51], v[224:227]
  ds_read_b128 v[48:51], v6 offset:2816
  ds_read_b64 v[76:77], v4 offset:3840
  ds_read_b64 v[78:79], v4 offset:3848
  s_waitcnt lgkmcnt(15)
  v_mfma_f32_16x16x32_f16 v[224:227], v[104:107], v[52:55], v[224:227]
  ds_read_b128 v[52:55], v6 offset:2880
  ds_read_b64 v[72:73], v4 offset:3904
  ds_read_b64 v[74:75], v4 offset:3912
  s_waitcnt lgkmcnt(15)
  v_mfma_f32_16x16x32_f16 v[224:227], v[100:103], v[56:59], v[224:227]
  ds_read_b128 v[56:59], v6 offset:2944
  ds_read_b64 v[68:69], v4 offset:3968
  ds_read_b64 v[70:71], v4 offset:3976
  s_waitcnt lgkmcnt(15)
  v_mfma_f32_16x16x32_f16 v[224:227], v[96:99], v[60:63], v[224:227]
  ds_read_b128 v[60:63], v6 offset:3008
  ds_read_b64 v[64:65], v4 offset:4032
  ds_read_b64 v[66:67], v4 offset:4040
  s_waitcnt lgkmcnt(15)
  v_mfma_f32_16x16x32_f16 v[224:227], v[92:95], v[32:35], v[224:227]
  v_mfma_f32_16x16x32_f16 v[224:227], v[88:91], v[36:39], v[224:227]
  v_mfma_f32_16x16x32_f16 v[224:227], v[84:87], v[40:43], v[224:227]
  s_waitcnt lgkmcnt(12)
  v_mfma_f32_16x16x32_f16 v[224:227], v[80:83], v[44:47], v[224:227]
  s_waitcnt lgkmcnt(9)
  v_mfma_f32_16x16x32_f16 v[224:227], v[76:79], v[48:51], v[224:227]
  s_waitcnt lgkmcnt(6)
  v_mfma_f32_16x16x32_f16 v[224:227], v[72:75], v[52:55], v[224:227]
  s_waitcnt lgkmcnt(3)
  v_mfma_f32_16x16x32_f16 v[224:227], v[68:71], v[56:59], v[224:227]
  s_waitcnt lgkmcnt(0)
  v_mfma_f32_16x16x32_f16 v[224:227], v[64:67], v[60:63], v[224:227]
  s_nop 7
M_CSP2:
  ds_read_b32 v40, v248 offset:236
  ds_read_b128 v[52:55], v8
  s_waitcnt lgkmcnt(0)
  v_readfirstlane_b32 s94, v40
  s_cmp_ge_u32 s94, 1
  s_cbranch_scc0 M_CSP2

  ds_read_b32 v40, v248 offset:40
  ds_read_b32 v41, v248 offset:56
  ds_read_b32 v42, v248 offset:72
  ds_read_b32 v43, v248 offset:88
  ds_read_b64 v[44:45], v3 offset:11776
  v_and_b32 v16, 15, v2
  v_mul_u32_u24 v16, 96, v16
  v_lshrrev_b32 v17, 5, v2
  v_mul_u32_u24 v17, 48, v17
  v_bfe_u32 v18, v2, 4, 1
  v_lshl_add_u32 v17, v18, 3, v17
  v_add_u32 v16, v16, v17
  v_add_u32 v16, 69152, v16

  v_add_f32 v224, v224, v52
  v_add_f32 v225, v225, v53
  v_add_f32 v226, v226, v54
  v_add_f32 v227, v227, v55
  s_waitcnt lgkmcnt(0)
  v_ldexp_f32 v43, v43, v42
  v_mul_f32 v224, v43, v224
  v_mul_f32 v225, v43, v225
  v_mul_f32 v226, v43, v226
  v_mul_f32 v227, v43, v227
  v_fma_mix_f32 v48, v44, v40, 0 op_sel:[0,0,0] op_sel_hi:[1,0,0]
  v_fma_mix_f32 v49, v44, v40, 0 op_sel:[1,0,0] op_sel_hi:[1,0,0]
  v_fma_mix_f32 v50, v45, v40, 0 op_sel:[0,0,0] op_sel_hi:[1,0,0]
  v_fma_mix_f32 v51, v45, v40, 0 op_sel:[1,0,0] op_sel_hi:[1,0,0]
  v_cvt_pk_bf16_f32 v225, v224, v225
  v_cvt_pk_bf16_f32 v227, v226, v227
  v_cvt_pk_bf16_f32 v49, v48, v49
  v_cvt_pk_bf16_f32 v51, v50, v51
  v_lshlrev_b32 v224, 16, v225
  v_and_b32 v225, 0xffff0000, v225
  v_lshlrev_b32 v226, 16, v227
  v_and_b32 v227, 0xffff0000, v227
  v_lshlrev_b32 v48, 16, v49
  v_and_b32 v49, 0xffff0000, v49
  v_lshlrev_b32 v50, 16, v51
  v_and_b32 v51, 0xffff0000, v51
  v_add_f32 v224, v224, v48
  v_add_f32 v225, v225, v49
  v_add_f32 v226, v226, v50
  v_add_f32 v227, v227, v51
  v_cvt_pk_bf16_f32 v225, v224, v225
  v_cvt_pk_bf16_f32 v227, v226, v227
  v_lshlrev_b32 v224, 16, v225
  v_and_b32 v225, 0xffff0000, v225
  v_lshlrev_b32 v226, 16, v227
  v_and_b32 v227, 0xffff0000, v227
  v_mul_f32 v224, v41, v224
  v_mul_f32 v225, v41, v225
  v_mul_f32 v226, v41, v226
  v_mul_f32 v227, v41, v227
  v_cvt_pk_bf16_f32 v48, v224, v225
  v_cvt_pk_bf16_f32 v49, v226, v227
  ds_write_b64 v16, v[48:49] offset:7680
  s_branch M_FIN
M_RUNP3:
M_HSP3:
  ds_read_b32 v251, v248 offset:240
  ds_read_b32 v15, v248 offset:196
  s_waitcnt lgkmcnt(0)
  v_readfirstlane_b32 s94, v251
  v_readfirstlane_b32 s38, v15
  s_cmp_ge_u32 s94, 8
  s_cbranch_scc0 M_HSP3

  v_lshlrev_b32 v8, 4, v2
  v_add_u32 v8, 16896, v8
  ds_read_b128 v[32:35], v6 offset:512
  ds_read_b128 v[36:39], v6 offset:576
  ds_read_b128 v[40:43], v6 offset:640
  ds_read_b128 v[44:47], v6 offset:704
  ds_read_b64 v[176:177], v4 offset:2240
  ds_read_b64 v[178:179], v4 offset:2248
  ds_read_b128 v[48:51], v6 offset:768
  ds_read_b64 v[172:173], v4 offset:2304
  ds_read_b64 v[174:175], v4 offset:2312
  ds_read_b128 v[52:55], v6 offset:832
  ds_read_b64 v[168:169], v4 offset:2368
  ds_read_b64 v[170:171], v4 offset:2376
  ds_read_b128 v[56:59], v6 offset:896
  ds_read_b64 v[164:165], v4 offset:2432
  ds_read_b64 v[166:167], v4 offset:2440
  ds_read_b128 v[60:63], v6 offset:960
  ds_read_b64 v[160:161], v4 offset:2496
  ds_read_b64 v[162:163], v4 offset:2504
  s_waitcnt lgkmcnt(15)
  v_mfma_f32_16x16x32_f16 v[224:227], v[188:191], v[32:35], 0
  ds_read_b128 v[32:35], v6 offset:1024
  v_mfma_f32_16x16x32_f16 v[224:227], v[184:187], v[36:39], v[224:227]
  ds_read_b128 v[36:39], v6 offset:1088
  v_mfma_f32_16x16x32_f16 v[224:227], v[180:183], v[40:43], v[224:227]
  ds_read_b128 v[40:43], v6 offset:1152
  s_waitcnt lgkmcnt(15)
  v_mfma_f32_16x16x32_f16 v[224:227], v[176:179], v[44:47], v[224:227]
  ds_read_b128 v[44:47], v6 offset:1216
  ds_read_b64 v[144:145], v4 offset:2752
  ds_read_b64 v[146:147], v4 offset:2760
  s_waitcnt lgkmcnt(15)
  v_mfma_f32_16x16x32_f16 v[224:227], v[172:175], v[48:51], v[224:227]
  ds_read_b128 v[48:51], v6 offset:1280
  ds_read_b64 v[140:141], v4 offset:2816
  ds_read_b64 v[142:143], v4 offset:2824
  s_waitcnt lgkmcnt(15)
  v_mfma_f32_16x16x32_f16 v[224:227], v[168:171], v[52:55], v[224:227]
  ds_read_b128 v[52:55], v6 offset:1344
  ds_read_b64 v[136:137], v4 offset:2880
  ds_read_b64 v[138:139], v4 offset:2888
  s_waitcnt lgkmcnt(15)
  v_mfma_f32_16x16x32_f16 v[224:227], v[164:167], v[56:59], v[224:227]
  ds_read_b128 v[56:59], v6 offset:1408
  ds_read_b64 v[132:133], v4 offset:2944
  ds_read_b64 v[134:135], v4 offset:2952
  s_waitcnt lgkmcnt(15)
  v_mfma_f32_16x16x32_f16 v[224:227], v[160:163], v[60:63], v[224:227]
  ds_read_b128 v[60:63], v6 offset:1472
  ds_read_b64 v[128:129], v4 offset:3008
  ds_read_b64 v[130:131], v4 offset:3016
  s_waitcnt lgkmcnt(15)
  v_mfma_f32_16x16x32_f16 v[224:227], v[156:159], v[32:35], v[224:227]
  ds_read_b128 v[32:35], v6 offset:1536
  v_mfma_f32_16x16x32_f16 v[224:227], v[152:155], v[36:39], v[224:227]
  ds_read_b128 v[36:39], v6 offset:1600
  v_mfma_f32_16x16x32_f16 v[224:227], v[148:151], v[40:43], v[224:227]
  ds_read_b128 v[40:43], v6 offset:1664
  s_waitcnt lgkmcnt(15)
  v_mfma_f32_16x16x32_f16 v[224:227], v[144:147], v[44:47], v[224:227]
  ds_read_b128 v[44:47], v6 offset:1728
  ds_read_b64 v[112:113], v4 offset:3264
  ds_read_b64 v[114:115], v4 offset:3272
  s_waitcnt lgkmcnt(15)
  v_mfma_f32_16x16x32_f16 v[224:227], v[140:143], v[48:51], v[224:227]
  ds_read_b128 v[48:51], v6 offset:1792
  ds_read_b64 v[108:109], v4 offset:3328
  ds_read_b64 v[110:111], v4 offset:3336
  s_waitcnt lgkmcnt(15)
  v_mfma_f32_16x16x32_f16 v[224:227], v[136:139], v[52:55], v[224:227]
  ds_read_b128 v[52:55], v6 offset:1856
  ds_read_b64 v[104:105], v4 offset:3392
  ds_read_b64 v[106:107], v4 offset:3400
  s_waitcnt lgkmcnt(15)
  v_mfma_f32_16x16x32_f16 v[224:227], v[132:135], v[56:59], v[224:227]
  ds_read_b128 v[56:59], v6 offset:1920
  ds_read_b64 v[100:101], v4 offset:3456
  ds_read_b64 v[102:103], v4 offset:3464
  s_waitcnt lgkmcnt(15)
  v_mfma_f32_16x16x32_f16 v[224:227], v[128:131], v[60:63], v[224:227]
  ds_read_b128 v[60:63], v6 offset:1984
  ds_read_b64 v[96:97], v4 offset:3520
  ds_read_b64 v[98:99], v4 offset:3528
  s_waitcnt lgkmcnt(15)
  v_mfma_f32_16x16x32_f16 v[224:227], v[124:127], v[32:35], v[224:227]
  ds_read_b128 v[32:35], v6 offset:2048
  v_mfma_f32_16x16x32_f16 v[224:227], v[120:123], v[36:39], v[224:227]
  ds_read_b128 v[36:39], v6 offset:2112
  v_mfma_f32_16x16x32_f16 v[224:227], v[116:119], v[40:43], v[224:227]
  ds_read_b128 v[40:43], v6 offset:2176
  s_waitcnt lgkmcnt(15)
  v_mfma_f32_16x16x32_f16 v[224:227], v[112:115], v[44:47], v[224:227]
  ds_read_b128 v[44:47], v6 offset:2240
  ds_read_b64 v[80:81], v4 offset:3776
  ds_read_b64 v[82:83], v4 offset:3784
  s_waitcnt lgkmcnt(15)
  v_mfma_f32_16x16x32_f16 v[224:227], v[108:111], v[48:51], v[224:227]
  ds_read_b128 v[48:51], v6 offset:2304
  ds_read_b64 v[76:77], v4 offset:3840
  ds_read_b64 v[78:79], v4 offset:3848
  s_waitcnt lgkmcnt(15)
  v_mfma_f32_16x16x32_f16 v[224:227], v[104:107], v[52:55], v[224:227]
  ds_read_b128 v[52:55], v6 offset:2368
  ds_read_b64 v[72:73], v4 offset:3904
  ds_read_b64 v[74:75], v4 offset:3912
  s_waitcnt lgkmcnt(15)
  v_mfma_f32_16x16x32_f16 v[224:227], v[100:103], v[56:59], v[224:227]
  ds_read_b128 v[56:59], v6 offset:2432
  ds_read_b64 v[68:69], v4 offset:3968
  ds_read_b64 v[70:71], v4 offset:3976
  s_waitcnt lgkmcnt(15)
  v_mfma_f32_16x16x32_f16 v[224:227], v[96:99], v[60:63], v[224:227]
  ds_read_b128 v[60:63], v6 offset:2496
  ds_read_b64 v[64:65], v4 offset:4032
  ds_read_b64 v[66:67], v4 offset:4040
  s_waitcnt lgkmcnt(15)
  v_mfma_f32_16x16x32_f16 v[224:227], v[92:95], v[32:35], v[224:227]
  v_mfma_f32_16x16x32_f16 v[224:227], v[88:91], v[36:39], v[224:227]
  v_mfma_f32_16x16x32_f16 v[224:227], v[84:87], v[40:43], v[224:227]
  s_waitcnt lgkmcnt(12)
  v_mfma_f32_16x16x32_f16 v[224:227], v[80:83], v[44:47], v[224:227]
  s_waitcnt lgkmcnt(9)
  v_mfma_f32_16x16x32_f16 v[224:227], v[76:79], v[48:51], v[224:227]
  s_waitcnt lgkmcnt(6)
  v_mfma_f32_16x16x32_f16 v[224:227], v[72:75], v[52:55], v[224:227]
  s_waitcnt lgkmcnt(3)
  v_mfma_f32_16x16x32_f16 v[224:227], v[68:71], v[56:59], v[224:227]
  s_waitcnt lgkmcnt(0)
  v_mfma_f32_16x16x32_f16 v[224:227], v[64:67], v[60:63], v[224:227]
  s_nop 7
M_CSP3:
  ds_read_b32 v40, v248 offset:236
  ds_read_b128 v[52:55], v8
  s_waitcnt lgkmcnt(0)
  v_readfirstlane_b32 s94, v40
  s_cmp_ge_u32 s94, 1
  s_cbranch_scc0 M_CSP3

  ds_read_b32 v40, v248 offset:40
  ds_read_b32 v41, v248 offset:56
  ds_read_b32 v42, v248 offset:72
  ds_read_b32 v43, v248 offset:88
  ds_read_b64 v[44:45], v3 offset:11264
  v_and_b32 v16, 15, v2
  v_mul_u32_u24 v16, 96, v16
  v_lshrrev_b32 v17, 5, v2
  v_mul_u32_u24 v17, 48, v17
  v_bfe_u32 v18, v2, 4, 1
  v_lshl_add_u32 v17, v18, 3, v17
  v_add_u32 v16, v16, v17
  v_add_u32 v16, 69152, v16

  v_add_f32 v224, v224, v52
  v_add_f32 v225, v225, v53
  v_add_f32 v226, v226, v54
  v_add_f32 v227, v227, v55
  s_waitcnt lgkmcnt(0)
  v_ldexp_f32 v43, v43, v42
  v_mul_f32 v224, v43, v224
  v_mul_f32 v225, v43, v225
  v_mul_f32 v226, v43, v226
  v_mul_f32 v227, v43, v227
  v_fma_mix_f32 v48, v44, v40, 0 op_sel:[0,0,0] op_sel_hi:[1,0,0]
  v_fma_mix_f32 v49, v44, v40, 0 op_sel:[1,0,0] op_sel_hi:[1,0,0]
  v_fma_mix_f32 v50, v45, v40, 0 op_sel:[0,0,0] op_sel_hi:[1,0,0]
  v_fma_mix_f32 v51, v45, v40, 0 op_sel:[1,0,0] op_sel_hi:[1,0,0]
  v_cvt_pk_bf16_f32 v225, v224, v225
  v_cvt_pk_bf16_f32 v227, v226, v227
  v_cvt_pk_bf16_f32 v49, v48, v49
  v_cvt_pk_bf16_f32 v51, v50, v51
  v_lshlrev_b32 v224, 16, v225
  v_and_b32 v225, 0xffff0000, v225
  v_lshlrev_b32 v226, 16, v227
  v_and_b32 v227, 0xffff0000, v227
  v_lshlrev_b32 v48, 16, v49
  v_and_b32 v49, 0xffff0000, v49
  v_lshlrev_b32 v50, 16, v51
  v_and_b32 v51, 0xffff0000, v51
  v_add_f32 v224, v224, v48
  v_add_f32 v225, v225, v49
  v_add_f32 v226, v226, v50
  v_add_f32 v227, v227, v51
  v_cvt_pk_bf16_f32 v225, v224, v225
  v_cvt_pk_bf16_f32 v227, v226, v227
  v_lshlrev_b32 v224, 16, v225
  v_and_b32 v225, 0xffff0000, v225
  v_lshlrev_b32 v226, 16, v227
  v_and_b32 v227, 0xffff0000, v227
  v_mul_f32 v224, v41, v224
  v_mul_f32 v225, v41, v225
  v_mul_f32 v226, v41, v226
  v_mul_f32 v227, v41, v227
  v_cvt_pk_bf16_f32 v48, v224, v225
  v_cvt_pk_bf16_f32 v49, v226, v227
  ds_write_b64 v16, v[48:49] offset:6144
  s_branch M_FIN
M_RUNQ0:
M_HSQ0:
  ds_read_b32 v251, v248 offset:240
  ds_read_b32 v15, v248 offset:196
  s_waitcnt lgkmcnt(0)
  v_readfirstlane_b32 s94, v251
  v_readfirstlane_b32 s38, v15
  s_cmp_ge_u32 s94, 8
  s_cbranch_scc0 M_HSQ0

  v_lshlrev_b32 v8, 4, v2
  v_add_u32 v8, 16896, v8
  ds_read_b128 v[96:99], v6 offset:432
  ds_read_b128 v[100:103], v6 offset:416
  ds_read_b128 v[104:107], v6 offset:944
  ds_read_b128 v[108:111], v6 offset:928
  ds_read_b128 v[112:115], v6 offset:1456
  ds_read_b128 v[116:119], v6 offset:1440
  ds_read_b128 v[120:123], v6 offset:1968
  ds_read_b128 v[124:127], v6 offset:1952
  ds_read_b128 v[128:131], v6 offset:1984
  s_waitcnt vmcnt(0)
  s_waitcnt lgkmcnt(7)
  v_mfma_f32_16x16x32_f16 v[32:35], v[96:99], v[192:195], 0
  v_mfma_f32_16x16x32_f16 v[36:39], v[100:103], v[196:199], 0
  s_waitcnt lgkmcnt(5)
  v_mfma_f32_16x16x32_f16 v[40:43], v[104:107], v[192:195], 0
  v_mfma_f32_16x16x32_f16 v[44:47], v[108:111], v[196:199], 0
  s_waitcnt lgkmcnt(3)
  v_mfma_f32_16x16x32_f16 v[48:51], v[112:115], v[192:195], 0
  v_mfma_f32_16x16x32_f16 v[52:55], v[116:119], v[196:199], 0
  s_waitcnt lgkmcnt(1)
  v_mfma_f32_16x16x32_f16 v[56:59], v[120:123], v[192:195], 0
  v_mfma_f32_16x16x32_f16 v[60:63], v[124:127], v[196:199], 0
  s_waitcnt lgkmcnt(0)
  v_mfma_f32_16x16x32_f16 v[224:227], v[216:219], v[128:131], 0
  s_nop 0
  v_cvt_pk_f16_f32 v32, v32, v33
  v_cvt_pk_f16_f32 v33, v34, v35
  v_cvt_pk_f16_f32 v34, v36, v37
  v_cvt_pk_f16_f32 v35, v38, v39
  v_cvt_pk_f16_f32 v40, v40, v41
  v_cvt_pk_f16_f32 v41, v42, v43
  v_cvt_pk_f16_f32 v42, v44, v45
  v_cvt_pk_f16_f32 v43, v46, v47
  v_cvt_pk_f16_f32 v48, v48, v49
  v_cvt_pk_f16_f32 v49, v50, v51
  v_cvt_pk_f16_f32 v50, v52, v53
  v_cvt_pk_f16_f32 v51, v54, v55
  s_nop 2
  v_cvt_pk_f16_f32 v56, v56, v57
  v_cvt_pk_f16_f32 v57, v58, v59
  v_cvt_pk_f16_f32 v58, v60, v61
  v_cvt_pk_f16_f32 v59, v62, v63
  s_nop 1
  v_mfma_f32_16x16x32_f16 v[224:227], v[32:35], v[212:215], v[224:227]
  v_mfma_f32_16x16x32_f16 v[224:227], v[40:43], v[208:211], v[224:227]
  v_mfma_f32_16x16x32_f16 v[224:227], v[48:51], v[204:207], v[224:227]
  v_mfma_f32_16x16x32_f16 v[224:227], v[56:59], v[200:203], v[224:227]
  ds_read_b128 v[32:35], v6 offset:0
  ds_read_b128 v[36:39], v6 offset:64
  ds_read_b128 v[40:43], v6 offset:128
  ds_read_b128 v[44:47], v6 offset:192
  ds_read_b64 v[80:81], v4 offset:3776
  ds_read_b64 v[82:83], v4 offset:3784
  ds_read_b128 v[48:51], v6 offset:256
  ds_read_b64 v[76:77], v4 offset:3840
  ds_read_b64 v[78:79], v4 offset:3848
  ds_read_b128 v[52:55], v6 offset:320
  ds_read_b64 v[72:73], v4 offset:3904
  ds_read_b64 v[74:75], v4 offset:3912
  ds_read_b128 v[56:59], v6 offset:384
  ds_read_b64 v[68:69], v4 offset:3968
  ds_read_b64 v[70:71], v4 offset:3976
  ds_read_b128 v[60:63], v6 offset:448
  ds_read_b64 v[64:65], v4 offset:4032
  ds_read_b64 v[66:67], v4 offset:4040
  s_waitcnt lgkmcnt(15)
  v_mfma_f32_16x16x32_f16 v[228:231], v[92:95], v[32:35], 0
  v_mfma_f32_16x16x32_f16 v[228:231], v[88:91], v[36:39], v[228:231]
  v_mfma_f32_16x16x32_f16 v[228:231], v[84:87], v[40:43], v[228:231]
  s_waitcnt lgkmcnt(12)
  v_mfma_f32_16x16x32_f16 v[228:231], v[80:83], v[44:47], v[228:231]
  s_waitcnt lgkmcnt(9)
  v_mfma_f32_16x16x32_f16 v[228:231], v[76:79], v[48:51], v[228:231]
  s_waitcnt lgkmcnt(6)
  v_mfma_f32_16x16x32_f16 v[228:231], v[72:75], v[52:55], v[228:231]
  s_waitcnt lgkmcnt(3)
  v_mfma_f32_16x16x32_f16 v[228:231], v[68:71], v[56:59], v[228:231]
  s_waitcnt lgkmcnt(0)
  v_mfma_f32_16x16x32_f16 v[228:231], v[64:67], v[60:63], v[228:231]
  s_nop 7
  ds_write_b128 v8, v[224:227]
  s_mov_b64 exec, 1
  ds_add_u32 v248, v249 offset:236
  s_mov_b64 exec, -1
  ds_read_b32 v40, v248 offset:40
  ds_read_b32 v41, v248 offset:56
  ds_read_b32 v42, v248 offset:72
  ds_read_b32 v43, v248 offset:88
  ds_read_b64 v[44:45], v3 offset:9216
  v_and_b32 v16, 15, v2
  v_mul_u32_u24 v16, 96, v16
  v_lshrrev_b32 v17, 5, v2
  v_mul_u32_u24 v17, 48, v17
  v_bfe_u32 v18, v2, 4, 1
  v_lshl_add_u32 v17, v18, 3, v17
  v_add_u32 v16, v16, v17
  v_add_u32 v16, 69152, v16

  s_waitcnt lgkmcnt(0)
  v_ldexp_f32 v43, v43, v42
  v_mul_f32 v228, v43, v228
  v_mul_f32 v229, v43, v229
  v_mul_f32 v230, v43, v230
  v_mul_f32 v231, v43, v231
  v_fma_mix_f32 v48, v44, v40, 0 op_sel:[0,0,0] op_sel_hi:[1,0,0]
  v_fma_mix_f32 v49, v44, v40, 0 op_sel:[1,0,0] op_sel_hi:[1,0,0]
  v_fma_mix_f32 v50, v45, v40, 0 op_sel:[0,0,0] op_sel_hi:[1,0,0]
  v_fma_mix_f32 v51, v45, v40, 0 op_sel:[1,0,0] op_sel_hi:[1,0,0]
  v_cvt_pk_bf16_f32 v229, v228, v229
  v_cvt_pk_bf16_f32 v231, v230, v231
  v_cvt_pk_bf16_f32 v49, v48, v49
  v_cvt_pk_bf16_f32 v51, v50, v51
  v_lshlrev_b32 v228, 16, v229
  v_and_b32 v229, 0xffff0000, v229
  v_lshlrev_b32 v230, 16, v231
  v_and_b32 v231, 0xffff0000, v231
  v_lshlrev_b32 v48, 16, v49
  v_and_b32 v49, 0xffff0000, v49
  v_lshlrev_b32 v50, 16, v51
  v_and_b32 v51, 0xffff0000, v51
  v_add_f32 v228, v228, v48
  v_add_f32 v229, v229, v49
  v_add_f32 v230, v230, v50
  v_add_f32 v231, v231, v51
  v_cvt_pk_bf16_f32 v229, v228, v229
  v_cvt_pk_bf16_f32 v231, v230, v231
  v_lshlrev_b32 v228, 16, v229
  v_and_b32 v229, 0xffff0000, v229
  v_lshlrev_b32 v230, 16, v231
  v_and_b32 v231, 0xffff0000, v231
  v_mul_f32 v228, v41, v228
  v_mul_f32 v229, v41, v229
  v_mul_f32 v230, v41, v230
  v_mul_f32 v231, v41, v231
  v_cvt_pk_bf16_f32 v48, v228, v229
  v_cvt_pk_bf16_f32 v49, v230, v231
  ds_write_b64 v16, v[48:49] offset:0
  s_branch M_FIN
M_RUNQ1:
M_HSQ1:
  ds_read_b32 v251, v248 offset:240
  ds_read_b32 v15, v248 offset:196
  s_waitcnt lgkmcnt(0)
  v_readfirstlane_b32 s94, v251
  v_readfirstlane_b32 s38, v15
  s_cmp_ge_u32 s94, 8
  s_cbranch_scc0 M_HSQ1

  v_lshlrev_b32 v8, 4, v2
  v_add_u32 v8, 16896, v8
  ds_read_b128 v[128:131], v6 offset:432
  ds_read_b128 v[132:135], v6 offset:416
  ds_read_b128 v[136:139], v6 offset:944
  ds_read_b128 v[140:143], v6 offset:928
  ds_read_b128 v[144:147], v6 offset:1456
  ds_read_b128 v[148:151], v6 offset:1440
  ds_read_b128 v[152:155], v6 offset:1472
  s_waitcnt vmcnt(0)
  s_waitcnt lgkmcnt(5)
  v_mfma_f32_16x16x32_f16 v[32:35], v[128:131], v[192:195], 0
  v_mfma_f32_16x16x32_f16 v[36:39], v[132:135], v[196:199], 0
  s_waitcnt lgkmcnt(3)
  v_mfma_f32_16x16x32_f16 v[40:43], v[136:139], v[192:195], 0
  v_mfma_f32_16x16x32_f16 v[44:47], v[140:143], v[196:199], 0
  s_waitcnt lgkmcnt(1)
  v_mfma_f32_16x16x32_f16 v[48:51], v[144:147], v[192:195], 0
  v_mfma_f32_16x16x32_f16 v[52:55], v[148:151], v[196:199], 0
  s_waitcnt lgkmcnt(0)
  v_mfma_f32_16x16x32_f16 v[224:227], v[216:219], v[152:155], 0
  s_nop 2
  v_cvt_pk_f16_f32 v32, v32, v33
  v_cvt_pk_f16_f32 v33, v34, v35
  v_cvt_pk_f16_f32 v34, v36, v37
  v_cvt_pk_f16_f32 v35, v38, v39
  v_cvt_pk_f16_f32 v40, v40, v41
  v_cvt_pk_f16_f32 v41, v42, v43
  v_cvt_pk_f16_f32 v42, v44, v45
  v_cvt_pk_f16_f32 v43, v46, v47
  s_nop 2
  v_cvt_pk_f16_f32 v48, v48, v49
  v_cvt_pk_f16_f32 v49, v50, v51
  v_cvt_pk_f16_f32 v50, v52, v53
  v_cvt_pk_f16_f32 v51, v54, v55
  s_nop 1
  v_mfma_f32_16x16x32_f16 v[224:227], v[32:35], v[208:211], v[224:227]
  v_mfma_f32_16x16x32_f16 v[224:227], v[40:43], v[204:207], v[224:227]
  v_mfma_f32_16x16x32_f16 v[224:227], v[48:51], v[200:203], v[224:227]
  ds_read_b128 v[32:35], v6 offset:0
  ds_read_b128 v[36:39], v6 offset:64
  ds_read_b128 v[40:43], v6 offset:128
  ds_read_b128 v[44:47], v6 offset:192
  ds_read_b64 v[112:113], v4 offset:3264
  ds_read_b64 v[114:115], v4 offset:3272
  ds_read_b128 v[48:51], v6 offset:256
  ds_read_b64 v[108:109], v4 offset:3328
  ds_read_b64 v[110:111], v4 offset:3336
  ds_read_b128 v[52:55], v6 offset:320
  ds_read_b64 v[104:105], v4 offset:3392
  ds_read_b64 v[106:107], v4 offset:3400
  ds_read_b128 v[56:59], v6 offset:384
  ds_read_b64 v[100:101], v4 offset:3456
  ds_read_b64 v[102:103], v4 offset:3464
  ds_read_b128 v[60:63], v6 offset:448
  ds_read_b64 v[96:97], v4 offset:3520
  ds_read_b64 v[98:99], v4 offset:3528
  s_waitcnt lgkmcnt(15)
  v_mfma_f32_16x16x32_f16 v[228:231], v[124:127], v[32:35], 0
  ds_read_b128 v[32:35], v6 offset:512
  v_mfma_f32_16x16x32_f16 v[228:231], v[120:123], v[36:39], v[228:231]
  ds_read_b128 v[36:39], v6 offset:576
  v_mfma_f32_16x16x32_f16 v[228:231], v[116:119], v[40:43], v[228:231]
  ds_read_b128 v[40:43], v6 offset:640
  s_waitcnt lgkmcnt(15)
  v_mfma_f32_16x16x32_f16 v[228:231], v[112:115], v[44:47], v[228:231]
  ds_read_b128 v[44:47], v6 offset:704
  ds_read_b64 v[80:81], v4 offset:3776
  ds_read_b64 v[82:83], v4 offset:3784
  s_waitcnt lgkmcnt(15)
  v_mfma_f32_16x16x32_f16 v[228:231], v[108:111], v[48:51], v[228:231]
  ds_read_b128 v[48:51], v6 offset:768
  ds_read_b64 v[76:77], v4 offset:3840
  ds_read_b64 v[78:79], v4 offset:3848
  s_waitcnt lgkmcnt(15)
  v_mfma_f32_16x16x32_f16 v[228:231], v[104:107], v[52:55], v[228:231]
  ds_read_b128 v[52:55], v6 offset:832
  ds_read_b64 v[72:73], v4 offset:3904
  ds_read_b64 v[74:75], v4 offset:3912
  s_waitcnt lgkmcnt(15)
  v_mfma_f32_16x16x32_f16 v[228:231], v[100:103], v[56:59], v[228:231]
  ds_read_b128 v[56:59], v6 offset:896
  ds_read_b64 v[68:69], v4 offset:3968
  ds_read_b64 v[70:71], v4 offset:3976
  s_waitcnt lgkmcnt(15)
  v_mfma_f32_16x16x32_f16 v[228:231], v[96:99], v[60:63], v[228:231]
  ds_read_b128 v[60:63], v6 offset:960
  ds_read_b64 v[64:65], v4 offset:4032
  ds_read_b64 v[66:67], v4 offset:4040
  s_waitcnt lgkmcnt(15)
  v_mfma_f32_16x16x32_f16 v[228:231], v[92:95], v[32:35], v[228:231]
  ds_write_b128 v8, v[224:227]
  s_mov_b64 exec, 1
  ds_add_u32 v248, v249 offset:236
  s_mov_b64 exec, -1
  v_mfma_f32_16x16x32_f16 v[228:231], v[88:91], v[36:39], v[228:231]
  v_mfma_f32_16x16x32_f16 v[228:231], v[84:87], v[40:43], v[228:231]
  s_waitcnt lgkmcnt(14)
  v_mfma_f32_16x16x32_f16 v[228:231], v[80:83], v[44:47], v[228:231]
  s_waitcnt lgkmcnt(11)
  v_mfma_f32_16x16x32_f16 v[228:231], v[76:79], v[48:51], v[228:231]
  s_waitcnt lgkmcnt(8)
  v_mfma_f32_16x16x32_f16 v[228:231], v[72:75], v[52:55], v[228:231]
  s_waitcnt lgkmcnt(5)
  v_mfma_f32_16x16x32_f16 v[228:231], v[68:71], v[56:59], v[228:231]
  s_waitcnt lgkmcnt(2)
  v_mfma_f32_16x16x32_f16 v[228:231], v[64:67], v[60:63], v[228:231]
  s_nop 7
  ds_read_b32 v40, v248 offset:40
  ds_read_b32 v41, v248 offset:56
  ds_read_b32 v42, v248 offset:72
  ds_read_b32 v43, v248 offset:88
  ds_read_b64 v[44:45], v3 offset:9728
  v_and_b32 v16, 15, v2
  v_mul_u32_u24 v16, 96, v16
  v_lshrrev_b32 v17, 5, v2
  v_mul_u32_u24 v17, 48, v17
  v_bfe_u32 v18, v2, 4, 1
  v_lshl_add_u32 v17, v18, 3, v17
  v_add_u32 v16, v16, v17
  v_add_u32 v16, 69152, v16

  s_waitcnt lgkmcnt(0)
  v_ldexp_f32 v43, v43, v42
  v_mul_f32 v228, v43, v228
  v_mul_f32 v229, v43, v229
  v_mul_f32 v230, v43, v230
  v_mul_f32 v231, v43, v231
  v_fma_mix_f32 v48, v44, v40, 0 op_sel:[0,0,0] op_sel_hi:[1,0,0]
  v_fma_mix_f32 v49, v44, v40, 0 op_sel:[1,0,0] op_sel_hi:[1,0,0]
  v_fma_mix_f32 v50, v45, v40, 0 op_sel:[0,0,0] op_sel_hi:[1,0,0]
  v_fma_mix_f32 v51, v45, v40, 0 op_sel:[1,0,0] op_sel_hi:[1,0,0]
  v_cvt_pk_bf16_f32 v229, v228, v229
  v_cvt_pk_bf16_f32 v231, v230, v231
  v_cvt_pk_bf16_f32 v49, v48, v49
  v_cvt_pk_bf16_f32 v51, v50, v51
  v_lshlrev_b32 v228, 16, v229
  v_and_b32 v229, 0xffff0000, v229
  v_lshlrev_b32 v230, 16, v231
  v_and_b32 v231, 0xffff0000, v231
  v_lshlrev_b32 v48, 16, v49
  v_and_b32 v49, 0xffff0000, v49
  v_lshlrev_b32 v50, 16, v51
  v_and_b32 v51, 0xffff0000, v51
  v_add_f32 v228, v228, v48
  v_add_f32 v229, v229, v49
  v_add_f32 v230, v230, v50
  v_add_f32 v231, v231, v51
  v_cvt_pk_bf16_f32 v229, v228, v229
  v_cvt_pk_bf16_f32 v231, v230, v231
  v_lshlrev_b32 v228, 16, v229
  v_and_b32 v229, 0xffff0000, v229
  v_lshlrev_b32 v230, 16, v231
  v_and_b32 v231, 0xffff0000, v231
  v_mul_f32 v228, v41, v228
  v_mul_f32 v229, v41, v229
  v_mul_f32 v230, v41, v230
  v_mul_f32 v231, v41, v231
  v_cvt_pk_bf16_f32 v48, v228, v229
  v_cvt_pk_bf16_f32 v49, v230, v231
  ds_write_b64 v16, v[48:49] offset:1536
  s_branch M_FIN
M_RUNQ2:
M_HSQ2:
  ds_read_b32 v251, v248 offset:240
  ds_read_b32 v15, v248 offset:196
  s_waitcnt lgkmcnt(0)
  v_readfirstlane_b32 s94, v251
  v_readfirstlane_b32 s38, v15
  s_cmp_ge_u32 s94, 8
  s_cbranch_scc0 M_HSQ2

  v_lshlrev_b32 v8, 4, v2
  v_add_u32 v8, 16896, v8
  ds_read_b128 v[160:163], v6 offset:432
  ds_read_b128 v[164:167], v6 offset:416
  ds_read_b128 v[168:171], v6 offset:944
  ds_read_b128 v[172:175], v6 offset:928
  ds_read_b128 v[176:179], v6 offset:960
  s_waitcnt vmcnt(0)
  s_waitcnt lgkmcnt(3)
  v_mfma_f32_16x16x32_f16 v[32:35], v[160:163], v[192:195], 0
  v_mfma_f32_16x16x32_f16 v[36:39], v[164:167], v[196:199], 0
  s_waitcnt lgkmcnt(1)
  v_mfma_f32_16x16x32_f16 v[40:43], v[168:171], v[192:195], 0
  v_mfma_f32_16x16x32_f16 v[44:47], v[172:175], v[196:199], 0
  s_waitcnt lgkmcnt(0)
  v_mfma_f32_16x16x32_f16 v[224:227], v[216:219], v[176:179], 0
  s_nop 4
  v_cvt_pk_f16_f32 v32, v32, v33
  v_cvt_pk_f16_f32 v33, v34, v35
  v_cvt_pk_f16_f32 v34, v36, v37
  v_cvt_pk_f16_f32 v35, v38, v39
  s_nop 2
  v_cvt_pk_f16_f32 v40, v40, v41
  v_cvt_pk_f16_f32 v41, v42, v43
  v_cvt_pk_f16_f32 v42, v44, v45
  v_cvt_pk_f16_f32 v43, v46, v47
  s_nop 1
  v_mfma_f32_16x16x32_f16 v[224:227], v[32:35], v[204:207], v[224:227]
  v_mfma_f32_16x16x32_f16 v[224:227], v[40:43], v[200:203], v[224:227]
  ds_read_b128 v[32:35], v6 offset:0
  ds_read_b128 v[36:39], v6 offset:64
  ds_read_b128 v[40:43], v6 offset:128
  ds_read_b128 v[44:47], v6 offset:192
  ds_read_b64 v[144:145], v4 offset:2752
  ds_read_b64 v[146:147], v4 offset:2760
  ds_read_b128 v[48:51], v6 offset:256
  ds_read_b64 v[140:141], v4 offset:2816
  ds_read_b64 v[142:143], v4 offset:2824
  ds_read_b128 v[52:55], v6 offset:320
  ds_read_b64 v[136:137], v4 offset:2880
  ds_read_b64 v[138:139], v4 offset:2888
  ds_read_b128 v[56:59], v6 offset:384
  ds_read_b64 v[132:133], v4 offset:2944
  ds_read_b64 v[134:135], v4 offset:2952
  ds_read_b128 v[60:63], v6 offset:448
  ds_read_b64 v[128:129], v4 offset:3008
  ds_read_b64 v[130:131], v4 offset:3016
  s_waitcnt lgkmcnt(15)
  v_mfma_f32_16x16x32_f16 v[228:231], v[156:159], v[32:35], 0
  ds_read_b128 v[32:35], v6 offset:512
  v_mfma_f32_16x16x32_f16 v[228:231], v[152:155], v[36:39], v[228:231]
  ds_read_b128 v[36:39], v6 offset:576
  v_mfma_f32_16x16x32_f16 v[228:231], v[148:151], v[40:43], v[228:231]
  ds_read_b128 v[40:43], v6 offset:640
  s_waitcnt lgkmcnt(15)
  v_mfma_f32_16x16x32_f16 v[228:231], v[144:147], v[44:47], v[228:231]
  ds_read_b128 v[44:47], v6 offset:704
  ds_read_b64 v[112:113], v4 offset:3264
  ds_read_b64 v[114:115], v4 offset:3272
  s_waitcnt lgkmcnt(15)
  v_mfma_f32_16x16x32_f16 v[228:231], v[140:143], v[48:51], v[228:231]
  ds_read_b128 v[48:51], v6 offset:768
  ds_read_b64 v[108:109], v4 offset:3328
  ds_read_b64 v[110:111], v4 offset:3336
  s_waitcnt lgkmcnt(15)
  v_mfma_f32_16x16x32_f16 v[228:231], v[136:139], v[52:55], v[228:231]
  ds_read_b128 v[52:55], v6 offset:832
  ds_read_b64 v[104:105], v4 offset:3392
  ds_read_b64 v[106:107], v4 offset:3400
  s_waitcnt lgkmcnt(15)
  v_mfma_f32_16x16x32_f16 v[228:231], v[132:135], v[56:59], v[228:231]
  ds_read_b128 v[56:59], v6 offset:896
  ds_read_b64 v[100:101], v4 offset:3456
  ds_read_b64 v[102:103], v4 offset:3464
  s_waitcnt lgkmcnt(15)
  v_mfma_f32_16x16x32_f16 v[228:231], v[128:131], v[60:63], v[228:231]
  ds_read_b128 v[60:63], v6 offset:960
  ds_read_b64 v[96:97], v4 offset:3520
  ds_read_b64 v[98:99], v4 offset:3528
  s_waitcnt lgkmcnt(15)
  v_mfma_f32_16x16x32_f16 v[228:231], v[124:127], v[32:35], v[228:231]
  ds_write_b128 v8, v[224:227]
  s_mov_b64 exec, 1
  ds_add_u32 v248, v249 offset:236
  s_mov_b64 exec, -1
  ds_read_b128 v[32:35], v6 offset:1024
  v_mfma_f32_16x16x32_f16 v[228:231], v[120:123], v[36:39], v[228:231]
  ds_read_b128 v[36:39], v6 offset:1088
  v_mfma_f32_16x16x32_f16 v[228:231], v[116:119], v[40:43], v[228:231]
  ds_read_b128 v[40:43], v6 offset:1152
  s_waitcnt lgkmcnt(15)
  v_mfma_f32_16x16x32_f16 v[228:231], v[112:115], v[44:47], v[228:231]
  ds_read_b128 v[44:47], v6 offset:1216
  ds_read_b64 v[80:81], v4 offset:3776
  ds_read_b64 v[82:83], v4 offset:3784
  s_waitcnt lgkmcnt(15)
  v_mfma_f32_16x16x32_f16 v[228:231], v[108:111], v[48:51], v[228:231]
  ds_read_b128 v[48:51], v6 offset:1280
  ds_read_b64 v[76:77], v4 offset:3840
  ds_read_b64 v[78:79], v4 offset:3848
  s_waitcnt lgkmcnt(15)
  v_mfma_f32_16x16x32_f16 v[228:231], v[104:107], v[52:55], v[228:231]
  ds_read_b128 v[52:55], v6 offset:1344
  ds_read_b64 v[72:73], v4 offset:3904
  ds_read_b64 v[74:75], v4 offset:3912
  s_waitcnt lgkmcnt(15)
  v_mfma_f32_16x16x32_f16 v[228:231], v[100:103], v[56:59], v[228:231]
  ds_read_b128 v[56:59], v6 offset:1408
  ds_read_b64 v[68:69], v4 offset:3968
  ds_read_b64 v[70:71], v4 offset:3976
  s_waitcnt lgkmcnt(15)
  v_mfma_f32_16x16x32_f16 v[228:231], v[96:99], v[60:63], v[228:231]
  ds_read_b128 v[60:63], v6 offset:1472
  ds_read_b64 v[64:65], v4 offset:4032
  ds_read_b64 v[66:67], v4 offset:4040
  s_waitcnt lgkmcnt(15)
  v_mfma_f32_16x16x32_f16 v[228:231], v[92:95], v[32:35], v[228:231]
  v_mfma_f32_16x16x32_f16 v[228:231], v[88:91], v[36:39], v[228:231]
  v_mfma_f32_16x16x32_f16 v[228:231], v[84:87], v[40:43], v[228:231]
  s_waitcnt lgkmcnt(12)
  v_mfma_f32_16x16x32_f16 v[228:231], v[80:83], v[44:47], v[228:231]
  s_waitcnt lgkmcnt(9)
  v_mfma_f32_16x16x32_f16 v[228:231], v[76:79], v[48:51], v[228:231]
  s_waitcnt lgkmcnt(6)
  v_mfma_f32_16x16x32_f16 v[228:231], v[72:75], v[52:55], v[228:231]
  s_waitcnt lgkmcnt(3)
  v_mfma_f32_16x16x32_f16 v[228:231], v[68:71], v[56:59], v[228:231]
  s_waitcnt lgkmcnt(0)
  v_mfma_f32_16x16x32_f16 v[228:231], v[64:67], v[60:63], v[228:231]
  s_nop 7
  ds_read_b32 v40, v248 offset:40
  ds_read_b32 v41, v248 offset:56
  ds_read_b32 v42, v248 offset:72
  ds_read_b32 v43, v248 offset:88
  ds_read_b64 v[44:45], v3 offset:10240
  v_and_b32 v16, 15, v2
  v_mul_u32_u24 v16, 96, v16
  v_lshrrev_b32 v17, 5, v2
  v_mul_u32_u24 v17, 48, v17
  v_bfe_u32 v18, v2, 4, 1
  v_lshl_add_u32 v17, v18, 3, v17
  v_add_u32 v16, v16, v17
  v_add_u32 v16, 69152, v16

  s_waitcnt lgkmcnt(0)
  v_ldexp_f32 v43, v43, v42
  v_mul_f32 v228, v43, v228
  v_mul_f32 v229, v43, v229
  v_mul_f32 v230, v43, v230
  v_mul_f32 v231, v43, v231
  v_fma_mix_f32 v48, v44, v40, 0 op_sel:[0,0,0] op_sel_hi:[1,0,0]
  v_fma_mix_f32 v49, v44, v40, 0 op_sel:[1,0,0] op_sel_hi:[1,0,0]
  v_fma_mix_f32 v50, v45, v40, 0 op_sel:[0,0,0] op_sel_hi:[1,0,0]
  v_fma_mix_f32 v51, v45, v40, 0 op_sel:[1,0,0] op_sel_hi:[1,0,0]
  v_cvt_pk_bf16_f32 v229, v228, v229
  v_cvt_pk_bf16_f32 v231, v230, v231
  v_cvt_pk_bf16_f32 v49, v48, v49
  v_cvt_pk_bf16_f32 v51, v50, v51
  v_lshlrev_b32 v228, 16, v229
  v_and_b32 v229, 0xffff0000, v229
  v_lshlrev_b32 v230, 16, v231
  v_and_b32 v231, 0xffff0000, v231
  v_lshlrev_b32 v48, 16, v49
  v_and_b32 v49, 0xffff0000, v49
  v_lshlrev_b32 v50, 16, v51
  v_and_b32 v51, 0xffff0000, v51
  v_add_f32 v228, v228, v48
  v_add_f32 v229, v229, v49
  v_add_f32 v230, v230, v50
  v_add_f32 v231, v231, v51
  v_cvt_pk_bf16_f32 v229, v228, v229
  v_cvt_pk_bf16_f32 v231, v230, v231
  v_lshlrev_b32 v228, 16, v229
  v_and_b32 v229, 0xffff0000, v229
  v_lshlrev_b32 v230, 16, v231
  v_and_b32 v231, 0xffff0000, v231
  v_mul_f32 v228, v41, v228
  v_mul_f32 v229, v41, v229
  v_mul_f32 v230, v41, v230
  v_mul_f32 v231, v41, v231
  v_cvt_pk_bf16_f32 v48, v228, v229
  v_cvt_pk_bf16_f32 v49, v230, v231
  ds_write_b64 v16, v[48:49] offset:3072
  s_branch M_FIN
M_RUNQ3:
M_HSQ3:
  ds_read_b32 v251, v248 offset:240
  ds_read_b32 v15, v248 offset:196
  s_waitcnt lgkmcnt(0)
  v_readfirstlane_b32 s94, v251
  v_readfirstlane_b32 s38, v15
  s_cmp_ge_u32 s94, 8
  s_cbranch_scc0 M_HSQ3

  v_lshlrev_b32 v8, 4, v2
  v_add_u32 v8, 16896, v8
  ds_read_b128 v[232:235], v6 offset:432
  ds_read_b128 v[236:239], v6 offset:416
  ds_read_b128 v[240:243], v6 offset:448
  s_waitcnt vmcnt(0)
  s_waitcnt lgkmcnt(1)
  v_mfma_f32_16x16x32_f16 v[32:35], v[232:235], v[192:195], 0
  v_mfma_f32_16x16x32_f16 v[36:39], v[236:239], v[196:199], 0
  s_waitcnt lgkmcnt(0)
  v_mfma_f32_16x16x32_f16 v[224:227], v[216:219], v[240:243], 0
  s_nop 6
  v_cvt_pk_f16_f32 v32, v32, v33
  v_cvt_pk_f16_f32 v33, v34, v35
  v_cvt_pk_f16_f32 v34, v36, v37
  v_cvt_pk_f16_f32 v35, v38, v39
  s_nop 1
  v_mfma_f32_16x16x32_f16 v[224:227], v[32:35], v[200:203], v[224:227]
  ds_read_b128 v[32:35], v6 offset:0
  ds_read_b128 v[36:39], v6 offset:64
  ds_read_b128 v[40:43], v6 offset:128
  ds_read_b128 v[44:47], v6 offset:192
  ds_read_b64 v[176:177], v4 offset:2240
  ds_read_b64 v[178:179], v4 offset:2248
  ds_read_b128 v[48:51], v6 offset:256
  ds_read_b64 v[172:173], v4 offset:2304
  ds_read_b64 v[174:175], v4 offset:2312
  ds_read_b128 v[52:55], v6 offset:320
  ds_read_b64 v[168:169], v4 offset:2368
  ds_read_b64 v[170:171], v4 offset:2376
  ds_read_b128 v[56:59], v6 offset:384
  ds_read_b64 v[164:165], v4 offset:2432
  ds_read_b64 v[166:167], v4 offset:2440
  ds_read_b128 v[60:63], v6 offset:448
  ds_read_b64 v[160:161], v4 offset:2496
  ds_read_b64 v[162:163], v4 offset:2504
  s_waitcnt lgkmcnt(15)
  v_mfma_f32_16x16x32_f16 v[228:231], v[188:191], v[32:35], 0
  ds_read_b128 v[32:35], v6 offset:512
  v_mfma_f32_16x16x32_f16 v[228:231], v[184:187], v[36:39], v[228:231]
  ds_read_b128 v[36:39], v6 offset:576
  v_mfma_f32_16x16x32_f16 v[228:231], v[180:183], v[40:43], v[228:231]
  ds_read_b128 v[40:43], v6 offset:640
  s_waitcnt lgkmcnt(15)
  v_mfma_f32_16x16x32_f16 v[228:231], v[176:179], v[44:47], v[228:231]
  ds_read_b128 v[44:47], v6 offset:704
  ds_read_b64 v[144:145], v4 offset:2752
  ds_read_b64 v[146:147], v4 offset:2760
  s_waitcnt lgkmcnt(15)
  v_mfma_f32_16x16x32_f16 v[228:231], v[172:175], v[48:51], v[228:231]
  ds_read_b128 v[48:51], v6 offset:768
  ds_read_b64 v[140:141], v4 offset:2816
  ds_read_b64 v[142:143], v4 offset:2824
  s_waitcnt lgkmcnt(15)
  v_mfma_f32_16x16x32_f16 v[228:231], v[168:171], v[52:55], v[228:231]
  ds_read_b128 v[52:55], v6 offset:832
  ds_read_b64 v[136:137], v4 offset:2880
  ds_read_b64 v[138:139], v4 offset:2888
  s_waitcnt lgkmcnt(15)
  v_mfma_f32_16x16x32_f16 v[228:231], v[164:167], v[56:59], v[228:231]
  ds_read_b128 v[56:59], v6 offset:896
  ds_read_b64 v[132:133], v4 offset:2944
  ds_read_b64 v[134:135], v4 offset:2952
  s_waitcnt lgkmcnt(15)
  v_mfma_f32_16x16x32_f16 v[228:231], v[160:163], v[60:63], v[228:231]
  ds_read_b128 v[60:63], v6 offset:960
  ds_read_b64 v[128:129], v4 offset:3008
  ds_read_b64 v[130:131], v4 offset:3016
  s_waitcnt lgkmcnt(15)
  v_mfma_f32_16x16x32_f16 v[228:231], v[156:159], v[32:35], v[228:231]
  ds_write_b128 v8, v[224:227]
  s_mov_b64 exec, 1
  ds_add_u32 v248, v249 offset:236
  s_mov_b64 exec, -1
  ds_read_b128 v[32:35], v6 offset:1024
  v_mfma_f32_16x16x32_f16 v[228:231], v[152:155], v[36:39], v[228:231]
  ds_read_b128 v[36:39], v6 offset:1088
  v_mfma_f32_16x16x32_f16 v[228:231], v[148:151], v[40:43], v[228:231]
  ds_read_b128 v[40:43], v6 offset:1152
  s_waitcnt lgkmcnt(15)
  v_mfma_f32_16x16x32_f16 v[228:231], v[144:147], v[44:47], v[228:231]
  ds_read_b128 v[44:47], v6 offset:1216
  ds_read_b64 v[112:113], v4 offset:3264
  ds_read_b64 v[114:115], v4 offset:3272
  s_waitcnt lgkmcnt(15)
  v_mfma_f32_16x16x32_f16 v[228:231], v[140:143], v[48:51], v[228:231]
  ds_read_b128 v[48:51], v6 offset:1280
  ds_read_b64 v[108:109], v4 offset:3328
  ds_read_b64 v[110:111], v4 offset:3336
  s_waitcnt lgkmcnt(15)
  v_mfma_f32_16x16x32_f16 v[228:231], v[136:139], v[52:55], v[228:231]
  ds_read_b128 v[52:55], v6 offset:1344
  ds_read_b64 v[104:105], v4 offset:3392
  ds_read_b64 v[106:107], v4 offset:3400
  s_waitcnt lgkmcnt(15)
  v_mfma_f32_16x16x32_f16 v[228:231], v[132:135], v[56:59], v[228:231]
  ds_read_b128 v[56:59], v6 offset:1408
  ds_read_b64 v[100:101], v4 offset:3456
  ds_read_b64 v[102:103], v4 offset:3464
  s_waitcnt lgkmcnt(15)
  v_mfma_f32_16x16x32_f16 v[228:231], v[128:131], v[60:63], v[228:231]
  ds_read_b128 v[60:63], v6 offset:1472
  ds_read_b64 v[96:97], v4 offset:3520
  ds_read_b64 v[98:99], v4 offset:3528
  s_waitcnt lgkmcnt(15)
  v_mfma_f32_16x16x32_f16 v[228:231], v[124:127], v[32:35], v[228:231]
  ds_read_b128 v[32:35], v6 offset:1536
  v_mfma_f32_16x16x32_f16 v[228:231], v[120:123], v[36:39], v[228:231]
  ds_read_b128 v[36:39], v6 offset:1600
  v_mfma_f32_16x16x32_f16 v[228:231], v[116:119], v[40:43], v[228:231]
  ds_read_b128 v[40:43], v6 offset:1664
  s_waitcnt lgkmcnt(15)
  v_mfma_f32_16x16x32_f16 v[228:231], v[112:115], v[44:47], v[228:231]
  ds_read_b128 v[44:47], v6 offset:1728
  ds_read_b64 v[80:81], v4 offset:3776
  ds_read_b64 v[82:83], v4 offset:3784
  s_waitcnt lgkmcnt(15)
  v_mfma_f32_16x16x32_f16 v[228:231], v[108:111], v[48:51], v[228:231]
  ds_read_b128 v[48:51], v6 offset:1792
  ds_read_b64 v[76:77], v4 offset:3840
  ds_read_b64 v[78:79], v4 offset:3848
  s_waitcnt lgkmcnt(15)
  v_mfma_f32_16x16x32_f16 v[228:231], v[104:107], v[52:55], v[228:231]
  ds_read_b128 v[52:55], v6 offset:1856
  ds_read_b64 v[72:73], v4 offset:3904
  ds_read_b64 v[74:75], v4 offset:3912
  s_waitcnt lgkmcnt(15)
  v_mfma_f32_16x16x32_f16 v[228:231], v[100:103], v[56:59], v[228:231]
  ds_read_b128 v[56:59], v6 offset:1920
  ds_read_b64 v[68:69], v4 offset:3968
  ds_read_b64 v[70:71], v4 offset:3976
  s_waitcnt lgkmcnt(15)
  v_mfma_f32_16x16x32_f16 v[228:231], v[96:99], v[60:63], v[228:231]
  ds_read_b128 v[60:63], v6 offset:1984
  ds_read_b64 v[64:65], v4 offset:4032
  ds_read_b64 v[66:67], v4 offset:4040
  s_waitcnt lgkmcnt(15)
  v_mfma_f32_16x16x32_f16 v[228:231], v[92:95], v[32:35], v[228:231]
  v_mfma_f32_16x16x32_f16 v[228:231], v[88:91], v[36:39], v[228:231]
  v_mfma_f32_16x16x32_f16 v[228:231], v[84:87], v[40:43], v[228:231]
  s_waitcnt lgkmcnt(12)
  v_mfma_f32_16x16x32_f16 v[228:231], v[80:83], v[44:47], v[228:231]
  s_waitcnt lgkmcnt(9)
  v_mfma_f32_16x16x32_f16 v[228:231], v[76:79], v[48:51], v[228:231]
  s_waitcnt lgkmcnt(6)
  v_mfma_f32_16x16x32_f16 v[228:231], v[72:75], v[52:55], v[228:231]
  s_waitcnt lgkmcnt(3)
  v_mfma_f32_16x16x32_f16 v[228:231], v[68:71], v[56:59], v[228:231]
  s_waitcnt lgkmcnt(0)
  v_mfma_f32_16x16x32_f16 v[228:231], v[64:67], v[60:63], v[228:231]
  s_nop 7
  ds_read_b32 v40, v248 offset:40
  ds_read_b32 v41, v248 offset:56
  ds_read_b32 v42, v248 offset:72
  ds_read_b32 v43, v248 offset:88
  ds_read_b64 v[44:45], v3 offset:10752
  v_and_b32 v16, 15, v2
  v_mul_u32_u24 v16, 96, v16
  v_lshrrev_b32 v17, 5, v2
  v_mul_u32_u24 v17, 48, v17
  v_bfe_u32 v18, v2, 4, 1
  v_lshl_add_u32 v17, v18, 3, v17
  v_add_u32 v16, v16, v17
  v_add_u32 v16, 69152, v16

  s_waitcnt lgkmcnt(0)
  v_ldexp_f32 v43, v43, v42
  v_mul_f32 v228, v43, v228
  v_mul_f32 v229, v43, v229
  v_mul_f32 v230, v43, v230
  v_mul_f32 v231, v43, v231
  v_fma_mix_f32 v48, v44, v40, 0 op_sel:[0,0,0] op_sel_hi:[1,0,0]
  v_fma_mix_f32 v49, v44, v40, 0 op_sel:[1,0,0] op_sel_hi:[1,0,0]
  v_fma_mix_f32 v50, v45, v40, 0 op_sel:[0,0,0] op_sel_hi:[1,0,0]
  v_fma_mix_f32 v51, v45, v40, 0 op_sel:[1,0,0] op_sel_hi:[1,0,0]
  v_cvt_pk_bf16_f32 v229, v228, v229
  v_cvt_pk_bf16_f32 v231, v230, v231
  v_cvt_pk_bf16_f32 v49, v48, v49
  v_cvt_pk_bf16_f32 v51, v50, v51
  v_lshlrev_b32 v228, 16, v229
  v_and_b32 v229, 0xffff0000, v229
  v_lshlrev_b32 v230, 16, v231
  v_and_b32 v231, 0xffff0000, v231
  v_lshlrev_b32 v48, 16, v49
  v_and_b32 v49, 0xffff0000, v49
  v_lshlrev_b32 v50, 16, v51
  v_and_b32 v51, 0xffff0000, v51
  v_add_f32 v228, v228, v48
  v_add_f32 v229, v229, v49
  v_add_f32 v230, v230, v50
  v_add_f32 v231, v231, v51
  v_cvt_pk_bf16_f32 v229, v228, v229
  v_cvt_pk_bf16_f32 v231, v230, v231
  v_lshlrev_b32 v228, 16, v229
  v_and_b32 v229, 0xffff0000, v229
  v_lshlrev_b32 v230, 16, v231
  v_and_b32 v231, 0xffff0000, v231
  v_mul_f32 v228, v41, v228
  v_mul_f32 v229, v41, v229
  v_mul_f32 v230, v41, v230
  v_mul_f32 v231, v41, v231
  v_cvt_pk_bf16_f32 v48, v228, v229
  v_cvt_pk_bf16_f32 v49, v230, v231
  ds_write_b64 v16, v[48:49] offset:4608
  s_branch M_FIN
M_FIN:
  s_setprio 0
  s_cmp_lg_u32 s3, 6
  s_cbranch_scc1 M_NRED
  s_cmp_lt_u32 s2, 229
  s_cbranch_scc1 M_NRED
  s_mov_b32 s41, 65536

  s_sub_u32 s40, s2, 202
  s_mul_i32 s40, s40, 4608
  s_add_u32 s40, s40, 524288
  v_lshl_add_u32 v146, v2, 3, s40
  v_add_u32 v147, 4096, v146

  s_waitcnt vmcnt(1)
M_RP:
  v_xor_b32 v148, s38, v145

  v_xor_b32 v149, s38, v129
  v_or_b32 v148, v148, v149
  v_xor_b32 v149, s38, v131
  v_or_b32 v148, v148, v149
  v_xor_b32 v149, s38, v133
  v_or_b32 v148, v148, v149
  v_xor_b32 v149, s38, v135
  v_or_b32 v148, v148, v149
  v_xor_b32 v149, s38, v137
  v_or_b32 v148, v148, v149
  v_xor_b32 v149, s38, v139
  v_or_b32 v148, v148, v149
  v_xor_b32 v149, s38, v141
  v_or_b32 v148, v148, v149
  v_xor_b32 v149, s38, v143
  v_or_b32 v148, v148, v149
  v_cmp_ne_u32 vcc, 0, v148
  s_cbranch_vccz M_RD

  global_load_dwordx2 v[128:129], v146, s[36:37] offset:0 sc1
  global_load_dwordx2 v[130:131], v146, s[36:37] offset:512 sc1
  global_load_dwordx2 v[132:133], v146, s[36:37] offset:1024 sc1
  global_load_dwordx2 v[134:135], v146, s[36:37] offset:1536 sc1
  global_load_dwordx2 v[136:137], v146, s[36:37] offset:2048 sc1
  global_load_dwordx2 v[138:139], v146, s[36:37] offset:2560 sc1
  global_load_dwordx2 v[140:141], v146, s[36:37] offset:3072 sc1
  global_load_dwordx2 v[142:143], v146, s[36:37] offset:3584 sc1
  global_load_dwordx2 v[144:145], v147, s[36:37] sc1
  s_waitcnt vmcnt(0)
  s_sub_u32 s41, s41, 1
  s_cbranch_scc0 M_RP
M_RD:

  v_add_f32 v144, v144, v128
  v_add_f32 v144, v144, v130
  v_add_f32 v144, v144, v132
  v_add_f32 v144, v144, v134
  v_add_f32 v144, v144, v136
  v_add_f32 v144, v144, v138
  v_add_f32 v144, v144, v140
  v_add_f32 v144, v144, v142
  v_cvt_pk_bf16_f32 v148, v144, v144
  s_sub_u32 s40, s2, 238
  s_cmp_lt_u32 s40, 9
  s_cbranch_scc0 M_RNC
  v_lshlrev_b32 v148, 16, v148
  v_add_f32 v148, 1.0, v148
  v_cvt_pk_bf16_f32 v148, v148, v148
M_RNC:
  s_sub_u32 s40, s2, 229
  s_lshl_b32 s40, s40, 8
  s_add_u32 s40, s40, 458752
  v_mov_b32 v150, v148 quad_perm:[1,1,3,3] row_mask:0xf bank_mask:0xf
  v_lshl_add_u32 v151, v2, 2, s40
  v_mov_b32 v149, s38
  v_alignbit_b32 v148, v150, v148, 16
  s_mov_b32 exec_lo, 0x55555555
  s_mov_b32 exec_hi, 0x55555555
  global_store_dwordx2 v151, v[148:149], s[36:37] sc1
  s_mov_b64 exec, -1
M_NRED:
  s_cmp_lg_u32 s3, 7
  s_cbranch_scc1 M_NWR
  v_lshlrev_b32 v148, 4, v2
  s_mov_b32 m0, 159616
  s_nop 0
  global_load_lds_dwordx4 v148, s[20:21]
  s_mov_b64 exec, 0xff
  global_load_lds_dwordx4 v148, s[20:21] offset:1024
  s_mov_b64 exec, -1
M_NWR:

  ds_read_b64 v[64:65], v248 offset:32
  ds_read_b64 v[66:67], v248 offset:48
  ds_read_b64 v[68:69], v248 offset:64
  ds_read_b64 v[70:71], v248 offset:80
  ds_read_b64 v[72:73], v27
  ds_read_b64 v[74:75], v27 offset:4608
  s_waitcnt lgkmcnt(6)
  s_barrier
  ds_read_b128 v[80:83], v24
  ds_read_b128 v[84:87], v25
  ds_read_b128 v[88:91], v26
  ds_read_b128 v[92:95], v24 offset:18432
  ds_read_b128 v[96:99], v25 offset:18432
  ds_read_b128 v[100:103], v26 offset:18432
  v_min_u32 v124, 175, v0
  v_lshlrev_b32 v125, 4, v0
  v_lshlrev_b32 v124, 4, v124
  v_add_u32 v126, 458752, v125
  v_add_u32 v127, 462848, v124
  s_cmp_ge_u32 s3, 4
  s_cbranch_scc1 M_NPL
  global_load_dwordx4 v[128:131], v126, s[36:37] sc1
  global_load_dwordx4 v[132:135], v127, s[36:37] sc1
M_NPL:
  s_waitcnt lgkmcnt(6)

  v_fma_mix_f32 v104, v72, v64, 0 op_sel:[0,0,0] op_sel_hi:[1,0,0]
  v_fma_mix_f32 v105, v72, v64, 0 op_sel:[1,0,0] op_sel_hi:[1,0,0]
  v_fma_mix_f32 v106, v73, v64, 0 op_sel:[0,0,0] op_sel_hi:[1,0,0]
  v_fma_mix_f32 v107, v73, v64, 0 op_sel:[1,0,0] op_sel_hi:[1,0,0]
  v_fma_mix_f32 v108, v74, v65, 0 op_sel:[0,0,0] op_sel_hi:[1,0,0]
  v_fma_mix_f32 v109, v74, v65, 0 op_sel:[1,0,0] op_sel_hi:[1,0,0]
  v_fma_mix_f32 v110, v75, v65, 0 op_sel:[0,0,0] op_sel_hi:[1,0,0]
  v_fma_mix_f32 v111, v75, v65, 0 op_sel:[1,0,0] op_sel_hi:[1,0,0]
  v_ldexp_f32 v70, v70, v68
  v_ldexp_f32 v71, v71, v69
  v_cvt_pk_bf16_f32 v105, v104, v105
  v_cvt_pk_bf16_f32 v107, v106, v107
  v_cvt_pk_bf16_f32 v109, v108, v109
  v_cvt_pk_bf16_f32 v111, v110, v111
  v_lshlrev_b32 v104, 16, v105
  v_and_b32 v105, 0xffff0000, v105
  v_lshlrev_b32 v106, 16, v107
  v_and_b32 v107, 0xffff0000, v107
  v_lshlrev_b32 v108, 16, v109
  v_and_b32 v109, 0xffff0000, v109
  v_lshlrev_b32 v110, 16, v111
  v_and_b32 v111, 0xffff0000, v111
  s_waitcnt lgkmcnt(3)
  v_fmac_f32 v80, s82, v84
  v_fmac_f32 v81, s82, v85
  v_fmac_f32 v82, s82, v86
  v_fmac_f32 v83, s82, v87
  v_fmac_f32 v80, s87, v88
  v_fmac_f32 v81, s87, v89
  v_fmac_f32 v82, s87, v90
  v_fmac_f32 v83, s87, v91
  s_waitcnt lgkmcnt(0)
  v_fma_f32 v84, s82, v96, v92
  v_fma_f32 v85, s82, v97, v93
  v_fma_f32 v86, s82, v98, v94
  v_fma_f32 v87, s82, v99, v95
  v_fmac_f32 v84, s87, v100
  v_fmac_f32 v85, s87, v101
  v_fmac_f32 v86, s87, v102
  v_fmac_f32 v87, s87, v103
  v_mul_f32 v80, v70, v80
  v_mul_f32 v81, v70, v81
  v_mul_f32 v82, v70, v82
  v_mul_f32 v83, v70, v83
  v_mul_f32 v84, v71, v84
  v_mul_f32 v85, v71, v85
  v_mul_f32 v86, v71, v86
  v_mul_f32 v87, v71, v87
  v_cvt_pk_bf16_f32 v88, v80, v81
  v_cvt_pk_bf16_f32 v89, v82, v83
  v_cvt_pk_bf16_f32 v90, v84, v85
  v_cvt_pk_bf16_f32 v91, v86, v87
  v_mov_b32 v62, 0x3f80
  v_mov_b32 v63, 0x3f800000
  v_dot2_f32_bf16 v80, v88, v62, v104
  v_dot2_f32_bf16 v81, v88, v63, v105
  v_dot2_f32_bf16 v82, v89, v62, v106
  v_dot2_f32_bf16 v83, v89, v63, v107
  v_dot2_f32_bf16 v84, v90, v62, v108
  v_dot2_f32_bf16 v85, v90, v63, v109
  v_dot2_f32_bf16 v86, v91, v62, v110
  v_dot2_f32_bf16 v87, v91, v63, v111
  v_cvt_pk_bf16_f32 v81, v80, v81
  v_cvt_pk_bf16_f32 v83, v82, v83
  v_cvt_pk_bf16_f32 v85, v84, v85
  v_cvt_pk_bf16_f32 v87, v86, v87
  v_lshlrev_b32 v80, 16, v81
  v_and_b32 v81, 0xffff0000, v81
  v_lshlrev_b32 v82, 16, v83
  v_and_b32 v83, 0xffff0000, v83
  v_lshlrev_b32 v84, 16, v85
  v_and_b32 v85, 0xffff0000, v85
  v_lshlrev_b32 v86, 16, v87
  v_and_b32 v87, 0xffff0000, v87
  v_mul_f32 v80, v66, v80
  v_mul_f32 v81, v66, v81
  v_mul_f32 v82, v66, v82
  v_mul_f32 v83, v66, v83
  v_mul_f32 v84, v67, v84
  v_mul_f32 v85, v67, v85
  v_mul_f32 v86, v67, v86
  v_mul_f32 v87, v67, v87
  v_cvt_pk_bf16_f32 v88, v80, v84
  v_cvt_pk_bf16_f32 v89, v81, v85
  v_cvt_pk_bf16_f32 v90, v82, v86
  v_cvt_pk_bf16_f32 v91, v83, v87
  ds_write_b128 v28, v[88:91]
  ds_read2_b32 v[116:117], v29 offset0:0 offset1:1
  ds_read_b32 v118, v29 offset:8
  ds_read2_b32 v[120:121], v29 offset0:12 offset1:13
  ds_read_b32 v122, v29 offset:56
  v_mov_b32 v119, s38
  v_mov_b32 v123, s38
  v_add_u32 v31, 16384, v30
  v_lshrrev_b32 v125, 1, v125
  v_lshrrev_b32 v124, 1, v124
  v_add_u32 v125, 156160, v125
  v_add_u32 v124, 158208, v124
  s_waitcnt lgkmcnt(2)
  global_store_dwordx4 v30, v[116:119], s[36:37] sc1
  s_waitcnt lgkmcnt(0)
  global_store_dwordx4 v31, v[120:123], s[36:37] sc1

  s_cmp_lg_u32 s3, 7
  s_cbranch_scc1 T_B7
  s_waitcnt vmcnt(2)
T_B7:
  s_barrier
  s_cmp_ge_u32 s3, 4
  s_cbranch_scc1 T_ZW

  s_mov_b32 s41, 65536

  s_waitcnt vmcnt(2)
  s_branch T_PP1
T_PP:
  global_load_dwordx4 v[128:131], v126, s[36:37] sc1
  global_load_dwordx4 v[132:135], v127, s[36:37] sc1
  s_waitcnt vmcnt(0)
T_PP1:
  v_xor_b32 v129, s38, v129
  v_xor_b32 v131, s38, v131
  v_xor_b32 v133, s38, v133
  v_xor_b32 v135, s38, v135
  v_or3_b32 v129, v129, v131, v133
  v_or_b32 v129, v129, v135
  v_cmp_ne_u32 vcc, 0, v129
  s_cbranch_vccz T_PD
  s_sub_u32 s41, s41, 1
  s_cbranch_scc0 T_PP
T_PD:
  ds_write2_b32 v125, v128, v130 offset0:0 offset1:1
  ds_write2_b32 v124, v132, v134 offset0:0 offset1:1

  s_mov_b64 exec, 1
  ds_add_u32 v248, v249 offset:244
  s_mov_b64 exec, -1
  s_cmp_ge_u32 s2, 144
  s_cbranch_scc1 T_NGU
  v_lshrrev_b32 v9, 2, v2
  s_mul_i32 s40, s3, 144
  v_add_u32 v9, s40, v9
  v_mul_u32_u24 v9, 9216, v9
  v_and_b32 v8, 3, v2
  v_lshl_add_u32 v9, v8, 4, v9
  s_lshl_b32 s40, s46, 6
  v_add_u32 v9, s40, v9
  s_mul_i32 s50, s3, 9216
  s_mov_b32 s40, 147456

  s_add_u32 m0, s50, 119296
  v_mov_b32 v8, v9
  global_load_lds_dwordx4 v8, s[22:23]
  s_add_u32 m0, m0, 1024
  v_add_u32 v8, s40, v8
  global_load_lds_dwordx4 v8, s[22:23]
  s_add_u32 m0, m0, 1024
  v_add_u32 v8, s40, v8
  global_load_lds_dwordx4 v8, s[22:23]
  s_add_u32 m0, m0, 1024
  v_add_u32 v8, s40, v8
  global_load_lds_dwordx4 v8, s[22:23]
  s_add_u32 m0, m0, 1024
  v_add_u32 v8, s40, v8
  global_load_lds_dwordx4 v8, s[22:23]
  s_add_u32 m0, m0, 1024
  v_add_u32 v8, s40, v8
  global_load_lds_dwordx4 v8, s[22:23]
  s_add_u32 m0, m0, 1024
  v_add_u32 v8, s40, v8
  global_load_lds_dwordx4 v8, s[22:23]
  s_add_u32 m0, m0, 1024
  v_add_u32 v8, s40, v8
  global_load_lds_dwordx4 v8, s[22:23]
  s_add_u32 m0, m0, 1024
  v_add_u32 v8, s40, v8
  global_load_lds_dwordx4 v8, s[22:23]
  s_add_u32 m0, s50, 45568
  v_mov_b32 v8, v9
  global_load_lds_dwordx4 v8, s[24:25]
  s_add_u32 m0, m0, 1024
  v_add_u32 v8, s40, v8
  global_load_lds_dwordx4 v8, s[24:25]
  s_add_u32 m0, m0, 1024
  v_add_u32 v8, s40, v8
  global_load_lds_dwordx4 v8, s[24:25]
  s_add_u32 m0, m0, 1024
  v_add_u32 v8, s40, v8
  global_load_lds_dwordx4 v8, s[24:25]
  s_add_u32 m0, m0, 1024
  v_add_u32 v8, s40, v8
  global_load_lds_dwordx4 v8, s[24:25]
  s_add_u32 m0, m0, 1024
  v_add_u32 v8, s40, v8
  global_load_lds_dwordx4 v8, s[24:25]
  s_add_u32 m0, m0, 1024
  v_add_u32 v8, s40, v8
  global_load_lds_dwordx4 v8, s[24:25]
  s_add_u32 m0, m0, 1024
  v_add_u32 v8, s40, v8
  global_load_lds_dwordx4 v8, s[24:25]
  s_add_u32 m0, m0, 1024
  v_add_u32 v8, s40, v8
  global_load_lds_dwordx4 v8, s[24:25]
T_NGU:
  s_branch T_COM
T_ZW:
  s_sub_u32 s40, s3, 4
  s_lshl_b32 s41, s40, 12
  s_lshl_b32 s50, s2, 14
  s_add_u32 s41, s41, s50
  s_add_u32 s41, s41, 6291456
  v_lshl_add_u32 v211, v2, 4, s41
  s_lshl_b32 s40, s40, 8
  v_lshrrev_b32 v64, 2, v2
  v_lshl_add_u32 v65, v64, 2, s40
  v_and_b32 v66, 3, v2
  v_mul_u32_u24 v67, 3168, v66
  v_add_u32 v208, v65, v67
  v_add_u32 v208, 1536, v208
  v_add_u32 v209, 1056, v208
  v_add_u32 v210, 2112, v208
  s_lshr_b32 s41, s2, 5
  s_sub_u32 s50, 7, s41
  s_min_u32 s41, s41, s50
  v_and_b32 v67, 3, v64
  v_and_b32 v65, -16, v65
  v_add_u32 v65, 9984, v65
  v_mov_b32 v68, 11008
  v_cmp_eq_u32 vcc, s41, v67
  s_nop 1
  v_cndmask_b32 v65, v68, v65, vcc
  v_add_u32 v67, 4, v65
  v_add_u32 v68, 8, v65
  v_add_u32 v69, 12, v65
  v_cmp_eq_u32 vcc, 2, v66
  s_nop 1
  v_cndmask_b32 v210, v210, v65, vcc
  v_cmp_eq_u32 vcc, 3, v66
  s_nop 1
  v_cndmask_b32 v208, v208, v67, vcc
  v_cndmask_b32 v209, v209, v68, vcc
  v_cndmask_b32 v210, v210, v69, vcc

T_COM:
  v_mov_b32 v64, 0
  v_mov_b32 v65, 0
  v_mov_b32 v66, 0
  v_mov_b32 v67, 0
  v_lshlrev_b32 v68, 4, v0
  v_min_u32 v69, 15, v0
  v_lshlrev_b32 v69, 4, v69
  ds_write_b128 v68, v[64:67] offset:11264
  ds_write_b128 v69, v[64:67] offset:19456
  v_mov_b32 v61, 0x3f803f80
  v_mov_b32 v15, 0x3ae38e39
  v_and_b32 v212, 3, v2
  v_lshlrev_b32 v212, 4, v212
  v_lshrrev_b32 v213, 2, v2
  v_lshlrev_b32 v213, 14, v213
  s_lshl_b32 s41, s2, 6
  s_add_u32 s41, s41, 65536
  v_add3_u32 v213, v213, v212, s41
  s_lshl_b32 s41, s3, 3
  v_mov_b32 v214, s41
  v_mov_b32 v217, s38
  s_lshl_b32 s61, s2, 3
  s_add_u32 s61, s61, s3
  s_sub_u32 s61, 0xffff, s61

  v_lshlrev_b32 v16, 16, v10
  v_and_b32 v17, 0xffff0000, v10
  v_lshlrev_b32 v18, 16, v11
  v_and_b32 v19, 0xffff0000, v11
  v_lshlrev_b32 v20, 16, v12
  v_and_b32 v21, 0xffff0000, v12
  v_lshlrev_b32 v22, 16, v13
  v_and_b32 v23, 0xffff0000, v13
  v_lshlrev_b32 v24, 16, v14
  v_lshlrev_b32 v4, 4, v2
  v_add_u32 v4, 156160, v4
  v_lshlrev_b32 v5, 1, v2
  v_add_u32 v5, 157184, v5
  s_mul_i32 s40, s3, 1056
  s_add_u32 s40, s40, 1536
  v_lshl_add_u32 v6, v2, 4, s40
  s_lshl_b32 s40, s3, 1
  s_add_u32 s40, s40, 9984
  v_lshl_add_u32 v7, v2, 4, s40

SP_8:
  ds_read_b32 v251, v248 offset:244
  s_waitcnt lgkmcnt(0)
  v_readfirstlane_b32 s94, v251
  s_cmp_ge_u32 s94, 4
  s_cbranch_scc0 SP_8

  ds_read_b128 v[72:75], v4 offset:0
  ds_read_u16 v76, v5 offset:0
  ds_read_b128 v[80:83], v4 offset:1152
  ds_read_u16 v84, v5 offset:1152
  ds_read_b128 v[88:91], v4 offset:2304
  ds_read_u16 v92, v5 offset:2304
  ds_read_b128 v[56:59], v4 offset:3456
  ds_read_u16 v60, v5 offset:3456
  s_waitcnt lgkmcnt(4)

  v_lshlrev_b32 v36, 16, v72
  v_and_b32 v37, 0xffff0000, v72
  v_lshlrev_b32 v38, 16, v73
  v_and_b32 v39, 0xffff0000, v73
  v_lshlrev_b32 v40, 16, v74
  v_and_b32 v41, 0xffff0000, v74
  v_lshlrev_b32 v42, 16, v75
  v_and_b32 v43, 0xffff0000, v75
  v_lshlrev_b32 v44, 16, v76
  v_and_b32 v26, 0xffff, v80
  v_and_b32 v27, 0xffff0000, v80
  v_and_b32 v28, 0xffff, v81
  v_and_b32 v29, 0xffff0000, v81
  v_and_b32 v30, 0xffff, v82
  v_and_b32 v31, 0xffff0000, v82
  v_and_b32 v32, 0xffff, v83
  v_and_b32 v33, 0xffff0000, v83
  v_mov_b32 v34, v84
  s_waitcnt lgkmcnt(2)
  v_and_b32 v46, 0xffff, v88
  v_and_b32 v47, 0xffff0000, v88
  v_and_b32 v48, 0xffff, v89
  v_and_b32 v49, 0xffff0000, v89
  v_and_b32 v50, 0xffff, v90
  v_and_b32 v51, 0xffff0000, v90
  v_and_b32 v52, 0xffff, v91
  v_and_b32 v53, 0xffff0000, v91
  v_mov_b32 v54, v92

  s_cmp_lt_u32 s3, 4
  s_cbranch_scc1 T_LW
  s_mov_b32 s41, 65536
  s_mov_b32 s60, 0

  s_waitcnt vmcnt(0)
T_ZP:
  s_sleep 16
T_ZP1:

  global_load_dwordx4 v[192:195], v211, s[36:37] offset:0 sc1
  global_load_dwordx4 v[196:199], v211, s[36:37] offset:1024 sc1
  global_load_dwordx4 v[200:203], v211, s[36:37] offset:2048 sc1
  global_load_dwordx4 v[204:207], v211, s[36:37] offset:3072 sc1
  s_waitcnt vmcnt(0)
  s_mov_b64 exec, -1
  v_xor_b32 v64, s38, v195
  v_xor_b32 v65, s38, v199
  v_xor_b32 v66, s38, v203
  v_xor_b32 v67, s38, v207
  v_or3_b32 v64, v64, v65, v66
  v_or_b32 v64, v64, v67
  v_cmp_ne_u32 vcc, 0, v64
  s_cbranch_vccz T_ZD
  s_mov_b64 exec, vcc
  s_sub_u32 s41, s41, 1
  s_cbranch_scc1 T_ZPX
  s_and_b32 s40, s41, 3
  s_cbranch_scc1 T_ZP1
  s_branch T_ZP
T_ZPX:
  s_mov_b64 exec, -1
T_ZD:

  s_mov_b64 exec, 1
  ds_add_u32 v248, v249 offset:264
  s_mov_b64 exec, -1
  ds_write2_b32 v208, v192, v196 offset0:0 offset1:16
  ds_write2_b32 v209, v193, v197 offset0:0 offset1:16
  ds_write2_b32 v210, v194, v198 offset0:0 offset1:16
  ds_write2_b32 v208, v200, v204 offset0:32 offset1:48
  ds_write2_b32 v209, v201, v205 offset0:32 offset1:48
  ds_write2_b32 v210, v202, v206 offset0:32 offset1:48
  s_branch T_B9
T_LW:
SP_9:
  ds_read_b32 v251, v248 offset:264
  s_waitcnt lgkmcnt(0)
  v_readfirstlane_b32 s94, v251
  s_cmp_ge_u32 s94, 4
  s_cbranch_scc0 SP_9

  s_cmp_ge_u32 s2, 144
  s_cbranch_scc1 T_NUP
  s_cmp_ge_u32 s3, 4
  s_cbranch_scc1 T_NUP
T_NUP:
  s_cmp_ge_u32 s3, 3
  s_cbranch_scc1 T_NT
  s_lshr_b32 s64, s2, 3
  s_mul_i32 s64, s64, 162
  s_mul_i32 s65, s3, 54
  s_add_u32 s64, s64, s65
  s_and_b32 s65, s2, 7
  s_mul_i32 s65, s65, 5184
  s_add_u32 s64, s64, s65
  v_min_u32 v252, 53, v2
  v_add_u32 v252, s64, v252
  v_lshlrev_b32 v252, 7, v252

  global_load_dword v250, v252, s[26:27]
T_NT:
T_B9:
  s_setprio 1
  s_waitcnt lgkmcnt(0)
  s_barrier
  ds_read_b128 v[64:67], v6
  ds_read_u16 v68, v7
  s_waitcnt lgkmcnt(0)

  v_dot2_f32_bf16 v78, v68, v62, v24
  v_dot2_f32_bf16 v70, v64, v62, v16
  v_dot2_f32_bf16 v71, v64, v63, v17
  v_dot2_f32_bf16 v72, v65, v62, v18
  v_dot2_f32_bf16 v73, v65, v63, v19
  v_dot2_f32_bf16 v74, v66, v62, v20
  v_dot2_f32_bf16 v75, v66, v63, v21
  v_dot2_f32_bf16 v76, v67, v62, v22
  v_dot2_f32_bf16 v77, v67, v63, v23
  v_cvt_pk_bf16_f32 v80, v70, v71
  v_cvt_pk_bf16_f32 v81, v72, v73
  v_cvt_pk_bf16_f32 v82, v74, v75
  v_cvt_pk_bf16_f32 v83, v76, v77
  v_cvt_pk_bf16_f32 v84, v78, 0
  v_dot2_f32_bf16 v86, v80, v61, 0
  v_dot2_f32_bf16 v88, v80, v80, 0
  v_dot2_f32_bf16 v86, v81, v61, v86
  v_dot2_f32_bf16 v88, v81, v81, v88
  v_dot2_f32_bf16 v86, v82, v61, v86
  v_dot2_f32_bf16 v88, v82, v82, v88
  v_dot2_f32_bf16 v86, v83, v61, v86
  v_dot2_f32_bf16 v88, v83, v83, v88
  v_dot2_f32_bf16 v86, v84, v61, v86
  v_dot2_f32_bf16 v88, v84, v84, v88
  s_nop 1
  v_add_f32 v86, v86, v86 row_shr:1 row_mask:0xf bank_mask:0xf bound_ctrl:0
  v_add_f32 v88, v88, v88 row_shr:1 row_mask:0xf bank_mask:0xf bound_ctrl:0
  s_nop 0
  v_add_f32 v86, v86, v86 row_shr:2 row_mask:0xf bank_mask:0xf bound_ctrl:0
  v_add_f32 v88, v88, v88 row_shr:2 row_mask:0xf bank_mask:0xf bound_ctrl:0
  s_nop 0
  v_add_f32 v86, v86, v86 row_shr:4 row_mask:0xf bank_mask:0xf bound_ctrl:0
  v_add_f32 v88, v88, v88 row_shr:4 row_mask:0xf bank_mask:0xf bound_ctrl:0
  s_nop 0
  v_add_f32 v86, v86, v86 row_shr:8 row_mask:0xf bank_mask:0xf bound_ctrl:0
  v_add_f32 v88, v88, v88 row_shr:8 row_mask:0xf bank_mask:0xf bound_ctrl:0
  s_nop 0
  v_add_f32 v86, v86, v86 row_bcast:15 row_mask:0xa bank_mask:0xf
  v_add_f32 v88, v88, v88 row_bcast:15 row_mask:0xa bank_mask:0xf
  s_nop 0
  v_add_f32 v86, v86, v86 row_bcast:31 row_mask:0xc bank_mask:0xf
  v_add_f32 v88, v88, v88 row_bcast:31 row_mask:0xc bank_mask:0xf
  s_nop 0
  v_readlane_b32 s66, v86, 63
  v_readlane_b32 s67, v88, 63
  s_nop 0
  v_mul_f32 v86, s66, v15
  v_mul_f32 v87, s67, v15
  v_mul_f32 v88, v86, v86
  v_fma_f32 v87, -v86, v86, v87
  v_mul_f32 v89, 0x41800000, v87
  v_cmp_gt_f32 vcc, v88, v89
  s_cbranch_vccz T_FAST
  v_sub_f32 v89, 0, v86

  v_dot2_f32_bf16 v78, v84, v62, v89
  v_dot2_f32_bf16 v70, v80, v62, v89
  v_dot2_f32_bf16 v71, v80, v63, v89
  v_dot2_f32_bf16 v72, v81, v62, v89
  v_dot2_f32_bf16 v73, v81, v63, v89
  v_dot2_f32_bf16 v74, v82, v62, v89
  v_dot2_f32_bf16 v75, v82, v63, v89
  v_dot2_f32_bf16 v76, v83, v62, v89
  v_dot2_f32_bf16 v77, v83, v63, v89
  v_mul_f32 v88, v78, v78
  v_fmac_f32 v88, v70, v70
  v_fmac_f32 v88, v71, v71
  v_fmac_f32 v88, v72, v72
  v_fmac_f32 v88, v73, v73
  v_fmac_f32 v88, v74, v74
  v_fmac_f32 v88, v75, v75
  v_fmac_f32 v88, v76, v76
  v_fmac_f32 v88, v77, v77
  s_nop 1
  v_add_f32 v88, v88, v88 row_shr:1 row_mask:0xf bank_mask:0xf bound_ctrl:0
  s_nop 1
  v_add_f32 v88, v88, v88 row_shr:2 row_mask:0xf bank_mask:0xf bound_ctrl:0
  s_nop 1
  v_add_f32 v88, v88, v88 row_shr:4 row_mask:0xf bank_mask:0xf bound_ctrl:0
  s_nop 1
  v_add_f32 v88, v88, v88 row_shr:8 row_mask:0xf bank_mask:0xf bound_ctrl:0
  s_nop 1
  v_add_f32 v88, v88, v88 row_bcast:15 row_mask:0xa bank_mask:0xf
  s_nop 1
  v_add_f32 v88, v88, v88 row_bcast:31 row_mask:0xc bank_mask:0xf
  s_nop 1
  v_readlane_b32 s67, v88, 63
  s_nop 1
  v_mul_f32 v87, s67, v15
T_FAST:
  v_cvt_pk_bf16_f32 v87, -v86, v87
  v_lshlrev_b32 v86, 16, v87
  v_and_b32 v87, 0xffff0000, v87
  v_add_f32 v87, 0x3727c5ac, v87
  v_cvt_pk_bf16_f32 v87, v87, v87
  v_lshlrev_b32 v87, 16, v87
  v_sqrt_f32 v87, v87

  v_dot2_f32_bf16 v78, v84, v62, v86
  v_dot2_f32_bf16 v70, v80, v62, v86
  v_dot2_f32_bf16 v71, v80, v63, v86
  v_dot2_f32_bf16 v72, v81, v62, v86
  v_dot2_f32_bf16 v73, v81, v63, v86
  v_dot2_f32_bf16 v74, v82, v62, v86
  v_dot2_f32_bf16 v75, v82, v63, v86
  v_dot2_f32_bf16 v76, v83, v62, v86
  v_dot2_f32_bf16 v77, v83, v63, v86
  v_cvt_pk_bf16_f32 v87, v87, v87
  v_lshlrev_b32 v87, 16, v87
  v_rcp_f32 v87, v87

  v_cvt_pk_bf16_f32 v78, v78, v78
  v_lshlrev_b32 v78, 16, v78
  v_cvt_pk_bf16_f32 v71, v70, v71
  v_cvt_pk_bf16_f32 v73, v72, v73
  v_cvt_pk_bf16_f32 v75, v74, v75
  v_cvt_pk_bf16_f32 v77, v76, v77
  v_lshlrev_b32 v70, 16, v71
  v_and_b32 v71, 0xffff0000, v71
  v_lshlrev_b32 v72, 16, v73
  v_and_b32 v73, 0xffff0000, v73
  v_lshlrev_b32 v74, 16, v75
  v_and_b32 v75, 0xffff0000, v75
  v_lshlrev_b32 v76, 16, v77
  v_and_b32 v77, 0xffff0000, v77
  v_mul_f32 v78, v78, v87
  v_pk_mul_f32 v[70:71], v[70:71], v[86:87] op_sel:[0,1] op_sel_hi:[1,1]
  v_pk_mul_f32 v[72:73], v[72:73], v[86:87] op_sel:[0,1] op_sel_hi:[1,1]
  v_pk_mul_f32 v[74:75], v[74:75], v[86:87] op_sel:[0,1] op_sel_hi:[1,1]
  v_pk_mul_f32 v[76:77], v[76:77], v[86:87] op_sel:[0,1] op_sel_hi:[1,1]
  v_cvt_pk_bf16_f32 v64, v70, v71
  v_cvt_pk_bf16_f32 v65, v72, v73
  v_cvt_pk_bf16_f32 v66, v74, v75
  v_cvt_pk_bf16_f32 v67, v76, v77
  v_cvt_pk_bf16_f32 v68, v78, 0
  v_dot2_f32_bf16 v78, v68, v34, 0
  v_dot2_f32_bf16 v70, v64, v26, 0
  v_dot2_f32_bf16 v71, v64, v27, 0
  v_dot2_f32_bf16 v72, v65, v28, 0
  v_dot2_f32_bf16 v73, v65, v29, 0
  v_dot2_f32_bf16 v74, v66, v30, 0
  v_dot2_f32_bf16 v75, v66, v31, 0
  v_dot2_f32_bf16 v76, v67, v32, 0
  v_dot2_f32_bf16 v77, v67, v33, 0
  v_cvt_pk_bf16_f32 v64, v70, v71
  v_cvt_pk_bf16_f32 v65, v72, v73
  v_cvt_pk_bf16_f32 v66, v74, v75
  v_cvt_pk_bf16_f32 v67, v76, v77
  v_cvt_pk_bf16_f32 v68, v78, 0
  v_dot2_f32_bf16 v78, v68, v62, v44
  v_dot2_f32_bf16 v70, v64, v62, v36
  v_dot2_f32_bf16 v71, v64, v63, v37
  v_dot2_f32_bf16 v72, v65, v62, v38
  v_dot2_f32_bf16 v73, v65, v63, v39
  v_dot2_f32_bf16 v74, v66, v62, v40
  v_dot2_f32_bf16 v75, v66, v63, v41
  v_dot2_f32_bf16 v76, v67, v62, v42
  v_dot2_f32_bf16 v77, v67, v63, v43
  v_cvt_pk_bf16_f32 v96, v70, v71
  v_cvt_pk_bf16_f32 v97, v72, v73
  v_cvt_pk_bf16_f32 v98, v74, v75
  v_cvt_pk_bf16_f32 v99, v76, v77
  v_cvt_pk_bf16_f32 v100, v78, 0
  v_dot2_f32_bf16 v86, v96, v56, 0
  v_dot2_f32_bf16 v86, v97, v57, v86
  v_dot2_f32_bf16 v86, v98, v58, v86
  v_dot2_f32_bf16 v86, v99, v59, v86
  v_dot2_f32_bf16 v86, v100, v60, v86
  s_nop 2
  v_add_f32 v86, v86, v86 row_shr:1 row_mask:0xf bank_mask:0xf bound_ctrl:0
  s_nop 1
  v_add_f32 v86, v86, v86 row_shr:2 row_mask:0xf bank_mask:0xf bound_ctrl:0
  s_nop 1
  v_add_f32 v86, v86, v86 row_shr:4 row_mask:0xf bank_mask:0xf bound_ctrl:0
  s_nop 1
  v_add_f32 v86, v86, v86 row_shr:8 row_mask:0xf bank_mask:0xf bound_ctrl:0
  s_nop 1
  v_add_f32 v86, v86, v86 row_bcast:15 row_mask:0xa bank_mask:0xf
  s_nop 1
  v_add_f32 v86, v86, v86 row_bcast:31 row_mask:0xc bank_mask:0xf
  s_nop 1
  v_cvt_pk_bf16_f32 v86, v86, v86
  s_mov_b64 exec, 1
  v_readlane_b32 s47, v86, 63
  s_ashr_i32 s41, s47, 31
  s_or_b32 s41, s41, 0x80000000
  s_xor_b32 s47, s47, s41
  s_and_b32 s47, s47, 0xffff0000
  s_or_b32 s47, s47, s61
  v_mov_b32 v216, s47
  ds_write_b64 v214, v[216:217] offset:320
  ds_add_u32 v248, v249 offset:248
  s_mov_b64 exec, -1
  s_mov_b32 s41, s3
  s_cmp_lg_u32 s3, 7
  s_cbranch_scc1 T_NK
T_KS:
  ds_read_b32 v89, v248 offset:248
  ds_read_b128 v[108:111], v212 offset:320
  s_waitcnt lgkmcnt(0)
  v_readfirstlane_b32 s94, v89
  s_cmp_ge_u32 s94, 8
  s_cbranch_scc0 T_KS
  s_mov_b32 exec_hi, 0
  s_waitcnt lgkmcnt(0)
  global_store_dwordx4 v213, v[108:111], s[36:37] sc1
  s_mov_b64 exec, -1
T_NK:
  s_setprio 0

  v_dot2_f32_bf16 v78, v100, v54, 0
  v_dot2_f32_bf16 v70, v96, v46, 0
  v_dot2_f32_bf16 v71, v96, v47, 0
  v_dot2_f32_bf16 v72, v97, v48, 0
  v_dot2_f32_bf16 v73, v97, v49, 0
  v_dot2_f32_bf16 v74, v98, v50, 0
  v_dot2_f32_bf16 v75, v98, v51, 0
  v_dot2_f32_bf16 v76, v99, v52, 0
  v_dot2_f32_bf16 v77, v99, v53, 0
  v_lshlrev_b32 v16, 16, v80
  v_and_b32 v17, 0xffff0000, v80
  v_lshlrev_b32 v18, 16, v81
  v_and_b32 v19, 0xffff0000, v81
  v_lshlrev_b32 v20, 16, v82
  v_and_b32 v21, 0xffff0000, v82
  v_lshlrev_b32 v22, 16, v83
  v_and_b32 v23, 0xffff0000, v83
  v_lshlrev_b32 v24, 16, v84
  v_cvt_pk_bf16_f32 v64, v70, v71
  v_cvt_pk_bf16_f32 v65, v72, v73
  v_cvt_pk_bf16_f32 v66, v74, v75
  v_cvt_pk_bf16_f32 v67, v76, v77
  v_cvt_pk_bf16_f32 v68, v78, 0
  v_dot2_f32_bf16 v78, v68, v62, v24
  v_dot2_f32_bf16 v70, v64, v62, v16
  v_dot2_f32_bf16 v71, v64, v63, v17
  v_dot2_f32_bf16 v72, v65, v62, v18
  v_dot2_f32_bf16 v73, v65, v63, v19
  v_dot2_f32_bf16 v74, v66, v62, v20
  v_dot2_f32_bf16 v75, v66, v63, v21
  v_dot2_f32_bf16 v76, v67, v62, v22
  v_dot2_f32_bf16 v77, v67, v63, v23
  s_and_b32 s40, s2, 7
  s_lshl_b32 s40, s40, 14
  s_lshl_b32 s50, s3, 11
  s_add_u32 s40, s40, s50
  s_add_u32 s40, s40, 65536
  v_lshl_add_u32 v6, v2, 4, s40

  v_cvt_pk_bf16_f32 v102, v70, v71
  v_cvt_pk_bf16_f32 v103, v72, v73
  v_cvt_pk_bf16_f32 v104, v74, v75
  v_cvt_pk_bf16_f32 v105, v76, v77
  v_cvt_pk_bf16_f32 v106, v78, 0
  s_cmp_lg_u32 s41, 7
  s_cbranch_scc1 T_NK2

  s_waitcnt vmcnt(0)
  s_mov_b64 exec, 1
  ds_add_u32 v248, v249 offset:256
  s_mov_b64 exec, -1
T_NK2:

  s_cmp_ge_u32 s2, 144
  s_cbranch_scc1 T_NW
  s_cmp_ge_u32 s3, 4
  s_cbranch_scc1 T_W2
  s_waitcnt vmcnt(0)

  s_mov_b64 exec, 1
  ds_add_u32 v248, v249 offset:260
  s_mov_b64 exec, -1
T_W2:
  v_bfe_u32 v7, v2, 2, 2
  v_lshrrev_b32 v8, 4, v2
  v_lshl_add_u32 v7, v8, 3, v7
  v_and_b32 v8, 3, v2
  v_lshlrev_b32 v8, 3, v8
  v_mul_u32_u24 v21, 1152, v7
  v_add_u32 v21, v21, v8
  s_lshl_b32 s40, s3, 5
  s_add_u32 s40, s40, 82432
  v_add_u32 v21, s40, v21
  v_lshl_add_u32 v7, v7, 6, v8
  s_lshr_b32 s40, s3, 1
  s_mul_i32 s50, s40, 5
  s_cmp_eq_u32 s40, 3
  s_cselect_b32 s50, 14, s50
  s_lshl_b32 s51, s50, 11
  s_and_b32 s40, s3, 1
  s_lshl_b32 s40, s40, 5
  s_add_u32 s40, s40, s51
  s_add_u32 s40, s40, 45568
  v_add_u32 v7, s40, v7
  v_add_u32 v8, 73728, v7

SP_10:
  ds_read_b32 v251, v248 offset:260
  s_waitcnt lgkmcnt(0)
  v_readfirstlane_b32 s94, v251
  s_cmp_ge_u32 s94, 4
  s_cbranch_scc0 SP_10

  ds_read_b64_tr_b16 v[136:137], v8 offset:0
  ds_read_b64_tr_b16 v[138:139], v8 offset:256
  ds_read_b64_tr_b16 v[140:141], v7 offset:0
  ds_read_b64_tr_b16 v[142:143], v7 offset:256
  ds_read_b64_tr_b16 v[144:145], v8 offset:2048
  ds_read_b64_tr_b16 v[146:147], v8 offset:2304
  ds_read_b64_tr_b16 v[148:149], v7 offset:2048
  ds_read_b64_tr_b16 v[150:151], v7 offset:2304
  ds_read_b64_tr_b16 v[152:153], v8 offset:4096
  ds_read_b64_tr_b16 v[154:155], v8 offset:4352
  ds_read_b64_tr_b16 v[156:157], v7 offset:4096
  ds_read_b64_tr_b16 v[158:159], v7 offset:4352
  ds_read_b64_tr_b16 v[160:161], v8 offset:6144
  ds_read_b64_tr_b16 v[162:163], v8 offset:6400
  ds_read_b64_tr_b16 v[164:165], v7 offset:6144
  ds_read_b64_tr_b16 v[166:167], v7 offset:6400
  ds_read_b64_tr_b16 v[168:169], v8 offset:8192
  ds_read_b64_tr_b16 v[170:171], v8 offset:8448
  ds_read_b64_tr_b16 v[172:173], v7 offset:8192
  ds_read_b64_tr_b16 v[174:175], v7 offset:8448
  s_cmp_ge_u32 s2, 144
  s_cbranch_scc1 T_NDN
  s_cmp_ge_u32 s3, 4
  s_cbranch_scc1 T_NDN
  s_mul_i32 s40, s46, 36864
  s_mul_i32 s51, s3, 9216
  s_add_u32 s40, s40, s51
  s_add_u32 m0, s51, 82432
  v_lshl_add_u32 v9, v2, 4, s40

  global_load_lds_dwordx4 v9, s[26:27] offset:0
  global_load_lds_dwordx4 v9, s[26:27] offset:1024
  global_load_lds_dwordx4 v9, s[26:27] offset:2048
  s_add_u32 m0, m0, 3072
  v_add_u32 v9, 3072, v9
  global_load_lds_dwordx4 v9, s[26:27] offset:0
  global_load_lds_dwordx4 v9, s[26:27] offset:1024
  global_load_lds_dwordx4 v9, s[26:27] offset:2048
  s_add_u32 m0, m0, 3072
  v_add_u32 v9, 3072, v9
  global_load_lds_dwordx4 v9, s[26:27] offset:0
  global_load_lds_dwordx4 v9, s[26:27] offset:1024
  global_load_lds_dwordx4 v9, s[26:27] offset:2048
T_NDN:
T_NW:
  v_and_b32 v4, 3, v2
  v_lshlrev_b32 v4, 3, v4
  s_mov_b32 s41, 65536

SP_11:
  ds_read_b32 v251, v248 offset:256
  s_waitcnt lgkmcnt(0)
  v_readfirstlane_b32 s94, v251
  s_cmp_ge_u32 s94, 1
  s_cbranch_scc0 SP_11

  s_cmp_lt_u32 s2, 144
  s_cbranch_scc1 T_KP1
T_KP:
  s_sleep 6
T_KP1:
  global_load_dwordx4 v[108:111], v6, s[36:37] offset:0 sc1
  global_load_dwordx4 v[112:115], v6, s[36:37] offset:1024 sc1
  s_waitcnt vmcnt(0)
  s_mov_b64 exec, -1
  v_xor_b32 v64, s38, v109
  v_xor_b32 v65, s38, v111
  v_xor_b32 v66, s38, v113
  v_xor_b32 v67, s38, v115
  v_or3_b32 v64, v64, v65, v66
  v_or_b32 v64, v64, v67
  v_cmp_ne_u32 vcc, 0, v64
  s_cbranch_vccz T_KD
  s_mov_b64 exec, vcc
  s_sub_u32 s41, s41, 1
  s_cbranch_scc1 T_KPX
  s_and_b32 s40, s41, 3
  s_cbranch_scc1 T_KP1
  s_branch T_KP
T_KPX:
  s_mov_b64 exec, -1
T_KD:

  v_max_u32 v64, v108, v112
  v_max_u32 v65, v110, v114
  s_nop 0
  v_max_u32 v64, v64, v64 row_shr:4 row_mask:0xf bank_mask:0xf bound_ctrl:0
  v_max_u32 v65, v65, v65 row_shr:4 row_mask:0xf bank_mask:0xf bound_ctrl:0
  s_nop 0
  v_max_u32 v64, v64, v64 row_shr:8 row_mask:0xf bank_mask:0xf bound_ctrl:0
  v_max_u32 v65, v65, v65 row_shr:8 row_mask:0xf bank_mask:0xf bound_ctrl:0
  s_mov_b32 exec_lo, 0xf000f000
  s_mov_b32 exec_hi, 0xf000f000
  ds_max_u32 v4, v64 offset:288
  ds_max_u32 v4, v65 offset:292
  s_mov_b64 exec, -1
  s_waitcnt lgkmcnt(0)
  s_barrier
  ds_read_b128 v[64:67], v248 offset:288
  ds_read_b128 v[68:71], v248 offset:304
  s_waitcnt lgkmcnt(0)
  v_min3_u32 v64, v64, v65, v66
  v_min3_u32 v68, v68, v69, v70
  v_min3_u32 v64, v64, v67, v71
  v_min_u32 v64, v64, v68
  s_lshl_b32 s40, s2, 3
  s_add_u32 s40, s40, s3
  s_mul_i32 s51, s40, 3072
  v_cmp_ge_u32 vcc, s47, v64

  v_cmp_ge_u32 s[66:67], v108, v64
  v_cmp_ge_u32 s[68:69], v110, v64
  v_cmp_ge_u32 s[70:71], v112, v64
  v_cmp_ge_u32 s[72:73], v114, v64
  s_bcnt1_i32_b64 s74, s[66:67]
  s_bcnt1_i32_b64 s75, s[68:69]
  s_bcnt1_i32_b64 s76, s[70:71]
  s_bcnt1_i32_b64 s77, s[72:73]
  s_add_u32 s75, s75, s74
  s_add_u32 s76, s76, s75
  s_add_u32 s77, s77, s76
  s_mov_b64 exec, 1
  v_mov_b32 v65, s77
  ds_add_rtn_u32 v66, v248, v65 offset:252
  s_mov_b64 exec, -1
  s_cbranch_vccz T_NPUB
  s_add_u32 s51, s51, 13631488
  v_lshl_add_u32 v5, v2, 4, s51
  v_mov_b32 v72, v99
  v_mov_b32 v73, v83
  v_lshl_or_b32 v74, v84, 16, v100
  v_mov_b32 v75, s38
  v_mov_b32 v99, s38
  v_mov_b32 v83, s38
  global_store_dwordx4 v5, v[96:99], s[36:37] sc1
  global_store_dwordx4 v5, v[72:75], s[36:37] offset:1024 sc1
  global_store_dwordx4 v5, v[80:83], s[36:37] offset:2048 sc1
T_NPUB:

  v_mbcnt_lo_u32_b32 v68, s66, 0
  v_mbcnt_hi_u32_b32 v68, s67, v68
  v_mov_b32 v69, s74
  v_mbcnt_lo_u32_b32 v69, s68, v69
  v_mbcnt_hi_u32_b32 v69, s69, v69
  v_mov_b32 v70, s75
  v_mbcnt_lo_u32_b32 v70, s70, v70
  v_mbcnt_hi_u32_b32 v70, s71, v70
  v_mov_b32 v71, s76
  v_mbcnt_lo_u32_b32 v71, s72, v71
  v_mbcnt_hi_u32_b32 v71, s73, v71
  s_waitcnt lgkmcnt(0)
  v_readfirstlane_b32 s74, v66
  v_and_b32 v4, 31, v2
  v_lshlrev_b32 v4, 2, v4
  v_lshrrev_b32 v7, 5, v2
  v_lshlrev_b32 v7, 4, v7
  s_mov_b32 s48, 8

  v_add_lshl_u32 v68, v68, s74, 2
  v_add_lshl_u32 v69, v69, s74, 2
  v_add_lshl_u32 v70, v70, s74, 2
  v_add_lshl_u32 v71, v71, s74, 2
  s_mov_b64 exec, s[66:67]
  ds_write_b32 v68, v108 offset:11264
  s_mov_b64 exec, s[68:69]
  ds_write_b32 v69, v110 offset:11264
  s_mov_b64 exec, s[70:71]
  ds_write_b32 v70, v112 offset:11264
  s_mov_b64 exec, s[72:73]
  ds_write_b32 v71, v114 offset:11264
  s_mov_b64 exec, -1
  s_mov_b32 s76, 0
  s_mov_b32 s77, 0
  s_waitcnt lgkmcnt(0)
  s_barrier
  ds_read_b32 v65, v248 offset:252
T_OUT:
  ds_read_b32 v64, v4 offset:11264

  ds_read_b128 v[108:111], v7 offset:11264
  ds_read_b128 v[112:115], v7 offset:11296
  ds_read_b128 v[116:119], v7 offset:11328
  ds_read_b128 v[120:123], v7 offset:11360
  v_mov_b32 v66, 0
  v_add_u32 v67, 128, v7
  s_waitcnt lgkmcnt(4)
  v_readfirstlane_b32 s74, v65

  s_waitcnt lgkmcnt(3)
  v_cmp_gt_u32 vcc, v108, v64
  v_addc_co_u32 v66, vcc, 0, v66, vcc
  v_cmp_gt_u32 vcc, v109, v64
  v_addc_co_u32 v66, vcc, 0, v66, vcc
  v_cmp_gt_u32 vcc, v110, v64
  v_addc_co_u32 v66, vcc, 0, v66, vcc
  v_cmp_gt_u32 vcc, v111, v64
  v_addc_co_u32 v66, vcc, 0, v66, vcc
  s_min_u32 s74, s74, 2048
  s_waitcnt lgkmcnt(2)
  v_cmp_gt_u32 vcc, v112, v64
  v_addc_co_u32 v66, vcc, 0, v66, vcc
  v_cmp_gt_u32 vcc, v113, v64
  v_addc_co_u32 v66, vcc, 0, v66, vcc
  v_cmp_gt_u32 vcc, v114, v64
  v_addc_co_u32 v66, vcc, 0, v66, vcc
  v_cmp_gt_u32 vcc, v115, v64
  v_addc_co_u32 v66, vcc, 0, v66, vcc
  s_cmp_le_u32 s74, 16
  s_cbranch_scc1 T_RK
  s_waitcnt lgkmcnt(1)
  v_cmp_gt_u32 vcc, v116, v64
  v_addc_co_u32 v66, vcc, 0, v66, vcc
  v_cmp_gt_u32 vcc, v117, v64
  v_addc_co_u32 v66, vcc, 0, v66, vcc
  v_cmp_gt_u32 vcc, v118, v64
  v_addc_co_u32 v66, vcc, 0, v66, vcc
  v_cmp_gt_u32 vcc, v119, v64
  v_addc_co_u32 v66, vcc, 0, v66, vcc
  s_cmp_le_u32 s74, 24
  s_cbranch_scc1 T_RK
  s_waitcnt lgkmcnt(0)
  v_cmp_gt_u32 vcc, v120, v64
  v_addc_co_u32 v66, vcc, 0, v66, vcc
  v_cmp_gt_u32 vcc, v121, v64
  v_addc_co_u32 v66, vcc, 0, v66, vcc
  v_cmp_gt_u32 vcc, v122, v64
  v_addc_co_u32 v66, vcc, 0, v66, vcc
  v_cmp_gt_u32 vcc, v123, v64
  v_addc_co_u32 v66, vcc, 0, v66, vcc
  s_mov_b32 s75, 32
T_IN:
  s_cmp_ge_u32 s75, s74
  s_cbranch_scc1 T_RK
  ds_read_b128 v[108:111], v67 offset:11264
  v_add_u32 v67, 32, v67
  s_add_u32 s75, s75, 8
  s_waitcnt lgkmcnt(0)

  v_cmp_gt_u32 vcc, v108, v64
  v_addc_co_u32 v66, vcc, 0, v66, vcc
  v_cmp_gt_u32 vcc, v109, v64
  v_addc_co_u32 v66, vcc, 0, v66, vcc
  v_cmp_gt_u32 vcc, v110, v64
  v_addc_co_u32 v66, vcc, 0, v66, vcc
  v_cmp_gt_u32 vcc, v111, v64
  v_addc_co_u32 v66, vcc, 0, v66, vcc
  s_branch T_IN
T_RK:
  v_mov_b32 v67, v66
  s_waitcnt lgkmcnt(0)
  s_nop 0
  v_permlane32_swap_b32 v66, v67
  v_add_u32 v66, v66, v67
  v_cmp_eq_u32 vcc, s3, v66
  v_cmp_eq_u32 s[66:67], s47, v64
  v_min_u32 v66, 8, v66
  s_ff1_i32_b64 s75, vcc
  v_lshlrev_b32 v67, 2, v66
  s_cbranch_vccz T_NMINE
  v_readlane_b32 s77, v64, s75
T_NMINE:
  s_ff1_i32_b64 s75, s[66:67]
  ds_write_b32 v67, v64 offset:384
  s_cmp_eq_u64 s[66:67], 0
  s_cbranch_scc1 T_NOWN
  v_readlane_b32 s48, v66, s75
T_NOWN:
  v_add_u32 v4, 128, v4
  s_add_u32 s76, s76, 32
  s_cmp_lt_u32 s76, s74
  s_cbranch_scc1 T_OUT

  s_andn2_b32 s77, 0x7ff, s77
  s_mul_i32 s77, s77, 3072
  s_add_u32 s77, s77, 13631488
  v_lshl_add_u32 v4, v2, 4, s77
  s_cmp_ge_u32 s2, 144
  s_cbranch_scc1 T_NRL
  global_load_dwordx4 v[64:67], v4, s[36:37] sc1
  global_load_dwordx4 v[68:71], v4, s[36:37] offset:1024 sc1
  global_load_dwordx4 v[72:75], v4, s[36:37] offset:2048 sc1
T_NRL:
  s_mul_i32 s40, s40, 1152
  s_cmp_lt_u32 s48, 8
  s_cbranch_scc1 T_STD
  v_lshl_add_u32 v18, v2, 4, s40
  v_lshl_add_u32 v19, v2, 1, s40
  global_store_dwordx4 v18, v[102:105], s[32:33]
  global_store_short v19, v106, s[32:33] offset:1024
T_STD:
  s_cmp_ge_u32 s2, 144
  s_cbranch_scc1 T_END
  s_mul_i32 s40, s3, 1168
  s_add_u32 s40, s40, 19712
  v_lshl_add_u32 v5, v2, 4, s40
  v_lshl_add_u32 v6, v2, 1, s40
  s_mov_b32 s41, 65536

  ds_read_b64_tr_b16 v[176:177], v21 offset:0
  ds_read_b64_tr_b16 v[178:179], v21 offset:4608
  ds_read_b64_tr_b16 v[180:181], v21 offset:256
  ds_read_b64_tr_b16 v[182:183], v21 offset:4864
  ds_read_b64_tr_b16 v[184:185], v21 offset:512
  ds_read_b64_tr_b16 v[186:187], v21 offset:5120
  ds_read_b64_tr_b16 v[188:189], v21 offset:768
  ds_read_b64_tr_b16 v[190:191], v21 offset:5376
  ds_read_b64_tr_b16 v[192:193], v21 offset:1024
  ds_read_b64_tr_b16 v[194:195], v21 offset:5632
  v_and_b32 v7, 7, v2
  v_mul_u32_u24 v17, 80, v7
  v_mul_u32_u24 v7, 1168, v7
  v_and_b32 v8, 0x30, v2
  v_add_u32 v17, v17, v8
  s_lshl_b32 s40, s50, 6
  s_add_u32 s40, s40, 19712
  v_add3_u32 v7, v7, v8, s40
  s_lshl_b32 s40, s3, 10
  s_add_u32 s40, s40, 1536
  v_lshl_add_u32 v8, v2, 4, s40
  v_and_b32 v9, 1, v2
  v_lshlrev_b32 v9, 9, v9
  v_bfe_u32 v16, v2, 1, 4
  v_lshl_add_u32 v9, v16, 4, v9
  v_lshrrev_b32 v16, 5, v2
  v_lshl_add_u32 v9, v16, 10, v9
  s_lshr_b32 s40, s3, 2
  s_lshl_b32 s40, s40, 8
  s_and_b32 s51, s3, 3
  s_lshl_b32 s51, s51, 2
  s_add_u32 s40, s40, s51
  s_add_u32 s40, s40, 1536
  v_add_u32 v9, s40, v9
  s_mul_i32 s40, s3, 80
  v_and_b32 v16, -2, v2
  v_add_u32 v16, s40, v16
  s_branch T_RP2
T_RP:
  s_sleep 10
T_RP1:
  global_load_dwordx4 v[64:67], v4, s[36:37] sc1
  global_load_dwordx4 v[68:71], v4, s[36:37] offset:1024 sc1
  global_load_dwordx4 v[72:75], v4, s[36:37] offset:2048 sc1
T_RP2:
  s_waitcnt vmcnt(0)
  v_xor_b32 v76, s38, v67
  v_xor_b32 v77, s38, v71
  v_xor_b32 v78, s38, v75
  v_or3_b32 v76, v76, v77, v78
  v_cmp_ne_u32 vcc, 0, v76
  s_cbranch_vccz T_RD
  s_sub_u32 s41, s41, 1
  s_cbranch_scc1 T_RD
  s_and_b32 s40, s41, 3
  s_cbranch_scc1 T_RP1
  s_branch T_RP
T_RD:
  v_mov_b32 v67, v68
  v_mov_b32 v75, v69
  ds_write_b128 v5, v[64:67]
  ds_write_b16 v6, v70 offset:1024
  s_waitcnt lgkmcnt(0)

  s_barrier
  ds_read_b128 v[108:111], v7 offset:0
  ds_read_b128 v[112:115], v7 offset:64
  ds_read_b128 v[116:119], v7 offset:128
  ds_read_b128 v[120:123], v7 offset:192
  ds_read_b128 v[124:127], v7 offset:256
  ds_write_b128 v5, v[72:75] offset:9344
  ds_write_b16_d16_hi v6, v70 offset:10368
  s_waitcnt lgkmcnt(6)
  v_mfma_f32_16x16x32_bf16 v[84:87], v[108:111], v[136:139], 0
  v_mfma_f32_16x16x32_bf16 v[88:91], v[108:111], v[140:143], 0
  s_waitcnt lgkmcnt(5)
  v_mfma_f32_16x16x32_bf16 v[84:87], v[112:115], v[144:147], v[84:87]
  v_mfma_f32_16x16x32_bf16 v[88:91], v[112:115], v[148:151], v[88:91]
  s_waitcnt lgkmcnt(4)
  v_mfma_f32_16x16x32_bf16 v[84:87], v[116:119], v[152:155], v[84:87]
  v_mfma_f32_16x16x32_bf16 v[88:91], v[116:119], v[156:159], v[88:91]
  s_waitcnt lgkmcnt(3)
  v_mfma_f32_16x16x32_bf16 v[84:87], v[120:123], v[160:163], v[84:87]
  v_mfma_f32_16x16x32_bf16 v[88:91], v[120:123], v[164:167], v[88:91]
  s_cmp_ge_u32 s3, 4
  s_cbranch_scc1 T_G4
  s_waitcnt lgkmcnt(2)
  v_mfma_f32_16x16x32_bf16 v[84:87], v[124:127], v[168:171], v[84:87]
  v_mfma_f32_16x16x32_bf16 v[88:91], v[124:127], v[172:175], v[88:91]
T_G4:
  v_lshrrev_b32 v18, 5, v2
  v_lshlrev_b32 v18, 5, v18
  v_bfe_u32 v19, v2, 3, 2
  v_add_u32 v18, v18, v19
  s_lshl_b32 s40, s3, 2
  v_add_u32 v18, s40, v18
  v_mul_u32_u24 v18, 18432, v18
  s_mov_b32 exec_hi, 0
  ds_write_b128 v8, v[84:87]
  ds_write_b128 v8, v[88:91] offset:512
  s_mov_b64 exec, -1
  v_and_b32 v19, 7, v2
  v_lshl_add_u32 v18, v19, 4, v18
  s_lshl_b32 s40, s2, 7
  s_add_u32 s40, s40, 10485760
  v_add_u32 v18, s40, v18
  v_add_u32 v19, 1179648, v18
  v_add_u32 v20, 2359296, v18
  s_waitcnt lgkmcnt(0)
  s_barrier
  ds_read_b32 v64, v9
  ds_read_b32 v65, v9 offset:2048
  ds_read_b32 v66, v9 offset:4096
  ds_read_b32 v67, v9 offset:6144

  s_mov_b32 s52, 0x05030201
  s_mov_b32 s53, 0x06050302
  s_mov_b32 s54, 0x07060503
  v_mov_b32 v71, s38
  v_mov_b32 v75, s38
  v_mov_b32 v79, s38
  s_waitcnt lgkmcnt(2)
  v_add_f32 v64, v64, v65
  s_waitcnt lgkmcnt(0)
  v_add_f32 v66, v66, v67
  v_add_f32 v64, v64, v66
  v_cvt_pk_bf16_f32 v64, v64, v64
  v_lshlrev_b32 v64, 16, v64
  v_mul_f32 v65, 0xbfb8aa3b, v64
  v_exp_f32 v65, v65
  s_nop 0
  v_add_f32 v65, 1.0, v65
  v_rcp_f32 v65, v65
  s_nop 0
  v_mul_f32 v65, v64, v65
  v_cvt_pk_bf16_f32 v65, v65, v65
  v_lshlrev_b32 v65, 16, v65
  s_nop 0
  v_mul_f32 v65, v64, v65 quad_perm:[1,1,3,3] row_mask:0xf bank_mask:0xf
  v_cvt_pk_bf16_f32 v65, v65, v65
  s_mov_b32 exec_lo, 0x55555555
  s_mov_b32 exec_hi, 0x55555555
  ds_write_b16 v16, v65 offset:38400
  s_mov_b64 exec, -1
  s_waitcnt lgkmcnt(0)
  s_barrier
  ds_read_b128 v[64:67], v17 offset:38400
  s_waitcnt lgkmcnt(0)

  v_mfma_f32_16x16x32_bf16 v[80:83], v[64:67], v[176:179], 0
  v_mfma_f32_16x16x32_bf16 v[84:87], v[64:67], v[180:183], 0
  v_mfma_f32_16x16x32_bf16 v[88:91], v[64:67], v[184:187], 0
  v_mfma_f32_16x16x32_bf16 v[92:95], v[64:67], v[188:191], 0
  v_mfma_f32_16x16x32_bf16 v[96:99], v[64:67], v[192:195], 0
  s_mul_i32 s40, s2, 18432
  s_add_u32 s40, s40, 10485760
  v_lshl_add_u32 v4, v0, 4, s40
  v_add_u32 v5, 8192, v4
  v_add_u32 v6, 16384, v4
  s_nop 0

  v_permlane32_swap_b32 v80, v84
  v_permlane32_swap_b32 v81, v85
  v_permlane32_swap_b32 v82, v86
  v_permlane32_swap_b32 v83, v87
  v_perm_b32 v68, v81, v80, s52
  v_perm_b32 v69, v82, v81, s53
  v_perm_b32 v70, v83, v82, s54
  global_store_dwordx4 v18, v[68:71], s[36:37] sc1
  v_permlane32_swap_b32 v88, v92
  v_permlane32_swap_b32 v89, v93
  v_permlane32_swap_b32 v90, v94
  v_permlane32_swap_b32 v91, v95
  v_perm_b32 v72, v89, v88, s52
  v_perm_b32 v73, v90, v89, s53
  v_perm_b32 v74, v91, v90, s54
  global_store_dwordx4 v19, v[72:75], s[36:37] sc1
  s_cmp_ge_u32 s3, 4
  s_cbranch_scc1 T_NS3
  v_perm_b32 v76, v97, v96, s52
  v_perm_b32 v77, v98, v97, s53
  v_perm_b32 v78, v99, v98, s54
  s_mov_b32 exec_hi, 0
  global_store_dwordx4 v20, v[76:79], s[36:37] sc1
  s_mov_b64 exec, -1
T_NS3:

  s_cmp_lg_u32 s3, 7
  s_cbranch_scc1 T_NF
  s_lshr_b32 s40, s2, 2
  s_lshl_b32 s40, s40, 4
  s_and_b32 s41, s2, 1
  s_lshl_b32 s41, s41, 3
  s_add_u32 s40, s40, s41
  v_and_b32 v24, 7, v2
  v_add_u32 v24, s40, v24
  v_lshlrev_b32 v24, 1, v24
  v_bfe_u32 v25, v2, 3, 2
  s_and_b32 s41, s2, 2
  s_lshl_b32 s41, s41, 1
  v_add_u32 v25, s41, v25
  v_lshlrev_b32 v26, 2, v25
  v_mul_u32_u24 v25, 1168, v25
  v_add_u32 v25, v25, v24
  v_add_u32 v27, 158464, v24
  ds_read_b32 v28, v26 offset:384
  ds_read_u16 v29, v25 offset:19712
  ds_read_u16 v30, v25 offset:29056
  ds_read_u16 v31, v27
  s_waitcnt lgkmcnt(0)
  v_and_b32 v32, 0xffff, v28
  v_sub_u32 v32, 0xffff, v32
  v_min_u32 v32, 2047, v32
  v_mul_u32_u24 v32, 1152, v32
  v_add_u32 v32, v32, v24
  v_ashrrev_i32 v33, 31, v28
  v_not_b32 v33, v33
  v_or_b32 v33, 0x80000000, v33
  v_xor_b32 v33, v33, v28
  v_and_b32 v33, 0xffff0000, v33
  v_mul_f32 v33, 0xbfb8aa3b, v33
  v_exp_f32 v33, v33
  v_lshlrev_b32 v29, 16, v29
  v_add_f32 v33, 1.0, v33
  v_rcp_f32 v33, v33
  v_lshlrev_b32 v30, 16, v30
  v_cvt_pk_bf16_f32 v33, v33, v33
  v_lshlrev_b32 v33, 16, v33
  v_lshlrev_b32 v31, 16, v31
  s_cmp_lg_u32 s2, 0
  s_cbranch_scc1 T_NF
  v_mov_b32 v34, 19922944
  v_mov_b32 v35, s38
  s_mov_b64 exec, 1
  global_store_dword v34, v35, s[36:37]
  s_mov_b64 exec, -1
T_NF:
  s_mov_b32 s52, 0x0201000c
  s_mov_b32 s53, 0x0504030c
  s_mov_b32 s54, 0x0403020c
  s_mov_b32 s55, 0x0302010c
  v_mov_b32 v107, s38
  v_mov_b32 v104, 0
  v_mov_b32 v105, 0
  v_mov_b32 v106, 0
  v_bfe_u32 v7, v2, 4, 2
  v_lshlrev_b32 v7, 5, v7
  v_and_b32 v8, 7, v2
  v_lshl_add_u32 v7, v8, 2, v7
  s_lshl_b32 s40, s3, 7
  v_add_u32 v7, s40, v7
  s_mov_b32 s41, 65536
  s_waitcnt vmcnt(0)
T_GP:
  s_sleep 3
  global_load_dwordx4 v[96:99], v4, s[36:37] sc1
  global_load_dwordx4 v[100:103], v5, s[36:37] sc1
  s_cmp_ge_u32 s3, 2
  s_cbranch_scc1 T_G3
  global_load_dwordx4 v[104:107], v6, s[36:37] sc1
T_G3:
  s_waitcnt vmcnt(0)
  s_mov_b64 exec, -1
  v_xor_b32 v64, s38, v99
  v_xor_b32 v65, s38, v103
  v_xor_b32 v66, s38, v107
  v_or3_b32 v64, v64, v65, v66
  v_cmp_ne_u32 vcc, 0, v64
  s_cbranch_vccz T_GD
  s_mov_b64 exec, vcc
  s_sub_u32 s41, s41, 1
  s_cbranch_scc0 T_GP
  s_mov_b64 exec, -1
T_GD:

  v_perm_b32 v64, v96, v96, s52
  v_perm_b32 v65, v97, v96, s53
  v_perm_b32 v66, v98, v97, s54
  v_perm_b32 v67, v98, v98, s55
  v_perm_b32 v68, v100, v100, s52
  v_perm_b32 v69, v101, v100, s53
  v_perm_b32 v70, v102, v101, s54
  v_perm_b32 v71, v102, v102, s55
  v_perm_b32 v72, v104, v104, s52
  v_perm_b32 v73, v105, v104, s53
  v_perm_b32 v74, v106, v105, s54
  v_perm_b32 v75, v106, v106, s55
  v_add_f32 v64, v64, v68
  v_add_f32 v65, v65, v69
  v_add_f32 v66, v66, v70
  v_add_f32 v67, v67, v71
  v_add_f32 v64, v64, v72
  v_add_f32 v65, v65, v73
  v_add_f32 v66, v66, v74
  v_add_f32 v67, v67, v75
  s_nop 1
  v_permlane32_swap_b32 v64, v66
  v_permlane32_swap_b32 v65, v67
  v_add_f32 v64, v64, v66
  v_add_f32 v65, v65, v67
  s_nop 1
  v_permlane16_swap_b32 v64, v65
  v_add_f32 v64, v64, v65
  s_nop 1
  v_add_f32 v64, v64, v64 row_shl:8 row_mask:0xf bank_mask:0x3
  s_mov_b32 exec_lo, 0x00ff00ff
  s_mov_b32 exec_hi, 0x00ff00ff
  ds_write_b32 v7, v64 offset:39040
  s_mov_b64 exec, -1
  v_lshlrev_b32 v8, 2, v2
  s_waitcnt lgkmcnt(0)
  s_barrier
  s_cmp_lg_u32 s3, 7
  s_cbranch_scc1 T_END

  ds_read_b32 v64, v8 offset:39040
  ds_read_b32 v65, v8 offset:39168
  ds_read_b32 v66, v8 offset:39296
  ds_read_b32 v67, v8 offset:39424
  ds_read_b32 v68, v8 offset:39552
  ds_read_b32 v69, v8 offset:39680
  ds_read_b32 v70, v8 offset:39808
  ds_read_b32 v71, v8 offset:39936
  s_waitcnt lgkmcnt(4)
  v_add_f32 v64, v64, v65
  v_add_f32 v66, v66, v67
  s_waitcnt lgkmcnt(0)
  v_add_f32 v68, v68, v69
  v_add_f32 v70, v70, v71
  v_add_f32 v64, v64, v66
  v_add_f32 v68, v68, v70
  v_add_f32 v64, v64, v68
  v_cvt_pk_bf16_f32 v64, v64, v64
  v_lshlrev_b32 v64, 16, v64
  v_mul_f32 v64, v64, v33
  v_cvt_pk_bf16_f32 v64, v64, v64
  v_lshlrev_b32 v64, 16, v64
  v_add_f32 v64, v64, v29
  v_cvt_pk_bf16_f32 v64, v64, v64
  v_lshlrev_b32 v64, 16, v64
  v_mul_f32 v64, v64, v31
  v_cvt_pk_bf16_f32 v64, v64, v64
  v_lshlrev_b32 v64, 16, v64
  v_add_f32 v64, v64, v30
  v_cvt_pk_bf16_f32 v64, v64, v64
  s_mov_b32 exec_hi, 0
  global_store_short v32, v64, s[32:33]

T_END:
M_END:
  s_endpgm
.p2align 7
BOXT:
  .long 0x0, 0x0, 0x0, 0x0
  .long 0x0, 0x0, 0x0, 0x0
  .long 0x0, 0x0, 0x0, 0x0
  .long 0x0, 0x0, 0x0, 0x0
  .long 0x0, 0x0, 0x0, 0x0
  .long 0x0, 0x0, 0x0, 0x0
  .long 0x0, 0x0, 0x0, 0x0
  .long 0x0, 0x0, 0x0, 0x0
  .long 0x0, 0x0, 0x0, 0x0
  .long 0x0, 0x0, 0x0, 0x0
  .long 0x0, 0x0, 0x0, 0x0
  .long 0x0, 0x0, 0x0, 0x0
  .long 0x3c00, 0x0, 0x0, 0x0
  .long 0x3c003c00, 0x0, 0x0, 0x0
  .long 0x3c003c00, 0x3c00, 0x0, 0x0
  .long 0x3c003c00, 0x3c003c00, 0x0, 0x0
  .long 0x0, 0x0, 0x0, 0x0
  .long 0x0, 0x0, 0x0, 0x0
  .long 0x0, 0x0, 0x0, 0x0
  .long 0x0, 0x0, 0x0, 0x0
  .long 0x3c00, 0x0, 0x0, 0x0
  .long 0x3c003c00, 0x0, 0x0, 0x0
  .long 0x3c003c00, 0x3c00, 0x0, 0x0
  .long 0x3c003c00, 0x3c003c00, 0x0, 0x0
  .long 0x3c003c00, 0x3c003c00, 0x3c00, 0x0
  .long 0x3c003c00, 0x3c003c00, 0x3c003c00, 0x0
  .long 0x3c003c00, 0x3c003c00, 0x3c003c00, 0x3c00
  .long 0x3c003c00, 0x3c003c00, 0x3c003c00, 0x3c003c00
  .long 0x3c003c00, 0x3c003c00, 0x3c003c00, 0x3c003c00
  .long 0x3c000000, 0x3c003c00, 0x3c003c00, 0x3c003c00
  .long 0x0, 0x3c003c00, 0x3c003c00, 0x3c003c00
  .long 0x0, 0x3c000000, 0x3c003c00, 0x3c003c00
  .long 0x3c003c00, 0x3c003c00, 0x3c00, 0x0
  .long 0x3c003c00, 0x3c003c00, 0x3c003c00, 0x0
  .long 0x3c003c00, 0x3c003c00, 0x3c003c00, 0x3c00
  .long 0x3c003c00, 0x3c003c00, 0x3c003c00, 0x3c003c00
  .long 0x3c003c00, 0x3c003c00, 0x3c003c00, 0x3c003c00
  .long 0x3c000000, 0x3c003c00, 0x3c003c00, 0x3c003c00
  .long 0x0, 0x3c003c00, 0x3c003c00, 0x3c003c00
  .long 0x0, 0x3c000000, 0x3c003c00, 0x3c003c00
  .long 0x0, 0x0, 0x3c003c00, 0x3c003c00
  .long 0x0, 0x0, 0x3c000000, 0x3c003c00
  .long 0x0, 0x0, 0x0, 0x3c003c00
  .long 0x0, 0x0, 0x0, 0x3c000000
  .long 0x0, 0x0, 0x0, 0x0
  .long 0x0, 0x0, 0x0, 0x0
  .long 0x0, 0x0, 0x0, 0x0
  .long 0x0, 0x0, 0x0, 0x0
  .long 0x0, 0x0, 0x3c003c00, 0x3c003c00
  .long 0x0, 0x0, 0x3c000000, 0x3c003c00
  .long 0x0, 0x0, 0x0, 0x3c003c00
  .long 0x0, 0x0, 0x0, 0x3c000000
  .long 0x0, 0x0, 0x0, 0x0
  .long 0x0, 0x0, 0x0, 0x0
  .long 0x0, 0x0, 0x0, 0x0
  .long 0x0, 0x0, 0x0, 0x0
  .long 0x0, 0x0, 0x0, 0x0
  .long 0x0, 0x0, 0x0, 0x0
  .long 0x0, 0x0, 0x0, 0x0
  .long 0x0, 0x0, 0x0, 0x0
  .long 0x0, 0x0, 0x0, 0x0
  .long 0x0, 0x0, 0x0, 0x0
  .long 0x0, 0x0, 0x0, 0x0
  .long 0x0, 0x0, 0x0, 0x0
  .long 0x0, 0x0, 0x0, 0x0
  .long 0x0, 0x0, 0x0, 0x0
  .long 0x0, 0x0, 0x0, 0x0
  .long 0x0, 0x0, 0x0, 0x0
  .long 0x0, 0x0, 0x0, 0x0
  .long 0x0, 0x0, 0x0, 0x0
  .long 0x0, 0x0, 0x0, 0x0
  .long 0x0, 0x0, 0x0, 0x0
  .long 0x0, 0x0, 0x0, 0x0
  .long 0x0, 0x0, 0x0, 0x0
  .long 0x0, 0x0, 0x0, 0x0
  .long 0x0, 0x0, 0x0, 0x0
  .long 0x0, 0x0, 0x0, 0x0
  .long 0x3c00, 0x0, 0x0, 0x0
  .long 0x3c003c00, 0x0, 0x0, 0x0
  .long 0x3c003c00, 0x3c00, 0x0, 0x0
  .long 0x0, 0x0, 0x0, 0x0
  .long 0x0, 0x0, 0x0, 0x0
  .long 0x0, 0x0, 0x0, 0x0
  .long 0x0, 0x0, 0x0, 0x0
  .long 0x0, 0x0, 0x0, 0x0
  .long 0x3c00, 0x0, 0x0, 0x0
  .long 0x3c003c00, 0x0, 0x0, 0x0
  .long 0x3c003c00, 0x3c00, 0x0, 0x0
  .long 0x3c003c00, 0x3c003c00, 0x0, 0x0
  .long 0x3c003c00, 0x3c003c00, 0x3c00, 0x0
  .long 0x3c003c00, 0x3c003c00, 0x3c003c00, 0x0
  .long 0x3c003c00, 0x3c003c00, 0x3c003c00, 0x3c00
  .long 0x3c000000, 0x3c003c00, 0x3c003c00, 0x3c003c00
  .long 0x0, 0x3c003c00, 0x3c003c00, 0x3c003c00
  .long 0x0, 0x3c000000, 0x3c003c00, 0x3c003c00
  .long 0x0, 0x0, 0x3c003c00, 0x3c003c00
  .long 0x3c003c00, 0x3c003c00, 0x0, 0x0
  .long 0x3c003c00, 0x3c003c00, 0x3c00, 0x0
  .long 0x3c003c00, 0x3c003c00, 0x3c003c00, 0x0
  .long 0x3c003c00, 0x3c003c00, 0x3c003c00, 0x3c00
  .long 0x3c000000, 0x3c003c00, 0x3c003c00, 0x3c003c00
  .long 0x0, 0x3c003c00, 0x3c003c00, 0x3c003c00
  .long 0x0, 0x3c000000, 0x3c003c00, 0x3c003c00
  .long 0x0, 0x0, 0x3c003c00, 0x3c003c00
  .long 0x0, 0x0, 0x3c000000, 0x3c003c00
  .long 0x0, 0x0, 0x0, 0x3c003c00
  .long 0x0, 0x0, 0x0, 0x3c000000
  .long 0x0, 0x0, 0x0, 0x0
  .long 0x0, 0x0, 0x0, 0x0
  .long 0x0, 0x0, 0x0, 0x0
  .long 0x0, 0x0, 0x0, 0x0
  .long 0x0, 0x0, 0x0, 0x0
  .long 0x0, 0x0, 0x3c000000, 0x3c003c00
  .long 0x0, 0x0, 0x0, 0x3c003c00
  .long 0x0, 0x0, 0x0, 0x3c000000
  .long 0x0, 0x0, 0x0, 0x0
  .long 0x0, 0x0, 0x0, 0x0
  .long 0x0, 0x0, 0x0, 0x0
  .long 0x0, 0x0, 0x0, 0x0
  .long 0x0, 0x0, 0x0, 0x0
  .long 0x0, 0x0, 0x0, 0x0
  .long 0x0, 0x0, 0x0, 0x0
  .long 0x0, 0x0, 0x0, 0x0
  .long 0x0, 0x0, 0x0, 0x0
  .long 0x0, 0x0, 0x0, 0x0
  .long 0x0, 0x0, 0x0, 0x0
  .long 0x0, 0x0, 0x0, 0x0
  .long 0x0, 0x0, 0x0, 0x0
CODE_END:
.section .rodata,"a"
.p2align 6
.amdhsa_kernel ka_kernel
  .amdhsa_next_free_vgpr 256
  .amdhsa_next_free_sgpr 100
  .amdhsa_accum_offset 256
  .amdhsa_group_segment_fixed_size 0
  .amdhsa_kernarg_size 136
  .amdhsa_user_sgpr_count 2
  .amdhsa_user_sgpr_kernarg_segment_ptr 1
  .amdhsa_system_sgpr_workgroup_id_x 1
  .amdhsa_float_denorm_mode_32 3
  .amdhsa_float_denorm_mode_16_64 3
.end_amdhsa_kernel
```
